```python
import torch

def _softmax(x, axis=-1):
    return torch.softmax(x, dim=axis)
def _gelu(x):
    return torch.nn.functional.gelu(x, approximate="tanh")
def _silu(x):
    return torch.nn.functional.silu(x)
def _sigmoid(x):
    return torch.sigmoid(x)
def _layernorm(x, axis=-1, eps=1e-5):
    m = x.mean(dim=axis, keepdim=True)
    v = x.var(dim=axis, keepdim=True, unbiased=False)
    return (x - m) / torch.sqrt(v + eps)
def _scatter_add(tgt, idx, src, axis=0):
    return tgt.clone().index_add_(axis, idx, src)
def _segment_sum(src, seg, n):
    out = torch.zeros((n,) + src.shape[1:], dtype=src.dtype)
    return out.index_add_(0, seg, src)
def _pad(x, pw):
    flat = tuple(v for pair in reversed(pw) for v in pair)
    return torch.nn.functional.pad(x, flat)

kernel_name = 'sequential_preLN__ssm_conv_s4d__swiglu_ffn__prompt'

def setup_inputs():

    _w = (lambda a: (lambda t: t.to(torch.bfloat16) if t.is_floating_point() else t)(torch.as_tensor(a)))
    def _A_setup():
        Bsz, L, D, N = 1, 2048, 512, 128
        return {
            "u": _w((lambda *s: torch.randn(*s, dtype=torch.bfloat16) * 0.05)(Bsz, L, D)),
            "log_A_real": _w((lambda *s: torch.randn(*s, dtype=torch.bfloat16) * 6.4)(D, N) * 0.5),
            "A_imag": _w((lambda *s: torch.randn(*s, dtype=torch.bfloat16) * 0.05)(D, N) * 3.14),
            "C_real": _w((lambda *s: torch.randn(*s, dtype=torch.bfloat16) * 0.05)(D, N) / N ** 0.5),
            "C_imag": _w((lambda *s: torch.randn(*s, dtype=torch.bfloat16) * 0.05)(D, N) / N ** 0.5),
            "log_dt": _w((lambda *s: torch.randn(*s, dtype=torch.bfloat16) * 0.05)(D) * 0.5 - 4.0),
            "D_skip": _w((lambda *s: torch.randn(*s, dtype=torch.bfloat16) * 0.05)(D)),
        }
    _A_in = _A_setup()

    def _B_setup():
        B, S, D, F = 1, 2048, 512, 1792
        return {
            "x": _w((lambda *s: torch.randn(*s, dtype=torch.bfloat16) * 0.05)(B, S, D)),
            "w_gate": _w((lambda *s: torch.randn(*s, dtype=torch.bfloat16) * 0.05)(D, F)),
            "w_up": _w((lambda *s: torch.randn(*s, dtype=torch.bfloat16) * 0.05)(D, F)),
            "w_down": _w((lambda *s: torch.randn(*s, dtype=torch.bfloat16) * 0.05)(F, D)),
        }
    _B_in = _B_setup()

    return {
        "A_u": _A_in["u"],
        "A_log_A_real": _A_in["log_A_real"],
        "A_A_imag": _A_in["A_imag"],
        "A_C_real": _A_in["C_real"],
        "A_C_imag": _A_in["C_imag"],
        "A_log_dt": _A_in["log_dt"],
        "A_D_skip": _A_in["D_skip"],
        "B_x": _B_in["x"],
        "B_w_gate": _B_in["w_gate"],
        "B_w_up": _B_in["w_up"],
        "B_w_down": _B_in["w_down"],
    }

def reference(A_u, A_log_A_real, A_A_imag, A_C_real, A_C_imag, A_log_dt, A_D_skip, B_x, B_w_gate, B_w_up, B_w_down):
    def _A_ref(u, log_A_real, A_imag, C_real, C_imag, log_dt, D_skip):
        L = u.shape[1]
        dt = torch.exp(log_dt)
        A = -torch.exp(log_A_real) + 1j * A_imag
        C = (C_real + 1j * C_imag) * dt[:, None]
        pos = (lambda x, dt: x.to(dt))(torch.arange(L), log_dt.dtype)
        P = torch.exp((A * dt[:, None])[:, :, None] * pos[None, None, :])
        K = 2.0 * torch.einsum("dn,dnl->dl", C, P).real
        L2 = 2 * L
        u_t = (lambda x, *d: x.permute(*d))(u, 0, 2, 1)
        Kf = (lambda x, *a, **k: torch.fft.rfft(x.float(), *a, **k))(K, L2)
        Uf = (lambda x, *a, **k: torch.fft.rfft(x.float(), *a, **k))(u_t, L2)
        y = (lambda x, *a, **k: torch.fft.irfft(x, *a, **k).to(torch.bfloat16))(Uf * Kf[None, :, :], L2)[:, :, :L]
        y = (lambda x, *d: x.permute(*d))(y, 0, 2, 1)
        return y + u * D_skip[None, None, :]

    def _B_ref(x, w_gate, w_up, w_down):
        g = _silu(x @ w_gate)
        u = x @ w_up
        return (g * u) @ w_down

    x = A_u
    h = x + _A_ref(_layernorm(x, axis=-1), A_log_A_real, A_A_imag, A_C_real, A_C_imag, A_log_dt, A_D_skip)
    h2 = h + _B_ref(_layernorm(h, axis=-1), B_w_gate, B_w_up, B_w_down)
    return h2
```

```asm
; @launch grid=(256,1,1) block=(512,1,1) lds=158720
.amdgcn_target "amdgcn-amd-amdhsa--gfx950"
.text
.globl sequential_preLN__ssm_conv_s4d__swiglu_ffn__prompt_kernel
.p2align 8
.type sequential_preLN__ssm_conv_s4d__swiglu_ffn__prompt_kernel,@function
sequential_preLN__ssm_conv_s4d__swiglu_ffn__prompt_kernel:
    s_load_dwordx16 s[4:19], s[0:1], 0
    s_load_dwordx4 s[52:55], s[0:1], 96
    s_load_dwordx8 s[44:51], s[0:1], 64
    s_memrealtime s[56:57]
    v_lshrrev_b32 v1, 6, v0
    s_cmp_ge_u32 s2, 256
    v_readfirstlane_b32 s20, v1
    s_cbranch_scc1 K12_END
    v_and_b32 v1, 63, v0
    s_getpc_b64 s[62:63]
    s_and_b32 s62, s62, 0xffffff00
    s_and_b32 s60, s2, 0xf8
    s_add_u32 s60, s60, s20
    s_lshl_b32 s60, s60, 8
    v_and_b32 v250, 1, v0
    v_lshl_add_u32 v250, v250, 7, s60
    v_min_u32 v250, K3_END-sequential_preLN__ssm_conv_s4d__swiglu_ffn__prompt_kernel, v250
    global_load_dword v251, v250, s[62:63]
    s_and_b32 s23, s2, 7
    s_lshl_b32 s61, s23, 5
    s_lshr_b32 s26, s2, 3
    s_or_b32 s61, s61, s26
    v_lshlrev_b32 v2, 4, v1
    s_cmp_ge_u32 s20, 4
    s_cbranch_scc1 K12_LN
    s_lshr_b32 s21, s20, 1
    s_lshl_b32 s23, s61, 1
    s_add_u32 s23, s23, s21
    s_lshl_b32 s24, s23, 8
    v_lshl_add_u32 v6, v1, 2, s24
    s_lshl_b32 s26, s23, 1
    v_mov_b32 v7, s26
    s_waitcnt lgkmcnt(0)
    global_load_dword v200, v6, s[6:7]
    global_load_ushort v204, v7, s[14:15]
    global_load_dword v201, v6, s[8:9]
    global_load_dword v202, v6, s[10:11]
    global_load_dword v203, v6, s[12:13]
    global_load_ushort v20, v7, s[16:17]
    s_branch K12_KG
K12_LN:
    s_setprio 2
    s_sub_u32 s58, s20, 4
    s_mov_b32 s21, s61
    s_lshl_b32 s24, s21, 13
    s_lshl_b32 s25, s58, 11
    s_add_u32 s25, s25, s24
    v_add_u32 v4, s25, v2
    v_mov_b32 v128, 0
    v_lshlrev_b32 v6, 2, v1
    s_waitcnt lgkmcnt(0)
    global_load_dwordx4 v[16:19], v4, s[4:5]
    global_load_dwordx4 v[20:23], v4, s[4:5] offset:1024
    s_cmp_lg_u32 s58, 0
    s_cbranch_scc1 K12_L2
    v_mov_b32 v8, 0
    v_writelane_b32 v8, s56, 16
    v_writelane_b32 v8, s57, 17
    s_mov_b64 exec, 0x3ffff
    ds_write_b32 v6, v8 offset:35456
    s_mov_b64 exec, -1
    s_waitcnt lgkmcnt(0)
K12_L2:
    s_barrier
    ds_read_b64 v[8:9], v128 offset:35520
    s_mov_b32 s36, 0xffff0000
    v_mov_b32 v132, 0x70007
    v_mov_b32 v12, 35456
    v_mov_b32 v13, 1
    s_mul_i32 s30, s58, 4224
    s_add_u32 s30, s30, 73728
    v_lshl_add_u32 v120, v1, 5, s30
    v_add_u32 v121, 2112, v120
    v_bfe_u32 v97, v1, 2, 2
    v_mul_u32_u24 v97, 2112, v97
    v_lshrrev_b32 v98, 4, v1
    v_lshl_add_u32 v97, v98, 5, v97
    v_and_b32 v98, 3, v1
    v_lshl_add_u32 v97, v98, 3, v97
    s_lshl_b32 s30, s58, 9
    s_add_u32 s30, s30, 73728
    v_add_u32 v99, s30, v97
    v_lshrrev_b32 v3, 2, v1
    v_lshlrev_b32 v3, 14, v3
    v_lshl_add_u32 v3, v98, 4, v3
    v_add_u32 v124, 0x40000, v3
    v_add_u32 v125, 0x80000, v3
    v_add_u32 v126, 0xc0000, v3
    s_lshl_b32 s30, s58, 20
    s_lshl_b32 s31, s21, 6
    s_add_u32 s30, s30, s31
    s_add_u32 s60, s54, s30
    s_addc_u32 s61, s55, 0
    s_waitcnt lgkmcnt(0)
    v_readfirstlane_b32 s10, v8
    v_readfirstlane_b32 s11, v9
    s_bfe_u32 s4, s10, 0xc0006
    s_and_b32 s14, s10, 0x0fff0000
    s_or_b32 s4, s4, s14
    s_lshr_b64 s[14:15], s[10:11], 26
    s_and_b32 s5, s14, 0xfff
    s_lshl_b32 s14, s14, 6
    s_and_b32 s14, s14, 0x0fff0000
    s_or_b32 s5, s5, s14
    s_mul_i32 s30, s58, 3
    s_lshr_b32 s4, s4, s30
    s_lshr_b32 s5, s5, s30
    s_pack_ll_b32_b16 s6, s4, s5
    s_pack_hh_b32_b16 s7, s4, s5
    s_waitcnt vmcnt(0)
    v_lshlrev_b32 v24, 16, v16
    v_and_b32 v25, s36, v16
    v_lshlrev_b32 v26, 16, v17
    v_and_b32 v27, s36, v17
    v_lshlrev_b32 v28, 16, v18
    v_and_b32 v29, s36, v18
    v_lshlrev_b32 v30, 16, v19
    v_and_b32 v31, s36, v19
    v_lshlrev_b32 v32, 16, v20
    v_and_b32 v33, s36, v20
    v_lshlrev_b32 v34, 16, v21
    v_and_b32 v35, s36, v21
    v_lshlrev_b32 v36, 16, v22
    v_and_b32 v37, s36, v22
    v_lshlrev_b32 v38, 16, v23
    v_and_b32 v39, s36, v23
    v_pk_add_f32 v[40:41], v[24:25], v[26:27]
    v_pk_add_f32 v[42:43], v[28:29], v[30:31]
    v_pk_mul_f32 v[48:49], v[24:25], v[24:25]
    v_pk_mul_f32 v[50:51], v[26:27], v[26:27]
    v_pk_add_f32 v[44:45], v[32:33], v[34:35]
    v_pk_add_f32 v[46:47], v[36:37], v[38:39]
    v_pk_mul_f32 v[52:53], v[32:33], v[32:33]
    v_pk_mul_f32 v[54:55], v[34:35], v[34:35]
    v_pk_add_f32 v[40:41], v[40:41], v[42:43]
    v_pk_fma_f32 v[48:49], v[28:29], v[28:29], v[48:49]
    v_pk_fma_f32 v[50:51], v[30:31], v[30:31], v[50:51]
    v_pk_add_f32 v[44:45], v[44:45], v[46:47]
    v_pk_fma_f32 v[52:53], v[36:37], v[36:37], v[52:53]
    v_pk_fma_f32 v[54:55], v[38:39], v[38:39], v[54:55]
    v_add_f32 v40, v40, v41
    v_pk_add_f32 v[48:49], v[48:49], v[50:51]
    v_add_f32 v44, v44, v45
    v_pk_add_f32 v[52:53], v[52:53], v[54:55]
    v_add_f32 v48, v48, v49
    v_add_f32 v52, v52, v53
    v_add_f32_dpp v40, v40, v40 row_shr:1 row_mask:0xf bank_mask:0xf
    v_add_f32_dpp v44, v44, v44 row_shr:1 row_mask:0xf bank_mask:0xf
    v_add_f32_dpp v48, v48, v48 row_shr:1 row_mask:0xf bank_mask:0xf
    v_add_f32_dpp v52, v52, v52 row_shr:1 row_mask:0xf bank_mask:0xf
    v_add_f32_dpp v40, v40, v40 row_shr:2 row_mask:0xf bank_mask:0xf
    v_add_f32_dpp v44, v44, v44 row_shr:2 row_mask:0xf bank_mask:0xf
    v_add_f32_dpp v48, v48, v48 row_shr:2 row_mask:0xf bank_mask:0xf
    v_add_f32_dpp v52, v52, v52 row_shr:2 row_mask:0xf bank_mask:0xf
    v_add_f32_dpp v40, v40, v40 row_shr:4 row_mask:0xf bank_mask:0xf
    v_add_f32_dpp v44, v44, v44 row_shr:4 row_mask:0xf bank_mask:0xf
    v_add_f32_dpp v48, v48, v48 row_shr:4 row_mask:0xf bank_mask:0xf
    v_add_f32_dpp v52, v52, v52 row_shr:4 row_mask:0xf bank_mask:0xf
    v_add_f32_dpp v40, v40, v40 row_shr:8 row_mask:0xf bank_mask:0xf
    v_add_f32_dpp v44, v44, v44 row_shr:8 row_mask:0xf bank_mask:0xf
    v_add_f32_dpp v48, v48, v48 row_shr:8 row_mask:0xf bank_mask:0xf
    v_add_f32_dpp v52, v52, v52 row_shr:8 row_mask:0xf bank_mask:0xf
    v_add_f32_dpp v40, v40, v40 row_bcast:15 row_mask:0xa bank_mask:0xf
    v_add_f32_dpp v44, v44, v44 row_bcast:15 row_mask:0xa bank_mask:0xf
    v_add_f32_dpp v48, v48, v48 row_bcast:15 row_mask:0xa bank_mask:0xf
    v_add_f32_dpp v52, v52, v52 row_bcast:15 row_mask:0xa bank_mask:0xf
    v_add_f32_dpp v40, v40, v40 row_bcast:31 row_mask:0xc bank_mask:0xf
    v_add_f32_dpp v44, v44, v44 row_bcast:31 row_mask:0xc bank_mask:0xf
    v_add_f32_dpp v48, v48, v48 row_bcast:31 row_mask:0xc bank_mask:0xf
    v_add_f32_dpp v52, v52, v52 row_bcast:31 row_mask:0xc bank_mask:0xf
    v_mul_f32 v40, 0x3b000000, v40
    v_mul_f32 v48, 0x3b000000, v48
    v_mul_f32 v44, 0x3b000000, v44
    v_mul_f32 v52, 0x3b000000, v52
    v_fma_f32 v48, -v40, v40, v48
    v_fma_f32 v52, -v44, v44, v52
    v_max_f32 v48, 0, v48
    v_max_f32 v52, 0, v52
    v_cvt_pk_bf16_f32 v48, v40, v48
    v_cvt_pk_bf16_f32 v52, v44, v52
    v_lshlrev_b32 v40, 16, v48
    v_and_b32 v48, s36, v48
    v_lshlrev_b32 v44, 16, v52
    v_and_b32 v52, s36, v52
    v_readlane_b32 s28, v40, 63
    v_readlane_b32 s32, v44, 63
    v_add_f32 v48, 0x3727c5ac, v48
    v_add_f32 v52, 0x3727c5ac, v52
    v_cvt_pk_bf16_f32 v48, v48, v48
    v_cvt_pk_bf16_f32 v52, v52, v52
    v_lshlrev_b32 v48, 16, v48
    v_lshlrev_b32 v52, 16, v52
    v_sqrt_f32 v48, v48
    v_sqrt_f32 v52, v52
    v_pk_add_f32 v[24:25], v[24:25], s[28:29] op_sel_hi:[1,0] neg_lo:[0,1] neg_hi:[0,1]
    v_pk_add_f32 v[26:27], v[26:27], s[28:29] op_sel_hi:[1,0] neg_lo:[0,1] neg_hi:[0,1]
    v_pk_add_f32 v[28:29], v[28:29], s[28:29] op_sel_hi:[1,0] neg_lo:[0,1] neg_hi:[0,1]
    v_pk_add_f32 v[30:31], v[30:31], s[28:29] op_sel_hi:[1,0] neg_lo:[0,1] neg_hi:[0,1]
    v_pk_add_f32 v[32:33], v[32:33], s[32:33] op_sel_hi:[1,0] neg_lo:[0,1] neg_hi:[0,1]
    v_pk_add_f32 v[34:35], v[34:35], s[32:33] op_sel_hi:[1,0] neg_lo:[0,1] neg_hi:[0,1]
    v_pk_add_f32 v[36:37], v[36:37], s[32:33] op_sel_hi:[1,0] neg_lo:[0,1] neg_hi:[0,1]
    v_pk_add_f32 v[38:39], v[38:39], s[32:33] op_sel_hi:[1,0] neg_lo:[0,1] neg_hi:[0,1]
    v_cvt_pk_bf16_f32 v48, v48, v48
    v_cvt_pk_bf16_f32 v52, v52, v52
    v_lshlrev_b32 v41, 16, v48
    v_lshlrev_b32 v45, 16, v52
    v_rcp_f32 v42, v41
    v_rcp_f32 v46, v45
    v_cvt_pk_bf16_f32 v56, v24, v25
    v_cvt_pk_bf16_f32 v57, v26, v27
    v_cvt_pk_bf16_f32 v58, v28, v29
    v_cvt_pk_bf16_f32 v59, v30, v31
    v_cvt_pk_bf16_f32 v60, v32, v33
    v_cvt_pk_bf16_f32 v61, v34, v35
    v_cvt_pk_bf16_f32 v62, v36, v37
    v_cvt_pk_bf16_f32 v63, v38, v39
    v_mov_b32 v81, v16
    v_xor_b32 v80, s6, v16
    v_mov_b32 v83, v17
    v_xor_b32 v82, s6, v17
    v_mov_b32 v85, v18
    v_xor_b32 v84, s6, v18
    v_mov_b32 v87, v19
    v_xor_b32 v86, s6, v19
    v_mov_b32 v89, v20
    v_xor_b32 v88, s7, v20
    v_mov_b32 v91, v21
    v_xor_b32 v90, s7, v21
    v_mov_b32 v93, v22
    v_xor_b32 v92, s7, v22
    v_mov_b32 v95, v23
    v_xor_b32 v94, s7, v23
    v_readlane_b32 s29, v41, 63
    v_readlane_b32 s30, v42, 63
    v_readlane_b32 s33, v45, 63
    v_readlane_b32 s34, v46, 63
    v_lshlrev_b32 v24, 16, v56
    v_and_b32 v25, s36, v56
    v_lshlrev_b32 v26, 16, v57
    v_and_b32 v27, s36, v57
    v_lshlrev_b32 v28, 16, v58
    v_and_b32 v29, s36, v58
    v_lshlrev_b32 v30, 16, v59
    v_and_b32 v31, s36, v59
    v_lshlrev_b32 v32, 16, v60
    v_and_b32 v33, s36, v60
    v_lshlrev_b32 v34, 16, v61
    v_and_b32 v35, s36, v61
    v_lshlrev_b32 v36, 16, v62
    v_and_b32 v37, s36, v62
    v_lshlrev_b32 v38, 16, v63
    v_and_b32 v39, s36, v63
    v_pk_mul_f32 v[64:65], v[24:25], s[30:31] op_sel_hi:[1,0]
    v_pk_mul_f32 v[66:67], v[26:27], s[30:31] op_sel_hi:[1,0]
    v_pk_mul_f32 v[68:69], v[28:29], s[30:31] op_sel_hi:[1,0]
    v_pk_mul_f32 v[70:71], v[30:31], s[30:31] op_sel_hi:[1,0]
    v_pk_mul_f32 v[72:73], v[32:33], s[34:35] op_sel_hi:[1,0]
    v_pk_mul_f32 v[74:75], v[34:35], s[34:35] op_sel_hi:[1,0]
    v_pk_mul_f32 v[76:77], v[36:37], s[34:35] op_sel_hi:[1,0]
    v_pk_mul_f32 v[78:79], v[38:39], s[34:35] op_sel_hi:[1,0]
    v_pk_fma_f32 v[24:25], v[64:65], s[28:29], v[24:25] op_sel:[0,1,0] op_sel_hi:[1,1,1] neg_lo:[1,0,0] neg_hi:[1,0,0]
    v_pk_fma_f32 v[26:27], v[66:67], s[28:29], v[26:27] op_sel:[0,1,0] op_sel_hi:[1,1,1] neg_lo:[1,0,0] neg_hi:[1,0,0]
    v_pk_fma_f32 v[28:29], v[68:69], s[28:29], v[28:29] op_sel:[0,1,0] op_sel_hi:[1,1,1] neg_lo:[1,0,0] neg_hi:[1,0,0]
    v_pk_fma_f32 v[30:31], v[70:71], s[28:29], v[30:31] op_sel:[0,1,0] op_sel_hi:[1,1,1] neg_lo:[1,0,0] neg_hi:[1,0,0]
    v_pk_fma_f32 v[32:33], v[72:73], s[32:33], v[32:33] op_sel:[0,1,0] op_sel_hi:[1,1,1] neg_lo:[1,0,0] neg_hi:[1,0,0]
    v_pk_fma_f32 v[34:35], v[74:75], s[32:33], v[34:35] op_sel:[0,1,0] op_sel_hi:[1,1,1] neg_lo:[1,0,0] neg_hi:[1,0,0]
    v_pk_fma_f32 v[36:37], v[76:77], s[32:33], v[36:37] op_sel:[0,1,0] op_sel_hi:[1,1,1] neg_lo:[1,0,0] neg_hi:[1,0,0]
    v_pk_fma_f32 v[38:39], v[78:79], s[32:33], v[38:39] op_sel:[0,1,0] op_sel_hi:[1,1,1] neg_lo:[1,0,0] neg_hi:[1,0,0]
    v_pk_fma_f32 v[64:65], v[24:25], s[30:31], v[64:65] op_sel_hi:[1,0,1]
    v_pk_fma_f32 v[66:67], v[26:27], s[30:31], v[66:67] op_sel_hi:[1,0,1]
    v_pk_fma_f32 v[68:69], v[28:29], s[30:31], v[68:69] op_sel_hi:[1,0,1]
    v_pk_fma_f32 v[70:71], v[30:31], s[30:31], v[70:71] op_sel_hi:[1,0,1]
    v_pk_fma_f32 v[72:73], v[32:33], s[34:35], v[72:73] op_sel_hi:[1,0,1]
    v_pk_fma_f32 v[74:75], v[34:35], s[34:35], v[74:75] op_sel_hi:[1,0,1]
    v_pk_fma_f32 v[76:77], v[36:37], s[34:35], v[76:77] op_sel_hi:[1,0,1]
    v_pk_fma_f32 v[78:79], v[38:39], s[34:35], v[78:79] op_sel_hi:[1,0,1]
    v_cvt_pk_bf16_f32 v56, v64, v65
    v_cvt_pk_bf16_f32 v57, v66, v67
    v_cvt_pk_bf16_f32 v58, v68, v69
    v_cvt_pk_bf16_f32 v59, v70, v71
    v_cvt_pk_bf16_f32 v60, v72, v73
    v_cvt_pk_bf16_f32 v61, v74, v75
    v_cvt_pk_bf16_f32 v62, v76, v77
    v_cvt_pk_bf16_f32 v63, v78, v79
    v_lshlrev_b32 v24, 16, v56
    v_and_b32 v25, s36, v56
    v_lshlrev_b32 v26, 16, v57
    v_and_b32 v27, s36, v57
    v_lshlrev_b32 v28, 16, v58
    v_and_b32 v29, s36, v58
    v_lshlrev_b32 v30, 16, v59
    v_and_b32 v31, s36, v59
    v_lshlrev_b32 v32, 16, v60
    v_and_b32 v33, s36, v60
    v_lshlrev_b32 v34, 16, v61
    v_and_b32 v35, s36, v61
    v_lshlrev_b32 v36, 16, v62
    v_and_b32 v37, s36, v62
    v_lshlrev_b32 v38, 16, v63
    v_and_b32 v39, s36, v63
    v_cvt_pk_f16_f32 v56, v24, v25
    v_cvt_pk_f16_f32 v57, v26, v27
    v_cvt_pk_f16_f32 v58, v28, v29
    v_cvt_pk_f16_f32 v59, v30, v31
    v_cvt_pk_f16_f32 v60, v32, v33
    v_cvt_pk_f16_f32 v61, v34, v35
    v_cvt_pk_f16_f32 v62, v36, v37
    v_cvt_pk_f16_f32 v63, v38, v39
    v_bfi_b32 v80, v132, v80, v56
    v_bfi_b32 v82, v132, v82, v57
    ds_write_b128 v120, v[80:83] offset:0
    v_bfi_b32 v84, v132, v84, v58
    v_bfi_b32 v86, v132, v86, v59
    ds_write_b128 v120, v[84:87] offset:16
    v_bfi_b32 v88, v132, v88, v60
    v_bfi_b32 v90, v132, v90, v61
    ds_write_b128 v121, v[88:91] offset:0
    v_bfi_b32 v92, v132, v92, v62
    v_bfi_b32 v94, v132, v94, v63
    ds_write_b128 v121, v[92:95] offset:16
    s_mov_b64 exec, 1
    ds_add_u32 v12, v13 offset:32
    s_mov_b64 exec, -1
SY_5:
    ds_read_b32 v14, v12 offset:32
    s_waitcnt lgkmcnt(0)
    v_cmp_gt_u32 vcc, 4, v14
    s_cbranch_vccnz SY_5
    ds_read_b64_tr_b16 v[40:41], v99 offset:0
    ds_read_b64_tr_b16 v[42:43], v99 offset:8448
    ds_read_b64_tr_b16 v[44:45], v99 offset:128
    ds_read_b64_tr_b16 v[46:47], v99 offset:8576
    ds_read_b64_tr_b16 v[48:49], v99 offset:256
    ds_read_b64_tr_b16 v[50:51], v99 offset:8704
    ds_read_b64_tr_b16 v[52:53], v99 offset:384
    ds_read_b64_tr_b16 v[54:55], v99 offset:8832
    s_waitcnt lgkmcnt(6)
    global_store_dwordx4 v3, v[40:43], s[60:61] sc1
    s_waitcnt lgkmcnt(4)
    global_store_dwordx4 v124, v[44:47], s[60:61] sc1
    s_waitcnt lgkmcnt(2)
    global_store_dwordx4 v125, v[48:51], s[60:61] sc1
    s_waitcnt lgkmcnt(0)
    global_store_dwordx4 v126, v[52:55], s[60:61] sc1
    s_setprio 0
    v_not_b32 v133, v132
    s_lshl_b32 s30, s21, 14
    s_lshl_b32 s31, s58, 12
    s_add_u32 s30, s30, s31
    v_add_u32 v17, s30, v2
    v_and_b32 v18, 1, v1
    v_cmp_eq_u32 vcc, 1, v18
    v_mul_u32_u24 v18, 129440, v18
    v_bfe_u32 v19, v1, 1, 1
    v_mul_u32_u24 v19, 4160, v19
    v_lshrrev_b32 v20, 2, v1
    v_lshlrev_b32 v20, 4, v20
    s_lshl_b32 s30, s58, 10
    s_add_u32 s30, s30, 17152
    v_add3_u32 v18, v18, v19, v20
    v_add_u32 v18, s30, v18
    s_mov_b64 s[34:35], vcc
    v_cmp_eq_u32 vcc, 0, v19
    s_nop 1
    v_cndmask_b32 v61, -1, v133, vcc
    s_mov_b64 s[32:33], vcc
    s_sub_u32 s16, s56, 800
    s_subb_u32 s17, s57, 0
    s_mov_b32 s18, 16384
    s_mov_b32 s19, 0
    s_bfe_u32 s12, s16, 0xc0006
    s_and_b32 s14, s16, 0x0fff0000
    s_or_b32 s12, s12, s14
    s_lshr_b64 s[14:15], s[16:17], 26
    s_and_b32 s13, s14, 0xfff
    s_lshl_b32 s14, s14, 6
    s_and_b32 s14, s14, 0x0fff0000
    s_or_b32 s13, s13, s14
    s_lshl_b32 s12, s12, 4
    s_lshl_b32 s13, s13, 4
    v_mov_b32 v56, s12
    v_mov_b32 v58, s13
    v_cndmask_b32 v56, v56, v58, s[34:35]
    s_lshr_b64 s[14:15], s[18:19], 6
    s_cmp_lg_u32 s15, 0
    s_cselect_b32 s12, -1, s14
    s_min_u32 s12, s12, 4094
    s_lshr_b64 s[14:15], s[18:19], 16
    s_cmp_lg_u32 s15, 0
    s_cselect_b32 s14, -1, s14
    s_min_u32 s14, s14, 4094
    s_lshl_b32 s14, s14, 16
    s_or_b32 s12, s12, s14
    s_add_u32 s12, s12, 0x10001
    s_lshl_b32 s12, s12, 4
    s_lshr_b64 s[14:15], s[18:19], 26
    s_cmp_lg_u32 s15, 0
    s_cselect_b32 s13, -1, s14
    s_min_u32 s13, s13, 4094
    s_lshr_b64 s[14:15], s[18:19], 36
    s_cmp_lg_u32 s15, 0
    s_cselect_b32 s14, -1, s14
    s_min_u32 s14, s14, 4094
    s_lshl_b32 s14, s14, 16
    s_or_b32 s13, s13, s14
    s_add_u32 s13, s13, 0x10001
    s_lshl_b32 s13, s13, 4
    v_mov_b32 v57, s12
    v_mov_b32 v58, s13
    v_cndmask_b32 v57, v57, v58, s[34:35]
    v_cndmask_b32 v57, -1, v57, s[32:33]
SY_6:
    s_sleep 1
    ds_read_b32 v14, v12 offset:12
    s_waitcnt lgkmcnt(0)
    v_cmp_gt_u32 vcc, 2, v14
    s_cbranch_vccnz SY_6
    s_setprio 2
K12_PL:
    global_load_dwordx4 v[64:67], v17, s[54:55] offset:0 sc1
    global_load_dwordx4 v[68:71], v17, s[54:55] offset:1024 sc1
    global_load_dwordx4 v[72:75], v17, s[54:55] offset:2048 sc1
    global_load_dwordx4 v[76:79], v17, s[54:55] offset:3072 sc1
    s_waitcnt vmcnt(3)
    v_xor_b32_dpp v80, v64, v64 quad_perm:[2,3,2,3] row_mask:0xf bank_mask:0xf
    v_xor_b32_dpp v81, v65, v65 quad_perm:[2,3,2,3] row_mask:0xf bank_mask:0xf
    v_xor_b32_dpp v82, v66, v66 quad_perm:[2,3,2,3] row_mask:0xf bank_mask:0xf
    v_xor_b32_dpp v83, v67, v67 quad_perm:[2,3,2,3] row_mask:0xf bank_mask:0xf
    v_and_b32 v64, v61, v64
    v_and_b32 v65, v61, v65
    v_and_b32 v66, v61, v66
    v_and_b32 v67, v61, v67
    ds_write_b128 v18, v[64:67] offset:0
    v_and_b32 v80, v132, v80
    v_and_b32 v81, v132, v81
    v_and_b32 v82, v132, v82
    v_and_b32 v83, v132, v83
    v_lshlrev_b32 v80, 4, v80
    v_lshl_or_b32 v80, v81, 7, v80
    v_lshl_or_b32 v80, v82, 10, v80
    v_lshl_or_b32 v80, v83, 13, v80
    v_pk_sub_u16 v80, v80, v56
    v_pk_max_u16 v48, v80, v57
    s_waitcnt vmcnt(2)
    v_xor_b32_dpp v80, v68, v68 quad_perm:[2,3,2,3] row_mask:0xf bank_mask:0xf
    v_xor_b32_dpp v81, v69, v69 quad_perm:[2,3,2,3] row_mask:0xf bank_mask:0xf
    v_xor_b32_dpp v82, v70, v70 quad_perm:[2,3,2,3] row_mask:0xf bank_mask:0xf
    v_xor_b32_dpp v83, v71, v71 quad_perm:[2,3,2,3] row_mask:0xf bank_mask:0xf
    v_and_b32 v68, v61, v68
    v_and_b32 v69, v61, v69
    v_and_b32 v70, v61, v70
    v_and_b32 v71, v61, v71
    ds_write_b128 v18, v[68:71] offset:256
    v_and_b32 v80, v132, v80
    v_and_b32 v81, v132, v81
    v_and_b32 v82, v132, v82
    v_and_b32 v83, v132, v83
    v_lshlrev_b32 v80, 4, v80
    v_lshl_or_b32 v80, v81, 7, v80
    v_lshl_or_b32 v80, v82, 10, v80
    v_lshl_or_b32 v80, v83, 13, v80
    v_pk_sub_u16 v80, v80, v56
    v_pk_max_u16 v48, v80, v48
    s_waitcnt vmcnt(1)
    v_xor_b32_dpp v80, v72, v72 quad_perm:[2,3,2,3] row_mask:0xf bank_mask:0xf
    v_xor_b32_dpp v81, v73, v73 quad_perm:[2,3,2,3] row_mask:0xf bank_mask:0xf
    v_xor_b32_dpp v82, v74, v74 quad_perm:[2,3,2,3] row_mask:0xf bank_mask:0xf
    v_xor_b32_dpp v83, v75, v75 quad_perm:[2,3,2,3] row_mask:0xf bank_mask:0xf
    v_and_b32 v72, v61, v72
    v_and_b32 v73, v61, v73
    v_and_b32 v74, v61, v74
    v_and_b32 v75, v61, v75
    ds_write_b128 v18, v[72:75] offset:512
    v_and_b32 v80, v132, v80
    v_and_b32 v81, v132, v81
    v_and_b32 v82, v132, v82
    v_and_b32 v83, v132, v83
    v_lshlrev_b32 v80, 4, v80
    v_lshl_or_b32 v80, v81, 7, v80
    v_lshl_or_b32 v80, v82, 10, v80
    v_lshl_or_b32 v80, v83, 13, v80
    v_pk_sub_u16 v80, v80, v56
    v_pk_max_u16 v48, v80, v48
    s_waitcnt vmcnt(0)
    v_xor_b32_dpp v80, v76, v76 quad_perm:[2,3,2,3] row_mask:0xf bank_mask:0xf
    v_xor_b32_dpp v81, v77, v77 quad_perm:[2,3,2,3] row_mask:0xf bank_mask:0xf
    v_xor_b32_dpp v82, v78, v78 quad_perm:[2,3,2,3] row_mask:0xf bank_mask:0xf
    v_xor_b32_dpp v83, v79, v79 quad_perm:[2,3,2,3] row_mask:0xf bank_mask:0xf
    v_and_b32 v76, v61, v76
    v_and_b32 v77, v61, v77
    v_and_b32 v78, v61, v78
    v_and_b32 v79, v61, v79
    ds_write_b128 v18, v[76:79] offset:768
    v_and_b32 v80, v132, v80
    v_and_b32 v81, v132, v81
    v_and_b32 v82, v132, v82
    v_and_b32 v83, v132, v83
    v_lshlrev_b32 v80, 4, v80
    v_lshl_or_b32 v80, v81, 7, v80
    v_lshl_or_b32 v80, v82, 10, v80
    v_lshl_or_b32 v80, v83, 13, v80
    v_pk_sub_u16 v80, v80, v56
    v_pk_max_u16 v48, v80, v48
    v_cmp_ne_u32 vcc, v48, v57
    s_cbranch_vccz K12_GO
    s_wqm_b64 s[28:29], vcc
    s_memrealtime s[14:15]
    s_waitcnt lgkmcnt(0)
    s_sub_u32 s14, s14, s56
    s_cmp_lt_u32 s14, 700
    s_cbranch_scc1 K12_PR
    s_cmp_gt_u32 s14, 200000000
    s_cbranch_scc1 K12_GO
    s_mov_b64 exec, -1
    s_not_b64 s[14:15], s[56:57]
    v_mov_b32 v130, s14
    v_mov_b32 v131, s15
    s_mov_b64 exec, 1
    global_atomic_umax_x2 v[134:135], v128, v[130:131], s[52:53] sc0 sc1
    s_mov_b64 exec, -1
    s_memrealtime s[18:19]
    s_waitcnt vmcnt(0) lgkmcnt(0)
    v_readfirstlane_b32 s14, v134
    v_readfirstlane_b32 s15, v135
    s_nop 0
    s_not_b64 s[14:15], s[14:15]
    s_sub_u32 s14, s14, 800
    s_subb_u32 s15, s15, 0
    s_sub_u32 s12, s14, s16
    s_subb_u32 s13, s15, s17
    s_cselect_b32 s16, s14, s16
    s_cselect_b32 s17, s15, s17
    s_sub_u32 s18, s18, s16
    s_subb_u32 s19, s19, s17
    s_add_u32 s18, s18, 16384
    s_addc_u32 s19, s19, 0
    s_bfe_u32 s12, s16, 0xc0006
    s_and_b32 s14, s16, 0x0fff0000
    s_or_b32 s12, s12, s14
    s_lshr_b64 s[14:15], s[16:17], 26
    s_and_b32 s13, s14, 0xfff
    s_lshl_b32 s14, s14, 6
    s_and_b32 s14, s14, 0x0fff0000
    s_or_b32 s13, s13, s14
    s_lshl_b32 s12, s12, 4
    s_lshl_b32 s13, s13, 4
    v_mov_b32 v56, s12
    v_mov_b32 v58, s13
    v_cndmask_b32 v56, v56, v58, s[34:35]
    s_lshr_b64 s[14:15], s[18:19], 6
    s_cmp_lg_u32 s15, 0
    s_cselect_b32 s12, -1, s14
    s_min_u32 s12, s12, 4094
    s_lshr_b64 s[14:15], s[18:19], 16
    s_cmp_lg_u32 s15, 0
    s_cselect_b32 s14, -1, s14
    s_min_u32 s14, s14, 4094
    s_lshl_b32 s14, s14, 16
    s_or_b32 s12, s12, s14
    s_add_u32 s12, s12, 0x10001
    s_lshl_b32 s12, s12, 4
    s_lshr_b64 s[14:15], s[18:19], 26
    s_cmp_lg_u32 s15, 0
    s_cselect_b32 s13, -1, s14
    s_min_u32 s13, s13, 4094
    s_lshr_b64 s[14:15], s[18:19], 36
    s_cmp_lg_u32 s15, 0
    s_cselect_b32 s14, -1, s14
    s_min_u32 s14, s14, 4094
    s_lshl_b32 s14, s14, 16
    s_or_b32 s13, s13, s14
    s_add_u32 s13, s13, 0x10001
    s_lshl_b32 s13, s13, 4
    v_mov_b32 v57, s12
    v_mov_b32 v58, s13
    v_cndmask_b32 v57, v57, v58, s[34:35]
    v_cndmask_b32 v57, -1, v57, s[32:33]
    s_sleep 8
K12_PR:
    s_mov_b64 exec, s[28:29]
    s_branch K12_PL
K12_GO:
    s_mov_b64 exec, -1
    s_waitcnt lgkmcnt(0)
    s_barrier
    s_setprio 0
    s_mov_b32 s4, 0
    s_add_u32 s30, s58, 1
    s_and_b32 s30, s30, 2
    s_cbranch_scc1 K12_LE
    s_memrealtime s[6:7]
    s_and_b32 s58, s58, 1
    s_min_u32 s27, s26, 27
    s_cmp_ge_u32 s27, 14
    s_cselect_b32 s28, 14, 0
    s_cselect_b32 s40, s46, s44
    s_cselect_b32 s41, s47, s45
    s_sub_u32 s28, s27, s28
    s_lshl_b32 s28, s28, 8
    s_lshl_b32 s29, s23, 1
    s_add_u32 s29, s29, s58
    s_mul_i32 s29, s29, 114688
    s_add_u32 s28, s28, s29
    v_lshrrev_b32 v7, 4, v1
    v_and_b32 v96, 15, v1
    v_mul_u32_u24 v7, 3584, v7
    v_lshl_add_u32 v7, v96, 4, v7
    v_add_u32 v7, s28, v7
    s_lshl_b32 s30, s2, 3
    s_add_u32 s30, s30, 0x1140000
    v_mov_b32 v30, s30
    s_waitcnt lgkmcnt(0)
    v_mov_b32 v32, s6
    v_mov_b32 v33, s7
    s_cmp_lg_u32 s58, 0
    s_cbranch_scc1 K12_NF
    s_mov_b64 exec, 1
    global_store_dwordx2 v30, v[32:33], s[54:55] sc1
    s_mov_b64 exec, -1
K12_NF:
    global_load_dwordx4 v[104:107], v7, s[40:41]
    v_add_u32 v7, 14336, v7
    global_load_dwordx4 v[108:111], v7, s[40:41]
    v_add_u32 v7, 14336, v7
    global_load_dwordx4 v[112:115], v7, s[40:41]
    v_add_u32 v7, 14336, v7
    global_load_dwordx4 v[116:119], v7, s[40:41]
    v_add_u32 v7, 14336, v7
    global_load_dwordx4 v[120:123], v7, s[40:41]
    v_add_u32 v7, 14336, v7
    global_load_dwordx4 v[124:127], v7, s[40:41]
    v_add_u32 v7, 14336, v7
    global_load_dwordx4 v[128:131], v7, s[40:41]
    v_add_u32 v7, 14336, v7
    global_load_dwordx4 v[132:135], v7, s[40:41]
    s_waitcnt vmcnt(7)
    v_lshlrev_b32 v64, 16, v104
    v_and_b32 v65, s36, v104
    v_lshlrev_b32 v66, 16, v105
    v_and_b32 v67, s36, v105
    v_lshlrev_b32 v68, 16, v106
    v_and_b32 v69, s36, v106
    v_lshlrev_b32 v70, 16, v107
    v_and_b32 v71, s36, v107
    s_waitcnt vmcnt(6)
    v_lshlrev_b32 v72, 16, v108
    v_and_b32 v73, s36, v108
    v_add_f32 v64, v64, v72
    v_add_f32 v65, v65, v73
    v_lshlrev_b32 v72, 16, v109
    v_and_b32 v73, s36, v109
    v_add_f32 v66, v66, v72
    v_add_f32 v67, v67, v73
    v_lshlrev_b32 v72, 16, v110
    v_and_b32 v73, s36, v110
    v_add_f32 v68, v68, v72
    v_add_f32 v69, v69, v73
    v_lshlrev_b32 v72, 16, v111
    v_and_b32 v73, s36, v111
    v_add_f32 v70, v70, v72
    v_add_f32 v71, v71, v73
    s_waitcnt vmcnt(5)
    v_lshlrev_b32 v72, 16, v112
    v_and_b32 v73, s36, v112
    v_add_f32 v64, v64, v72
    v_add_f32 v65, v65, v73
    v_lshlrev_b32 v72, 16, v113
    v_and_b32 v73, s36, v113
    v_add_f32 v66, v66, v72
    v_add_f32 v67, v67, v73
    v_lshlrev_b32 v72, 16, v114
    v_and_b32 v73, s36, v114
    v_add_f32 v68, v68, v72
    v_add_f32 v69, v69, v73
    v_lshlrev_b32 v72, 16, v115
    v_and_b32 v73, s36, v115
    v_add_f32 v70, v70, v72
    v_add_f32 v71, v71, v73
    s_waitcnt vmcnt(4)
    v_lshlrev_b32 v72, 16, v116
    v_and_b32 v73, s36, v116
    v_add_f32 v64, v64, v72
    v_add_f32 v65, v65, v73
    v_lshlrev_b32 v72, 16, v117
    v_and_b32 v73, s36, v117
    v_add_f32 v66, v66, v72
    v_add_f32 v67, v67, v73
    v_lshlrev_b32 v72, 16, v118
    v_and_b32 v73, s36, v118
    v_add_f32 v68, v68, v72
    v_add_f32 v69, v69, v73
    v_lshlrev_b32 v72, 16, v119
    v_and_b32 v73, s36, v119
    v_add_f32 v70, v70, v72
    v_add_f32 v71, v71, v73
    s_waitcnt vmcnt(3)
    v_lshlrev_b32 v72, 16, v120
    v_and_b32 v73, s36, v120
    v_add_f32 v64, v64, v72
    v_add_f32 v65, v65, v73
    v_lshlrev_b32 v72, 16, v121
    v_and_b32 v73, s36, v121
    v_add_f32 v66, v66, v72
    v_add_f32 v67, v67, v73
    v_lshlrev_b32 v72, 16, v122
    v_and_b32 v73, s36, v122
    v_add_f32 v68, v68, v72
    v_add_f32 v69, v69, v73
    v_lshlrev_b32 v72, 16, v123
    v_and_b32 v73, s36, v123
    v_add_f32 v70, v70, v72
    v_add_f32 v71, v71, v73
    s_waitcnt vmcnt(2)
    v_lshlrev_b32 v72, 16, v124
    v_and_b32 v73, s36, v124
    v_add_f32 v64, v64, v72
    v_add_f32 v65, v65, v73
    v_lshlrev_b32 v72, 16, v125
    v_and_b32 v73, s36, v125
    v_add_f32 v66, v66, v72
    v_add_f32 v67, v67, v73
    v_lshlrev_b32 v72, 16, v126
    v_and_b32 v73, s36, v126
    v_add_f32 v68, v68, v72
    v_add_f32 v69, v69, v73
    v_lshlrev_b32 v72, 16, v127
    v_and_b32 v73, s36, v127
    v_add_f32 v70, v70, v72
    v_add_f32 v71, v71, v73
    s_waitcnt vmcnt(1)
    v_lshlrev_b32 v72, 16, v128
    v_and_b32 v73, s36, v128
    v_add_f32 v64, v64, v72
    v_add_f32 v65, v65, v73
    v_lshlrev_b32 v72, 16, v129
    v_and_b32 v73, s36, v129
    v_add_f32 v66, v66, v72
    v_add_f32 v67, v67, v73
    v_lshlrev_b32 v72, 16, v130
    v_and_b32 v73, s36, v130
    v_add_f32 v68, v68, v72
    v_add_f32 v69, v69, v73
    v_lshlrev_b32 v72, 16, v131
    v_and_b32 v73, s36, v131
    v_add_f32 v70, v70, v72
    v_add_f32 v71, v71, v73
    s_waitcnt vmcnt(0)
    v_lshlrev_b32 v72, 16, v132
    v_and_b32 v73, s36, v132
    v_add_f32 v64, v64, v72
    v_add_f32 v65, v65, v73
    v_lshlrev_b32 v72, 16, v133
    v_and_b32 v73, s36, v133
    v_add_f32 v66, v66, v72
    v_add_f32 v67, v67, v73
    v_lshlrev_b32 v72, 16, v134
    v_and_b32 v73, s36, v134
    v_add_f32 v68, v68, v72
    v_add_f32 v69, v69, v73
    v_lshlrev_b32 v72, 16, v135
    v_and_b32 v73, s36, v135
    v_add_f32 v70, v70, v72
    v_add_f32 v71, v71, v73
    s_lshl_b32 s30, s58, 11
    s_add_u32 s30, s30, 81920
    v_lshl_add_u32 v7, v1, 5, s30
    ds_write_b128 v7, v[64:67]
    ds_write_b128 v7, v[68:71] offset:16
    s_mov_b64 exec, 1
    ds_add_rtn_u32 v14, v12, v13 offset:36
    s_mov_b64 exec, -1
    s_waitcnt lgkmcnt(0)
    v_readfirstlane_b32 s30, v14
    s_nop 0
    s_cmp_lg_u32 s30, 1
    s_cbranch_scc1 K12_LE
    v_lshlrev_b32 v7, 3, v1
    v_add_u32 v15, 81920, v7
    s_mul_i32 s30, s23, 14336
    s_lshl_b32 s31, s27, 9
    s_add_u32 s30, s30, s31
    s_add_u32 s30, s30, 0x1120000
    v_add_u32 v7, s30, v7
    ds_read_b64 v[64:65], v15 offset:0
    ds_read_b64 v[66:67], v15 offset:512
    ds_read_b64 v[68:69], v15 offset:1024
    ds_read_b64 v[70:71], v15 offset:1536
    ds_read_b64 v[72:73], v15 offset:2048
    ds_read_b64 v[74:75], v15 offset:2560
    ds_read_b64 v[76:77], v15 offset:3072
    ds_read_b64 v[78:79], v15 offset:3584
    s_waitcnt lgkmcnt(0)
    v_add_f32 v64, v64, v72
    v_add_f32 v65, v65, v73
    v_add_f32 v66, v66, v74
    v_add_f32 v67, v67, v75
    v_add_f32 v68, v68, v76
    v_add_f32 v69, v69, v77
    v_add_f32 v70, v70, v78
    v_add_f32 v71, v71, v79
    v_add_f32 v64, v64, v68
    v_add_f32 v65, v65, v69
    v_add_f32 v66, v66, v70
    v_add_f32 v67, v67, v71
    v_add_f32 v64, v64, v66
    v_add_f32 v65, v65, v67
    global_store_dwordx2 v7, v[64:65], s[54:55] sc1
    s_mov_b32 s4, 1
K12_LE:
    s_branch FFN_ENTRY
K12_END:
    s_endpgm
K12_KG:
    s_setprio 1
    s_and_b32 s22, s20, 1
    s_mul_i32 s25, s21, 56320
    s_add_u32 s25, s25, 41984
    s_mul_i32 s59, s21, 46592
    s_add_u32 s59, s59, 27136
    s_mul_i32 s27, s21, 129440
    v_and_b32 v3, 15, v1
    v_lshrrev_b32 v4, 4, v1
    v_mov_b32 v8, 0
    v_mov_b32 v9, 0
    v_mov_b32 v10, 0
    v_mov_b32 v11, 0
    s_mov_b32 s36, 0xffff0000
    s_lshl_b32 s30, s61, 13
    s_lshl_b32 s31, s20, 11
    s_add_u32 s30, s30, s31
    s_add_u32 s30, s30, 0x800000
    v_add_u32 v212, s30, v2
    v_mov_b32 v208, -1
    v_mov_b32 v209, -1
    v_mov_b32 v210, -1
    v_mov_b32 v211, -1
    s_barrier
    global_store_dwordx4 v212, v[208:211], s[54:55] sc1
    global_store_dwordx4 v212, v[208:211], s[54:55] offset:1024 sc1
    s_mov_b32 s32, 0x3fb8aa3b
    s_mov_b32 s33, 0x32a57060
    s_mov_b32 s34, 0x3e22f983
    s_mov_b32 s35, 0x31dc9c88
    v_lshl_add_u32 v26, v1, 3, s25
    v_mul_u32_u24 v27, 544, v3
    v_lshl_add_u32 v27, v4, 4, v27
    v_add_u32 v27, s25, v27
    s_lshl_b32 s26, s21, 4
    s_add_u32 s26, s26, 35456
    v_mov_b32 v18, s26
    v_mov_b32 v19, 1
    s_add_u32 s28, s27, 25424
    s_mul_i32 s29, s22, 4160
    s_add_u32 s29, s29, s27
    s_lshl_b32 s37, s22, 8
    s_add_u32 s37, s37, s27
    s_add_u32 s37, s37, 16640
    v_add_u32 v6, s37, v2
    s_add_u32 s38, s29, 3840
    v_add_u32 v7, s38, v2
    v_cmp_lt_u32 vcc, 15, v1
    s_nop 1
    v_cndmask_b32 v6, v6, v7, vcc
    v_add_u32 v7, 8256, v7
    v_cmp_lt_u32 vcc, 19, v1
    s_nop 1
    v_cndmask_b32 v6, v6, v7, vcc
    s_sub_u32 s38, s28, 16
    v_mov_b32 v7, s38
    v_cmp_lt_u32 vcc, 23, v1
    s_nop 1
    v_cndmask_b32 v6, v6, v7, vcc
    s_mov_b64 exec, 0x1ffffff
    ds_write_b128 v6, v[8:11]
    s_mov_b64 exec, -1
    s_add_u32 s39, s28, 0x69800000
    v_lshlrev_b32 v30, 3, v1
    s_lshl_b32 s38, s22, 10
    s_sub_u32 s37, 2047, s38
    v_sub_u32 v31, s37, v30
    v_ffbh_u32 v32, v31
    v_sub_u32 v32, 24, v32
    v_max_i32 v32, 0, v32
    v_sub_u32 v33, 127, v32
    v_lshlrev_b32 v33, 23, v33
    v_cvt_f32_i32 v34, v31
    v_mul_f32 v34, v34, v33
    v_lshlrev_b32 v35, 7, v32
    v_add_u32 v35, 0x4b400000, v35
    v_add_f32 v36, v34, v35
    v_lshl_add_u32 v176, v36, 1, s39
    v_sub_f32 v34, v34, v33
    v_add_f32 v36, v34, v35
    v_lshl_add_u32 v177, v36, 1, s39
    v_sub_f32 v34, v34, v33
    v_add_f32 v36, v34, v35
    v_lshl_add_u32 v178, v36, 1, s39
    v_sub_f32 v34, v34, v33
    v_add_f32 v36, v34, v35
    v_lshl_add_u32 v179, v36, 1, s39
    v_sub_f32 v34, v34, v33
    v_add_f32 v36, v34, v35
    v_lshl_add_u32 v180, v36, 1, s39
    v_sub_f32 v34, v34, v33
    v_add_f32 v36, v34, v35
    v_lshl_add_u32 v181, v36, 1, s39
    v_sub_f32 v34, v34, v33
    v_add_f32 v36, v34, v35
    v_lshl_add_u32 v182, v36, 1, s39
    v_sub_f32 v34, v34, v33
    v_add_f32 v36, v34, v35
    v_lshl_add_u32 v183, v36, 1, s39
    v_add_u32 v31, -8, v31
    v_max_i32 v32, 1, v31
    v_ffbh_u32 v32, v32
    v_sub_u32 v32, 24, v32
    v_max_i32 v32, 0, v32
    v_sub_u32 v33, 127, v32
    v_lshlrev_b32 v33, 23, v33
    v_cvt_f32_i32 v34, v31
    v_mul_f32 v34, v34, v33
    v_lshlrev_b32 v35, 7, v32
    v_add_u32 v35, 0x4b400000, v35
    v_add_f32 v36, v34, v35
    v_lshl_add_u32 v184, v36, 1, s39
    v_sub_f32 v34, v34, v33
    v_add_f32 v36, v34, v35
    v_lshl_add_u32 v185, v36, 1, s39
    v_sub_f32 v34, v34, v33
    v_add_f32 v36, v34, v35
    v_lshl_add_u32 v186, v36, 1, s39
    s_sub_u32 s37, 1535, s38
    v_sub_u32 v31, s37, v30
    v_ffbh_u32 v32, v31
    v_sub_u32 v32, 24, v32
    v_max_i32 v32, 0, v32
    v_sub_u32 v33, 127, v32
    v_lshlrev_b32 v33, 23, v33
    v_cvt_f32_i32 v34, v31
    v_mul_f32 v34, v34, v33
    v_lshlrev_b32 v35, 7, v32
    v_add_u32 v35, 0x4b400000, v35
    v_add_f32 v36, v34, v35
    v_lshl_add_u32 v187, v36, 1, s39
    v_sub_f32 v34, v34, v33
    v_add_f32 v36, v34, v35
    v_lshl_add_u32 v188, v36, 1, s39
    v_sub_f32 v34, v34, v33
    v_add_f32 v36, v34, v35
    v_lshl_add_u32 v189, v36, 1, s39
    v_sub_f32 v34, v34, v33
    v_add_f32 v36, v34, v35
    v_lshl_add_u32 v190, v36, 1, s39
    v_sub_f32 v34, v34, v33
    v_add_f32 v36, v34, v35
    v_lshl_add_u32 v191, v36, 1, s39
    v_sub_f32 v34, v34, v33
    v_add_f32 v36, v34, v35
    v_lshl_add_u32 v192, v36, 1, s39
    v_sub_f32 v34, v34, v33
    v_add_f32 v36, v34, v35
    v_lshl_add_u32 v193, v36, 1, s39
    v_sub_f32 v34, v34, v33
    v_add_f32 v36, v34, v35
    v_lshl_add_u32 v194, v36, 1, s39
    v_add_u32 v31, -8, v31
    v_max_i32 v32, 1, v31
    v_ffbh_u32 v32, v32
    v_sub_u32 v32, 24, v32
    v_max_i32 v32, 0, v32
    v_sub_u32 v33, 127, v32
    v_lshlrev_b32 v33, 23, v33
    v_cvt_f32_i32 v34, v31
    v_mul_f32 v34, v34, v33
    v_lshlrev_b32 v35, 7, v32
    v_add_u32 v35, 0x4b400000, v35
    v_add_f32 v36, v34, v35
    v_lshl_add_u32 v195, v36, 1, s39
    v_sub_f32 v34, v34, v33
    v_add_f32 v36, v34, v35
    v_lshl_add_u32 v196, v36, 1, s39
    v_sub_f32 v34, v34, v33
    v_add_f32 v36, v34, v35
    v_lshl_add_u32 v197, v36, 1, s39
    s_lshl_b32 s30, s22, 11
    s_add_u32 s37, s30, s27
    v_add_u32 v21, s37, v2
    v_lshlrev_b32 v5, 5, v3
    v_lshl_add_u32 v5, v4, 3, v5
    s_add_u32 s37, s37, 17152
    v_add_u32 v15, s37, v5
    s_lshl_b32 s37, s22, 6
    s_sub_u32 s38, s27, s37
    s_add_u32 s39, s38, 16736
    v_lshlrev_b32 v12, 5, v3
    v_lshl_add_u32 v12, v4, 4, v12
    v_add_u32 v12, s39, v12
    v_sub_u32 v13, 47, v3
    v_lshl_add_u32 v13, v4, 3, v13
    v_and_b32 v14, 3, v13
    v_and_b32 v13, -4, v13
    v_lshlrev_b32 v13, 1, v13
    v_mul_u32_u24 v14, 4160, v14
    v_add3_u32 v13, v13, v14, s38
    s_lshl_b32 s37, s22, 12
    s_add_u32 s37, s37, s59
    v_add_u32 v16, s37, v2
    s_xor_b32 s37, s22, 1
    s_lshl_b32 s37, s37, 12
    s_add_u32 s37, s37, s59
    v_add_u32 v17, s37, v2
    s_lshl_b32 s37, s23, 12
    s_add_u32 s37, s37, s30
    s_add_u32 s37, s37, 0x800000
    s_add_u32 s40, s54, s37
    s_addc_u32 s41, s55, 0
    s_waitcnt vmcnt(2)
    v_lshlrev_b32 v20, 16, v20
    v_lshlrev_b32 v42, 16, v204
    v_lshlrev_b32 v40, 16, v200
    v_and_b32 v41, s36, v200
    v_mul_f32 v43, s32, v40
    v_mul_f32 v44, s32, v41
    v_mul_f32 v45, s32, v42
    v_fma_f32 v49, v40, s32, -v43
    v_fma_f32 v50, v41, s32, -v44
    v_fma_f32 v51, v42, s32, -v45
    v_exp_f32 v46, v43
    v_exp_f32 v47, v44
    v_exp_f32 v48, v45
    v_fma_f32 v49, v40, s33, v49
    v_fma_f32 v50, v41, s33, v50
    v_fma_f32 v51, v42, s33, v51
    v_mul_f32 v49, 0x3f317218, v49
    v_mul_f32 v50, 0x3f317218, v50
    v_mul_f32 v51, 0x3f317218, v51
    v_fma_f32 v46, v46, v49, v46
    v_fma_f32 v47, v47, v50, v47
    v_fma_f32 v48, v48, v51, v48
    v_and_b32 v52, 0x7fff7fff, v202
    v_and_b32 v53, 0x7fff7fff, v203
    v_pk_max_u16 v52, v52, v53
    v_lshrrev_b32 v53, 16, v52
    v_and_b32 v52, 0xffff, v52
    v_max_u32 v52, v52, v53
    v_cvt_pk_bf16_f32 v43, v46, v47
    v_cvt_pk_bf16_f32 v44, v48, v48
    v_max_u32_dpp v52, v52, v52 row_shr:1 row_mask:0xf bank_mask:0xf
    v_lshlrev_b32 v48, 16, v44
    v_lshlrev_b32 v46, 16, v43
    v_max_u32_dpp v52, v52, v52 row_shr:2 row_mask:0xf bank_mask:0xf
    v_and_b32 v47, s36, v43
    v_lshlrev_b32 v40, 16, v201
    v_max_u32_dpp v52, v52, v52 row_shr:4 row_mask:0xf bank_mask:0xf
    v_and_b32 v41, s36, v201
    v_mul_f32 v46, v46, v48
    v_max_u32_dpp v52, v52, v52 row_shr:8 row_mask:0xf bank_mask:0xf
    v_mul_f32 v47, v47, v48
    v_mul_f32 v40, v40, v48
    v_max_u32_dpp v52, v52, v52 row_bcast:15 row_mask:0xa bank_mask:0xf
    v_mul_f32 v41, v41, v48
    v_mul_f32 v56, s32, v46
    v_max_u32_dpp v52, v52, v52 row_bcast:31 row_mask:0xc bank_mask:0xf
    v_mul_f32 v57, s32, v47
    v_mul_f32 v58, s34, v40
    v_readlane_b32 s30, v52, 63
    v_mul_f32 v59, s34, v41
    v_fma_f32 v60, v40, s34, -v58
    v_fma_f32 v61, v41, s34, -v59
    s_lshr_b32 s30, s30, 7
    s_max_u32 s30, s30, 8
    s_min_u32 s30, s30, 250
    s_sub_u32 s31, 260, s30
    s_lshl_b32 s31, s31, 23
    s_sub_u32 s30, s30, 5
    s_lshl_b32 s30, s30, 23
    v_fma_f32 v60, v40, s35, v60
    v_fma_f32 v61, v41, s35, v61
    v_lshlrev_b32 v64, 16, v202
    v_and_b32 v65, s36, v202
    v_lshlrev_b32 v66, 16, v203
    v_and_b32 v67, s36, v203
    v_mul_f32 v64, s31, v64
    v_mul_f32 v65, s31, v65
    v_mul_f32 v66, s31, v66
    v_mul_f32 v67, s31, v67
    v_mul_f32 v22, s30, v48
    s_cmp_eq_u32 s22, 1
    s_cbranch_scc1 K12_H1
    v_mul_f32 v43, 0xc1000000, v56
    v_mul_f32 v45, 0x41000000, v58
    v_mul_f32 v44, 0xc1000000, v57
    v_mul_f32 v46, 0x41000000, v59
    v_exp_f32 v43, v43
    v_fract_f32 v45, v45
    v_exp_f32 v44, v44
    v_fract_f32 v46, v46
    v_fmac_f32 v45, 0x41000000, v60
    v_fmac_f32 v46, 0x41000000, v61
    v_cos_f32 v68, v45
    v_sin_f32 v70, v45
    v_cos_f32 v69, v46
    v_sin_f32 v71, v46
    v_mul_f32 v68, v68, v43
    v_mul_f32 v70, v70, v43
    v_mul_f32 v69, v69, v44
    v_mul_f32 v71, v71, v44
    v_mul_f32 v43, 0xbf800000, v56
    v_mul_f32 v45, 0x3f800000, v58
    v_mul_f32 v44, 0xbf800000, v57
    v_mul_f32 v46, 0x3f800000, v59
    v_exp_f32 v43, v43
    v_fract_f32 v45, v45
    v_exp_f32 v44, v44
    v_fract_f32 v46, v46
    v_fmac_f32 v45, 0x3f800000, v60
    v_fmac_f32 v46, 0x3f800000, v61
    v_cos_f32 v72, v45
    v_sin_f32 v74, v45
    v_cos_f32 v73, v46
    v_sin_f32 v75, v46
    v_mul_f32 v72, v72, v43
    v_mul_f32 v74, v74, v43
    v_mul_f32 v73, v73, v44
    v_mul_f32 v75, v75, v44
    v_mul_f32 v43, 0xc3000000, v56
    v_mul_f32 v45, 0x43000000, v58
    v_mul_f32 v44, 0xc3000000, v57
    v_mul_f32 v46, 0x43000000, v59
    v_exp_f32 v43, v43
    v_fract_f32 v45, v45
    v_exp_f32 v44, v44
    v_fract_f32 v46, v46
    v_fmac_f32 v45, 0x43000000, v60
    v_fmac_f32 v46, 0x43000000, v61
    v_cos_f32 v76, v45
    v_sin_f32 v78, v45
    v_cos_f32 v77, v46
    v_sin_f32 v79, v46
    v_mul_f32 v76, v76, v43
    v_mul_f32 v78, v78, v43
    v_mul_f32 v77, v77, v44
    v_mul_f32 v79, v79, v44
    v_mov_b32 v104, 0x3c003c00
    v_mov_b32 v105, 0
    ds_write_b64 v26, v[104:105] offset:22304
    v_cvt_pk_f16_f32 v106, v68, v69
    v_cvt_pk_f16_f32 v107, v70, v71
    ds_write_b64 v26, v[106:107] offset:22848
    v_cvt_pk_f16_f32 v108, v64, v65
    v_cvt_pk_f16_f32 v109, -v66, -v67
    ds_write_b64 v26, v[108:109] offset:0
    v_pk_mul_f32 v[92:93], v[66:67], v[78:79]
    v_pk_mul_f32 v[94:95], v[66:67], v[76:77]
    v_pk_fma_f32 v[86:87], v[64:65], v[78:79], v[94:95]
    v_pk_fma_f32 v[84:85], v[64:65], v[76:77], v[92:93] neg_lo:[0,0,1] neg_hi:[0,0,1]
    v_cvt_pk_f16_f32 v110, v84, v85
    v_cvt_pk_f16_f32 v111, -v86, -v87
    ds_write_b64 v26, v[110:111] offset:4352
    v_pk_mul_f32 v[96:97], v[70:71], v[70:71]
    v_pk_mul_f32 v[98:99], v[70:71], v[68:69]
    v_pk_fma_f32 v[82:83], v[68:69], v[70:71], v[98:99]
    v_pk_fma_f32 v[80:81], v[68:69], v[68:69], v[96:97] neg_lo:[0,0,1] neg_hi:[0,0,1]
    v_pk_mul_f32 v[100:101], v[66:67], v[74:75]
    v_pk_mul_f32 v[102:103], v[66:67], v[72:73]
    v_pk_fma_f32 v[66:67], v[64:65], v[74:75], v[102:103]
    v_pk_fma_f32 v[64:65], v[64:65], v[72:73], v[100:101] neg_lo:[0,0,1] neg_hi:[0,0,1]
    v_cvt_pk_f16_f32 v104, v80, v81
    v_cvt_pk_f16_f32 v105, v82, v83
    ds_write_b64 v26, v[104:105] offset:23392
    v_cvt_pk_f16_f32 v106, v64, v65
    v_cvt_pk_f16_f32 v107, -v66, -v67
    ds_write_b64 v26, v[106:107] offset:544
    v_pk_mul_f32 v[92:93], v[82:83], v[70:71]
    v_pk_mul_f32 v[94:95], v[82:83], v[68:69]
    v_pk_fma_f32 v[82:83], v[80:81], v[70:71], v[94:95]
    v_pk_fma_f32 v[80:81], v[80:81], v[68:69], v[92:93] neg_lo:[0,0,1] neg_hi:[0,0,1]
    v_pk_mul_f32 v[96:97], v[66:67], v[78:79]
    v_pk_mul_f32 v[98:99], v[66:67], v[76:77]
    v_pk_fma_f32 v[86:87], v[64:65], v[78:79], v[98:99]
    v_pk_fma_f32 v[84:85], v[64:65], v[76:77], v[96:97] neg_lo:[0,0,1] neg_hi:[0,0,1]
    v_cvt_pk_f16_f32 v108, v80, v81
    v_cvt_pk_f16_f32 v109, v82, v83
    ds_write_b64 v26, v[108:109] offset:23936
    v_cvt_pk_f16_f32 v110, v84, v85
    v_cvt_pk_f16_f32 v111, -v86, -v87
    ds_write_b64 v26, v[110:111] offset:4896
    v_pk_mul_f32 v[100:101], v[82:83], v[70:71]
    v_pk_mul_f32 v[102:103], v[82:83], v[68:69]
    v_pk_fma_f32 v[82:83], v[80:81], v[70:71], v[102:103]
    v_pk_fma_f32 v[80:81], v[80:81], v[68:69], v[100:101] neg_lo:[0,0,1] neg_hi:[0,0,1]
    v_pk_mul_f32 v[92:93], v[66:67], v[74:75]
    v_pk_mul_f32 v[94:95], v[66:67], v[72:73]
    v_pk_fma_f32 v[66:67], v[64:65], v[74:75], v[94:95]
    v_pk_fma_f32 v[64:65], v[64:65], v[72:73], v[92:93] neg_lo:[0,0,1] neg_hi:[0,0,1]
    v_cvt_pk_f16_f32 v104, v80, v81
    v_cvt_pk_f16_f32 v105, v82, v83
    ds_write_b64 v26, v[104:105] offset:24480
    v_cvt_pk_f16_f32 v106, v64, v65
    v_cvt_pk_f16_f32 v107, -v66, -v67
    ds_write_b64 v26, v[106:107] offset:1088
    v_pk_mul_f32 v[96:97], v[82:83], v[70:71]
    v_pk_mul_f32 v[98:99], v[82:83], v[68:69]
    v_pk_fma_f32 v[82:83], v[80:81], v[70:71], v[98:99]
    v_pk_fma_f32 v[80:81], v[80:81], v[68:69], v[96:97] neg_lo:[0,0,1] neg_hi:[0,0,1]
    v_pk_mul_f32 v[100:101], v[66:67], v[78:79]
    v_pk_mul_f32 v[102:103], v[66:67], v[76:77]
    v_pk_fma_f32 v[86:87], v[64:65], v[78:79], v[102:103]
    v_pk_fma_f32 v[84:85], v[64:65], v[76:77], v[100:101] neg_lo:[0,0,1] neg_hi:[0,0,1]
    v_cvt_pk_f16_f32 v108, v80, v81
    v_cvt_pk_f16_f32 v109, v82, v83
    ds_write_b64 v26, v[108:109] offset:25024
    v_cvt_pk_f16_f32 v110, v84, v85
    v_cvt_pk_f16_f32 v111, -v86, -v87
    ds_write_b64 v26, v[110:111] offset:5440
    v_pk_mul_f32 v[92:93], v[82:83], v[70:71]
    v_pk_mul_f32 v[94:95], v[82:83], v[68:69]
    v_pk_fma_f32 v[82:83], v[80:81], v[70:71], v[94:95]
    v_pk_fma_f32 v[80:81], v[80:81], v[68:69], v[92:93] neg_lo:[0,0,1] neg_hi:[0,0,1]
    v_pk_mul_f32 v[96:97], v[66:67], v[74:75]
    v_pk_mul_f32 v[98:99], v[66:67], v[72:73]
    v_pk_fma_f32 v[66:67], v[64:65], v[74:75], v[98:99]
    v_pk_fma_f32 v[64:65], v[64:65], v[72:73], v[96:97] neg_lo:[0,0,1] neg_hi:[0,0,1]
    v_cvt_pk_f16_f32 v104, v80, v81
    v_cvt_pk_f16_f32 v105, v82, v83
    ds_write_b64 v26, v[104:105] offset:25568
    v_cvt_pk_f16_f32 v106, v64, v65
    v_cvt_pk_f16_f32 v107, -v66, -v67
    ds_write_b64 v26, v[106:107] offset:1632
    v_pk_mul_f32 v[100:101], v[82:83], v[70:71]
    v_pk_mul_f32 v[102:103], v[82:83], v[68:69]
    v_pk_fma_f32 v[82:83], v[80:81], v[70:71], v[102:103]
    v_pk_fma_f32 v[80:81], v[80:81], v[68:69], v[100:101] neg_lo:[0,0,1] neg_hi:[0,0,1]
    v_pk_mul_f32 v[92:93], v[66:67], v[78:79]
    v_pk_mul_f32 v[94:95], v[66:67], v[76:77]
    v_pk_fma_f32 v[86:87], v[64:65], v[78:79], v[94:95]
    v_pk_fma_f32 v[84:85], v[64:65], v[76:77], v[92:93] neg_lo:[0,0,1] neg_hi:[0,0,1]
    v_cvt_pk_f16_f32 v108, v80, v81
    v_cvt_pk_f16_f32 v109, v82, v83
    ds_write_b64 v26, v[108:109] offset:26112
    v_cvt_pk_f16_f32 v110, v84, v85
    v_cvt_pk_f16_f32 v111, -v86, -v87
    ds_write_b64 v26, v[110:111] offset:5984
    v_pk_mul_f32 v[96:97], v[82:83], v[70:71]
    v_pk_mul_f32 v[98:99], v[82:83], v[68:69]
    v_pk_fma_f32 v[82:83], v[80:81], v[70:71], v[98:99]
    v_pk_fma_f32 v[80:81], v[80:81], v[68:69], v[96:97] neg_lo:[0,0,1] neg_hi:[0,0,1]
    v_pk_mul_f32 v[100:101], v[66:67], v[74:75]
    v_pk_mul_f32 v[102:103], v[66:67], v[72:73]
    v_pk_fma_f32 v[66:67], v[64:65], v[74:75], v[102:103]
    v_pk_fma_f32 v[64:65], v[64:65], v[72:73], v[100:101] neg_lo:[0,0,1] neg_hi:[0,0,1]
    v_cvt_pk_f16_f32 v104, v80, v81
    v_cvt_pk_f16_f32 v105, v82, v83
    ds_write_b64 v26, v[104:105] offset:26656
    v_cvt_pk_f16_f32 v106, v64, v65
    v_cvt_pk_f16_f32 v107, -v66, -v67
    ds_write_b64 v26, v[106:107] offset:2176
    v_pk_mul_f32 v[92:93], v[82:83], v[70:71]
    v_pk_mul_f32 v[94:95], v[82:83], v[68:69]
    v_pk_fma_f32 v[82:83], v[80:81], v[70:71], v[94:95]
    v_pk_fma_f32 v[80:81], v[80:81], v[68:69], v[92:93] neg_lo:[0,0,1] neg_hi:[0,0,1]
    v_pk_mul_f32 v[96:97], v[66:67], v[78:79]
    v_pk_mul_f32 v[98:99], v[66:67], v[76:77]
    v_pk_fma_f32 v[86:87], v[64:65], v[78:79], v[98:99]
    v_pk_fma_f32 v[84:85], v[64:65], v[76:77], v[96:97] neg_lo:[0,0,1] neg_hi:[0,0,1]
    v_cvt_pk_f16_f32 v108, v80, v81
    v_cvt_pk_f16_f32 v109, v82, v83
    ds_write_b64 v26, v[108:109] offset:27200
    v_cvt_pk_f16_f32 v110, v84, v85
    v_cvt_pk_f16_f32 v111, -v86, -v87
    ds_write_b64 v26, v[110:111] offset:6528
    v_pk_mul_f32 v[100:101], v[82:83], v[70:71]
    v_pk_mul_f32 v[102:103], v[82:83], v[68:69]
    v_pk_fma_f32 v[82:83], v[80:81], v[70:71], v[102:103]
    v_pk_fma_f32 v[80:81], v[80:81], v[68:69], v[100:101] neg_lo:[0,0,1] neg_hi:[0,0,1]
    v_pk_mul_f32 v[92:93], v[66:67], v[74:75]
    v_pk_mul_f32 v[94:95], v[66:67], v[72:73]
    v_pk_fma_f32 v[66:67], v[64:65], v[74:75], v[94:95]
    v_pk_fma_f32 v[64:65], v[64:65], v[72:73], v[92:93] neg_lo:[0,0,1] neg_hi:[0,0,1]
    v_cvt_pk_f16_f32 v104, v80, v81
    v_cvt_pk_f16_f32 v105, v82, v83
    ds_write_b64 v26, v[104:105] offset:27744
    v_cvt_pk_f16_f32 v106, v64, v65
    v_cvt_pk_f16_f32 v107, -v66, -v67
    ds_write_b64 v26, v[106:107] offset:2720
    v_pk_mul_f32 v[96:97], v[82:83], v[70:71]
    v_pk_mul_f32 v[98:99], v[82:83], v[68:69]
    v_pk_fma_f32 v[82:83], v[80:81], v[70:71], v[98:99]
    v_pk_fma_f32 v[80:81], v[80:81], v[68:69], v[96:97] neg_lo:[0,0,1] neg_hi:[0,0,1]
    v_pk_mul_f32 v[100:101], v[66:67], v[78:79]
    v_pk_mul_f32 v[102:103], v[66:67], v[76:77]
    v_pk_fma_f32 v[86:87], v[64:65], v[78:79], v[102:103]
    v_pk_fma_f32 v[84:85], v[64:65], v[76:77], v[100:101] neg_lo:[0,0,1] neg_hi:[0,0,1]
    v_cvt_pk_f16_f32 v108, v80, v81
    v_cvt_pk_f16_f32 v109, v82, v83
    ds_write_b64 v26, v[108:109] offset:28288
    v_cvt_pk_f16_f32 v110, v84, v85
    v_cvt_pk_f16_f32 v111, -v86, -v87
    ds_write_b64 v26, v[110:111] offset:7072
    v_pk_mul_f32 v[92:93], v[82:83], v[70:71]
    v_pk_mul_f32 v[94:95], v[82:83], v[68:69]
    v_pk_fma_f32 v[82:83], v[80:81], v[70:71], v[94:95]
    v_pk_fma_f32 v[80:81], v[80:81], v[68:69], v[92:93] neg_lo:[0,0,1] neg_hi:[0,0,1]
    v_pk_mul_f32 v[96:97], v[66:67], v[74:75]
    v_pk_mul_f32 v[98:99], v[66:67], v[72:73]
    v_pk_fma_f32 v[66:67], v[64:65], v[74:75], v[98:99]
    v_pk_fma_f32 v[64:65], v[64:65], v[72:73], v[96:97] neg_lo:[0,0,1] neg_hi:[0,0,1]
    v_cvt_pk_f16_f32 v104, v80, v81
    v_cvt_pk_f16_f32 v105, v82, v83
    ds_write_b64 v26, v[104:105] offset:28832
    v_cvt_pk_f16_f32 v106, v64, v65
    v_cvt_pk_f16_f32 v107, -v66, -v67
    ds_write_b64 v26, v[106:107] offset:3264
    v_pk_mul_f32 v[100:101], v[82:83], v[70:71]
    v_pk_mul_f32 v[102:103], v[82:83], v[68:69]
    v_pk_fma_f32 v[82:83], v[80:81], v[70:71], v[102:103]
    v_pk_fma_f32 v[80:81], v[80:81], v[68:69], v[100:101] neg_lo:[0,0,1] neg_hi:[0,0,1]
    v_pk_mul_f32 v[92:93], v[66:67], v[78:79]
    v_pk_mul_f32 v[94:95], v[66:67], v[76:77]
    v_pk_fma_f32 v[86:87], v[64:65], v[78:79], v[94:95]
    v_pk_fma_f32 v[84:85], v[64:65], v[76:77], v[92:93] neg_lo:[0,0,1] neg_hi:[0,0,1]
    v_cvt_pk_f16_f32 v108, v80, v81
    v_cvt_pk_f16_f32 v109, v82, v83
    ds_write_b64 v26, v[108:109] offset:29376
    v_cvt_pk_f16_f32 v110, v84, v85
    v_cvt_pk_f16_f32 v111, -v86, -v87
    ds_write_b64 v26, v[110:111] offset:7616
    v_pk_mul_f32 v[96:97], v[82:83], v[70:71]
    v_pk_mul_f32 v[98:99], v[82:83], v[68:69]
    v_pk_fma_f32 v[82:83], v[80:81], v[70:71], v[98:99]
    v_pk_fma_f32 v[80:81], v[80:81], v[68:69], v[96:97] neg_lo:[0,0,1] neg_hi:[0,0,1]
    v_pk_mul_f32 v[100:101], v[66:67], v[74:75]
    v_pk_mul_f32 v[102:103], v[66:67], v[72:73]
    v_pk_fma_f32 v[66:67], v[64:65], v[74:75], v[102:103]
    v_pk_fma_f32 v[64:65], v[64:65], v[72:73], v[100:101] neg_lo:[0,0,1] neg_hi:[0,0,1]
    v_cvt_pk_f16_f32 v104, v80, v81
    v_cvt_pk_f16_f32 v105, v82, v83
    ds_write_b64 v26, v[104:105] offset:29920
    v_cvt_pk_f16_f32 v106, v64, v65
    v_cvt_pk_f16_f32 v107, -v66, -v67
    ds_write_b64 v26, v[106:107] offset:3808
    v_pk_mul_f32 v[92:93], v[82:83], v[70:71]
    v_pk_mul_f32 v[94:95], v[82:83], v[68:69]
    v_pk_fma_f32 v[82:83], v[80:81], v[70:71], v[94:95]
    v_pk_fma_f32 v[80:81], v[80:81], v[68:69], v[92:93] neg_lo:[0,0,1] neg_hi:[0,0,1]
    v_pk_mul_f32 v[96:97], v[66:67], v[78:79]
    v_pk_mul_f32 v[98:99], v[66:67], v[76:77]
    v_pk_fma_f32 v[86:87], v[64:65], v[78:79], v[98:99]
    v_pk_fma_f32 v[84:85], v[64:65], v[76:77], v[96:97] neg_lo:[0,0,1] neg_hi:[0,0,1]
    v_cvt_pk_f16_f32 v108, v80, v81
    v_cvt_pk_f16_f32 v109, v82, v83
    ds_write_b64 v26, v[108:109] offset:30464
    v_cvt_pk_f16_f32 v110, v84, v85
    v_cvt_pk_f16_f32 v111, -v86, -v87
    ds_write_b64 v26, v[110:111] offset:8160
    s_branch K12_TAB
K12_H1:
    v_mul_f32 v43, 0xc3000000, v56
    v_mul_f32 v45, 0x43000000, v58
    v_mul_f32 v44, 0xc3000000, v57
    v_mul_f32 v46, 0x43000000, v59
    v_exp_f32 v43, v43
    v_fract_f32 v45, v45
    v_exp_f32 v44, v44
    v_fract_f32 v46, v46
    v_fmac_f32 v45, 0x43000000, v60
    v_fmac_f32 v46, 0x43000000, v61
    v_cos_f32 v76, v45
    v_sin_f32 v78, v45
    v_cos_f32 v77, v46
    v_sin_f32 v79, v46
    v_mul_f32 v76, v76, v43
    v_mul_f32 v78, v78, v43
    v_mul_f32 v77, v77, v44
    v_mul_f32 v79, v79, v44
    v_mul_f32 v43, 0xc0000000, v56
    v_mul_f32 v45, 0x40000000, v58
    v_mul_f32 v44, 0xc0000000, v57
    v_mul_f32 v46, 0x40000000, v59
    v_exp_f32 v43, v43
    v_fract_f32 v45, v45
    v_exp_f32 v44, v44
    v_fract_f32 v46, v46
    v_fmac_f32 v45, 0x40000000, v60
    v_fmac_f32 v46, 0x40000000, v61
    v_cos_f32 v68, v45
    v_sin_f32 v70, v45
    v_cos_f32 v69, v46
    v_sin_f32 v71, v46
    v_mul_f32 v68, v68, v43
    v_mul_f32 v70, v70, v43
    v_mul_f32 v69, v69, v44
    v_mul_f32 v71, v71, v44
    v_mul_f32 v43, 0xc0800000, v56
    v_mul_f32 v45, 0x40800000, v58
    v_mul_f32 v44, 0xc0800000, v57
    v_mul_f32 v46, 0x40800000, v59
    v_exp_f32 v43, v43
    v_fract_f32 v45, v45
    v_exp_f32 v44, v44
    v_fract_f32 v46, v46
    v_fmac_f32 v45, 0x40800000, v60
    v_fmac_f32 v46, 0x40800000, v61
    v_cos_f32 v72, v45
    v_sin_f32 v74, v45
    v_cos_f32 v73, v46
    v_sin_f32 v75, v46
    v_mul_f32 v72, v72, v43
    v_mul_f32 v74, v74, v43
    v_mul_f32 v73, v73, v44
    v_mul_f32 v75, v75, v44
    v_pk_mul_f32 v[100:101], v[66:67], v[78:79]
    v_pk_mul_f32 v[102:103], v[66:67], v[76:77]
    v_pk_fma_f32 v[66:67], v[64:65], v[78:79], v[102:103]
    v_pk_fma_f32 v[64:65], v[64:65], v[76:77], v[100:101] neg_lo:[0,0,1] neg_hi:[0,0,1]
    v_pk_mul_f32 v[92:93], v[66:67], v[78:79]
    v_pk_mul_f32 v[94:95], v[66:67], v[76:77]
    v_pk_fma_f32 v[66:67], v[64:65], v[78:79], v[94:95]
    v_pk_fma_f32 v[64:65], v[64:65], v[76:77], v[92:93] neg_lo:[0,0,1] neg_hi:[0,0,1]
    v_cvt_pk_f16_f32 v104, v64, v65
    v_cvt_pk_f16_f32 v105, -v66, -v67
    ds_write_b64 v26, v[104:105] offset:8704
    v_pk_mul_f32 v[96:97], v[66:67], v[70:71]
    v_pk_mul_f32 v[98:99], v[66:67], v[68:69]
    v_pk_fma_f32 v[82:83], v[64:65], v[70:71], v[98:99]
    v_pk_fma_f32 v[80:81], v[64:65], v[68:69], v[96:97] neg_lo:[0,0,1] neg_hi:[0,0,1]
    v_pk_mul_f32 v[100:101], v[66:67], v[78:79]
    v_pk_mul_f32 v[102:103], v[66:67], v[76:77]
    v_pk_fma_f32 v[66:67], v[64:65], v[78:79], v[102:103]
    v_pk_fma_f32 v[64:65], v[64:65], v[76:77], v[100:101] neg_lo:[0,0,1] neg_hi:[0,0,1]
    v_cvt_pk_f16_f32 v106, v80, v81
    v_cvt_pk_f16_f32 v107, -v82, -v83
    ds_write_b64 v26, v[106:107] offset:9248
    v_cvt_pk_f16_f32 v108, v64, v65
    v_cvt_pk_f16_f32 v109, -v66, -v67
    ds_write_b64 v26, v[108:109] offset:10880
    v_pk_mul_f32 v[92:93], v[82:83], v[70:71]
    v_pk_mul_f32 v[94:95], v[82:83], v[68:69]
    v_pk_fma_f32 v[82:83], v[80:81], v[70:71], v[94:95]
    v_pk_fma_f32 v[80:81], v[80:81], v[68:69], v[92:93] neg_lo:[0,0,1] neg_hi:[0,0,1]
    v_pk_mul_f32 v[96:97], v[66:67], v[70:71]
    v_pk_mul_f32 v[98:99], v[66:67], v[68:69]
    v_pk_fma_f32 v[86:87], v[64:65], v[70:71], v[98:99]
    v_pk_fma_f32 v[84:85], v[64:65], v[68:69], v[96:97] neg_lo:[0,0,1] neg_hi:[0,0,1]
    v_pk_mul_f32 v[100:101], v[66:67], v[78:79]
    v_pk_mul_f32 v[102:103], v[66:67], v[76:77]
    v_pk_fma_f32 v[66:67], v[64:65], v[78:79], v[102:103]
    v_pk_fma_f32 v[64:65], v[64:65], v[76:77], v[100:101] neg_lo:[0,0,1] neg_hi:[0,0,1]
    v_cvt_pk_f16_f32 v110, v80, v81
    v_cvt_pk_f16_f32 v111, -v82, -v83
    ds_write_b64 v26, v[110:111] offset:9792
    v_cvt_pk_f16_f32 v104, v84, v85
    v_cvt_pk_f16_f32 v105, -v86, -v87
    ds_write_b64 v26, v[104:105] offset:11424
    v_cvt_pk_f16_f32 v106, v64, v65
    v_cvt_pk_f16_f32 v107, -v66, -v67
    ds_write_b64 v26, v[106:107] offset:13056
    v_pk_mul_f32 v[92:93], v[82:83], v[70:71]
    v_pk_mul_f32 v[94:95], v[82:83], v[68:69]
    v_pk_fma_f32 v[82:83], v[80:81], v[70:71], v[94:95]
    v_pk_fma_f32 v[80:81], v[80:81], v[68:69], v[92:93] neg_lo:[0,0,1] neg_hi:[0,0,1]
    v_pk_mul_f32 v[96:97], v[86:87], v[70:71]
    v_pk_mul_f32 v[98:99], v[86:87], v[68:69]
    v_pk_fma_f32 v[86:87], v[84:85], v[70:71], v[98:99]
    v_pk_fma_f32 v[84:85], v[84:85], v[68:69], v[96:97] neg_lo:[0,0,1] neg_hi:[0,0,1]
    v_cvt_pk_f16_f32 v108, v80, v81
    v_cvt_pk_f16_f32 v109, -v82, -v83
    ds_write_b64 v26, v[108:109] offset:10336
    v_cvt_pk_f16_f32 v110, v84, v85
    v_cvt_pk_f16_f32 v111, -v86, -v87
    ds_write_b64 v26, v[110:111] offset:11968
    v_pk_mul_f32 v[100:101], v[66:67], v[74:75]
    v_pk_mul_f32 v[102:103], v[66:67], v[72:73]
    v_pk_fma_f32 v[82:83], v[64:65], v[74:75], v[102:103]
    v_pk_fma_f32 v[80:81], v[64:65], v[72:73], v[100:101] neg_lo:[0,0,1] neg_hi:[0,0,1]
    v_pk_mul_f32 v[92:93], v[86:87], v[70:71]
    v_pk_mul_f32 v[94:95], v[86:87], v[68:69]
    v_pk_fma_f32 v[86:87], v[84:85], v[70:71], v[94:95]
    v_pk_fma_f32 v[84:85], v[84:85], v[68:69], v[92:93] neg_lo:[0,0,1] neg_hi:[0,0,1]
    v_pk_mul_f32 v[96:97], v[66:67], v[78:79]
    v_pk_mul_f32 v[98:99], v[66:67], v[76:77]
    v_pk_fma_f32 v[66:67], v[64:65], v[78:79], v[98:99]
    v_pk_fma_f32 v[64:65], v[64:65], v[76:77], v[96:97] neg_lo:[0,0,1] neg_hi:[0,0,1]
    v_cvt_pk_f16_f32 v104, v80, v81
    v_cvt_pk_f16_f32 v105, -v82, -v83
    ds_write_b64 v26, v[104:105] offset:13600
    v_cvt_pk_f16_f32 v106, v84, v85
    v_cvt_pk_f16_f32 v107, -v86, -v87
    ds_write_b64 v26, v[106:107] offset:12512
    v_cvt_pk_f16_f32 v108, v64, v65
    v_cvt_pk_f16_f32 v109, -v66, -v67
    ds_write_b64 v26, v[108:109] offset:14144
    v_pk_mul_f32 v[100:101], v[66:67], v[74:75]
    v_pk_mul_f32 v[102:103], v[66:67], v[72:73]
    v_pk_fma_f32 v[82:83], v[64:65], v[74:75], v[102:103]
    v_pk_fma_f32 v[80:81], v[64:65], v[72:73], v[100:101] neg_lo:[0,0,1] neg_hi:[0,0,1]
    v_pk_mul_f32 v[92:93], v[66:67], v[78:79]
    v_pk_mul_f32 v[94:95], v[66:67], v[76:77]
    v_pk_fma_f32 v[66:67], v[64:65], v[78:79], v[94:95]
    v_pk_fma_f32 v[64:65], v[64:65], v[76:77], v[92:93] neg_lo:[0,0,1] neg_hi:[0,0,1]
    v_cvt_pk_f16_f32 v110, v80, v81
    v_cvt_pk_f16_f32 v111, -v82, -v83
    ds_write_b64 v26, v[110:111] offset:14688
    v_cvt_pk_f16_f32 v104, v64, v65
    v_cvt_pk_f16_f32 v105, -v66, -v67
    ds_write_b64 v26, v[104:105] offset:15232
    v_pk_mul_f32 v[96:97], v[66:67], v[74:75]
    v_pk_mul_f32 v[98:99], v[66:67], v[72:73]
    v_pk_fma_f32 v[82:83], v[64:65], v[74:75], v[98:99]
    v_pk_fma_f32 v[80:81], v[64:65], v[72:73], v[96:97] neg_lo:[0,0,1] neg_hi:[0,0,1]
    v_pk_mul_f32 v[100:101], v[66:67], v[78:79]
    v_pk_mul_f32 v[102:103], v[66:67], v[76:77]
    v_pk_fma_f32 v[66:67], v[64:65], v[78:79], v[102:103]
    v_pk_fma_f32 v[64:65], v[64:65], v[76:77], v[100:101] neg_lo:[0,0,1] neg_hi:[0,0,1]
    v_cvt_pk_f16_f32 v106, v80, v81
    v_cvt_pk_f16_f32 v107, -v82, -v83
    ds_write_b64 v26, v[106:107] offset:15776
    v_cvt_pk_f16_f32 v108, v64, v65
    v_cvt_pk_f16_f32 v109, -v66, -v67
    ds_write_b64 v26, v[108:109] offset:16320
    v_pk_mul_f32 v[92:93], v[66:67], v[74:75]
    v_pk_mul_f32 v[94:95], v[66:67], v[72:73]
    v_pk_fma_f32 v[82:83], v[64:65], v[74:75], v[94:95]
    v_pk_fma_f32 v[80:81], v[64:65], v[72:73], v[92:93] neg_lo:[0,0,1] neg_hi:[0,0,1]
    v_pk_mul_f32 v[96:97], v[66:67], v[78:79]
    v_pk_mul_f32 v[98:99], v[66:67], v[76:77]
    v_pk_fma_f32 v[66:67], v[64:65], v[78:79], v[98:99]
    v_pk_fma_f32 v[64:65], v[64:65], v[76:77], v[96:97] neg_lo:[0,0,1] neg_hi:[0,0,1]
    v_cvt_pk_f16_f32 v110, v80, v81
    v_cvt_pk_f16_f32 v111, -v82, -v83
    ds_write_b64 v26, v[110:111] offset:16864
    v_cvt_pk_f16_f32 v104, v64, v65
    v_cvt_pk_f16_f32 v105, -v66, -v67
    ds_write_b64 v26, v[104:105] offset:17408
    v_pk_mul_f32 v[100:101], v[66:67], v[78:79]
    v_pk_mul_f32 v[102:103], v[66:67], v[76:77]
    v_pk_fma_f32 v[66:67], v[64:65], v[78:79], v[102:103]
    v_pk_fma_f32 v[64:65], v[64:65], v[76:77], v[100:101] neg_lo:[0,0,1] neg_hi:[0,0,1]
    v_cvt_pk_f16_f32 v106, v64, v65
    v_cvt_pk_f16_f32 v107, -v66, -v67
    ds_write_b64 v26, v[106:107] offset:17952
    v_pk_mul_f32 v[92:93], v[66:67], v[78:79]
    v_pk_mul_f32 v[94:95], v[66:67], v[76:77]
    v_pk_fma_f32 v[66:67], v[64:65], v[78:79], v[94:95]
    v_pk_fma_f32 v[64:65], v[64:65], v[76:77], v[92:93] neg_lo:[0,0,1] neg_hi:[0,0,1]
    v_cvt_pk_f16_f32 v108, v64, v65
    v_cvt_pk_f16_f32 v109, -v66, -v67
    ds_write_b64 v26, v[108:109] offset:18496
    v_pk_mul_f32 v[96:97], v[66:67], v[78:79]
    v_pk_mul_f32 v[98:99], v[66:67], v[76:77]
    v_pk_fma_f32 v[66:67], v[64:65], v[78:79], v[98:99]
    v_pk_fma_f32 v[64:65], v[64:65], v[76:77], v[96:97] neg_lo:[0,0,1] neg_hi:[0,0,1]
    v_cvt_pk_f16_f32 v110, v64, v65
    v_cvt_pk_f16_f32 v111, -v66, -v67
    ds_write_b64 v26, v[110:111] offset:19040
    v_pk_mul_f32 v[100:101], v[66:67], v[78:79]
    v_pk_mul_f32 v[102:103], v[66:67], v[76:77]
    v_pk_fma_f32 v[66:67], v[64:65], v[78:79], v[102:103]
    v_pk_fma_f32 v[64:65], v[64:65], v[76:77], v[100:101] neg_lo:[0,0,1] neg_hi:[0,0,1]
    v_cvt_pk_f16_f32 v104, v64, v65
    v_cvt_pk_f16_f32 v105, -v66, -v67
    ds_write_b64 v26, v[104:105] offset:19584
    v_pk_mul_f32 v[92:93], v[66:67], v[78:79]
    v_pk_mul_f32 v[94:95], v[66:67], v[76:77]
    v_pk_fma_f32 v[66:67], v[64:65], v[78:79], v[94:95]
    v_pk_fma_f32 v[64:65], v[64:65], v[76:77], v[92:93] neg_lo:[0,0,1] neg_hi:[0,0,1]
    v_cvt_pk_f16_f32 v106, v64, v65
    v_cvt_pk_f16_f32 v107, -v66, -v67
    ds_write_b64 v26, v[106:107] offset:20128
    v_pk_mul_f32 v[96:97], v[66:67], v[78:79]
    v_pk_mul_f32 v[98:99], v[66:67], v[76:77]
    v_pk_fma_f32 v[66:67], v[64:65], v[78:79], v[98:99]
    v_pk_fma_f32 v[64:65], v[64:65], v[76:77], v[96:97] neg_lo:[0,0,1] neg_hi:[0,0,1]
    v_cvt_pk_f16_f32 v108, v64, v65
    v_cvt_pk_f16_f32 v109, -v66, -v67
    ds_write_b64 v26, v[108:109] offset:20672
    v_pk_mul_f32 v[100:101], v[66:67], v[78:79]
    v_pk_mul_f32 v[102:103], v[66:67], v[76:77]
    v_pk_fma_f32 v[66:67], v[64:65], v[78:79], v[102:103]
    v_pk_fma_f32 v[64:65], v[64:65], v[76:77], v[100:101] neg_lo:[0,0,1] neg_hi:[0,0,1]
    v_cvt_pk_f16_f32 v110, v64, v65
    v_cvt_pk_f16_f32 v111, -v66, -v67
    ds_write_b64 v26, v[110:111] offset:21216
    v_pk_mul_f32 v[92:93], v[66:67], v[78:79]
    v_pk_mul_f32 v[94:95], v[66:67], v[76:77]
    v_pk_fma_f32 v[66:67], v[64:65], v[78:79], v[94:95]
    v_pk_fma_f32 v[64:65], v[64:65], v[76:77], v[92:93] neg_lo:[0,0,1] neg_hi:[0,0,1]
    v_cvt_pk_f16_f32 v104, v64, v65
    v_cvt_pk_f16_f32 v105, -v66, -v67
    ds_write_b64 v26, v[104:105] offset:21760
K12_TAB:
    s_mov_b64 exec, 1
    ds_add_u32 v18, v19 offset:0
    s_mov_b64 exec, -1
SY_1:
    ds_read_b32 v40, v18 offset:0
    s_waitcnt lgkmcnt(0)
    v_cmp_gt_u32 vcc, 2, v40
    s_cbranch_vccnz SY_1
    ds_read_b128 v[64:67], v27 offset:22304
    ds_read_b128 v[68:71], v27 offset:22368
    ds_read_b128 v[72:75], v27 offset:22432
    ds_read_b128 v[76:79], v27 offset:22496
    ds_read_b128 v[80:83], v27 offset:22560
    ds_read_b128 v[84:87], v27 offset:22624
    ds_read_b128 v[88:91], v27 offset:22688
    ds_read_b128 v[92:95], v27 offset:22752
    s_cmp_eq_u32 s22, 0
    s_cbranch_scc1 K12_T2
    ds_read_b128 v[96:99], v27 offset:0
    ds_read_b128 v[100:103], v27 offset:64
    ds_read_b128 v[104:107], v27 offset:128
    ds_read_b128 v[108:111], v27 offset:192
    ds_read_b128 v[112:115], v27 offset:256
    ds_read_b128 v[116:119], v27 offset:320
    ds_read_b128 v[120:123], v27 offset:384
    ds_read_b128 v[124:127], v27 offset:448
    ds_read_b128 v[128:131], v27 offset:8704
    ds_read_b128 v[132:135], v27 offset:8768
    ds_read_b128 v[136:139], v27 offset:8832
    ds_read_b128 v[140:143], v27 offset:8896
    ds_read_b128 v[144:147], v27 offset:8960
    ds_read_b128 v[148:151], v27 offset:9024
    ds_read_b128 v[152:155], v27 offset:9088
    ds_read_b128 v[156:159], v27 offset:9152
    v_lshrrev_b32 v32, 1, v4
    v_and_b32 v33, 1, v4
    v_lshlrev_b32 v34, 8, v32
    v_lshl_add_u32 v34, v33, 3, v34
    v_lshl_add_u32 v34, v3, 4, v34
    v_add_u32 v34, s28, v34
    v_sub_u32 v35, 3, v32
    v_lshlrev_b32 v35, v35, v3
    v_lshl_add_u32 v35, v4, 7, v35
    v_add_u32 v35, s28, v35
    v_mul_u32_u24 v36, 60, v32
    v_add3_u32 v36, v35, v36, 4
    s_waitcnt lgkmcnt(8)
    v_mfma_f32_16x16x32_f16 v[40:43], v[96:99], v[64:67], 0
    v_mfma_f32_16x16x32_f16 v[40:43], v[100:103], v[68:71], v[40:43]
    v_mfma_f32_16x16x32_f16 v[40:43], v[104:107], v[72:75], v[40:43]
    v_mfma_f32_16x16x32_f16 v[40:43], v[108:111], v[76:79], v[40:43]
    v_mfma_f32_16x16x32_f16 v[40:43], v[112:115], v[80:83], v[40:43]
    v_mfma_f32_16x16x32_f16 v[40:43], v[116:119], v[84:87], v[40:43]
    v_mfma_f32_16x16x32_f16 v[40:43], v[120:123], v[88:91], v[40:43]
    v_mfma_f32_16x16x32_f16 v[40:43], v[124:127], v[92:95], v[40:43]
    s_waitcnt lgkmcnt(0)
    v_mfma_f32_16x16x32_f16 v[44:47], v[128:131], v[64:67], 0
    v_mfma_f32_16x16x32_f16 v[44:47], v[132:135], v[68:71], v[44:47]
    v_mfma_f32_16x16x32_f16 v[44:47], v[136:139], v[72:75], v[44:47]
    v_mfma_f32_16x16x32_f16 v[44:47], v[140:143], v[76:79], v[44:47]
    v_mfma_f32_16x16x32_f16 v[44:47], v[144:147], v[80:83], v[44:47]
    v_mfma_f32_16x16x32_f16 v[44:47], v[148:151], v[84:87], v[44:47]
    v_mfma_f32_16x16x32_f16 v[44:47], v[152:155], v[88:91], v[44:47]
    v_mfma_f32_16x16x32_f16 v[44:47], v[156:159], v[92:95], v[44:47]
    v_cvt_pk_f16_f32 v48, v40, v41
    v_cvt_pk_f16_f32 v49, v42, v43
    ds_write_b64 v34, v[48:49]
    s_nop 4
    v_cvt_pk_f16_f32 v50, v44, v45
    v_cvt_pk_f16_f32 v51, v46, v47
    ds_write_b32 v35, v50 offset:512
    ds_write_b32 v36, v51 offset:512
    s_branch K12_EXP
K12_T2:
    ds_read_b128 v[96:99], v27 offset:17408
    ds_read_b128 v[100:103], v27 offset:17472
    ds_read_b128 v[104:107], v27 offset:17536
    ds_read_b128 v[108:111], v27 offset:17600
    ds_read_b128 v[112:115], v27 offset:17664
    ds_read_b128 v[116:119], v27 offset:17728
    ds_read_b128 v[120:123], v27 offset:17792
    ds_read_b128 v[124:127], v27 offset:17856
    v_lshlrev_b32 v34, 7, v4
    v_lshl_add_u32 v34, v3, 1, v34
    v_add_u32 v34, s28, v34
    s_waitcnt lgkmcnt(0)
    v_mfma_f32_16x16x32_f16 v[40:43], v[96:99], v[64:67], 0
    v_mfma_f32_16x16x32_f16 v[40:43], v[100:103], v[68:71], v[40:43]
    v_mfma_f32_16x16x32_f16 v[40:43], v[104:107], v[72:75], v[40:43]
    v_mfma_f32_16x16x32_f16 v[40:43], v[108:111], v[76:79], v[40:43]
    v_mfma_f32_16x16x32_f16 v[40:43], v[112:115], v[80:83], v[40:43]
    v_mfma_f32_16x16x32_f16 v[40:43], v[116:119], v[84:87], v[40:43]
    v_mfma_f32_16x16x32_f16 v[40:43], v[120:123], v[88:91], v[40:43]
    v_mfma_f32_16x16x32_f16 v[40:43], v[124:127], v[92:95], v[40:43]
    s_nop 7
    v_cvt_pk_f16_f32 v48, v40, v41
    v_cvt_pk_f16_f32 v49, v42, v43
    ds_write_b16 v34, v48 offset:1024
    ds_write_b16_d16_hi v34, v48 offset:1056
    ds_write_b16 v34, v49 offset:1088
    ds_write_b16_d16_hi v34, v49 offset:1120
K12_EXP:
    s_mov_b64 exec, 1
    ds_add_u32 v18, v19 offset:4
    s_mov_b64 exec, -1
SY_2:
    ds_read_b32 v40, v18 offset:4
    s_waitcnt lgkmcnt(0)
    v_cmp_gt_u32 vcc, 2, v40
    s_cbranch_vccnz SY_2
    ds_read_u16 v112, v176
    ds_read_u16 v113, v177
    ds_read_u16 v114, v178
    ds_read_u16 v115, v179
    ds_read_u16 v116, v180
    ds_read_u16 v117, v181
    ds_read_u16 v118, v182
    ds_read_u16 v119, v183
    ds_read_u16 v120, v184
    ds_read_u16 v121, v185
    ds_read_u16 v122, v186
    ds_read_u16 v124, v187
    ds_read_u16 v125, v188
    ds_read_u16 v126, v189
    ds_read_u16 v127, v190
    ds_read_u16 v128, v191
    ds_read_u16 v129, v192
    ds_read_u16 v130, v193
    ds_read_u16 v131, v194
    ds_read_u16 v132, v195
    ds_read_u16 v133, v196
    ds_read_u16 v134, v197
    s_waitcnt lgkmcnt(11)
    v_lshl_or_b32 v136, v113, 16, v112
    v_lshl_or_b32 v137, v115, 16, v114
    v_lshl_or_b32 v138, v117, 16, v116
    v_lshl_or_b32 v139, v119, 16, v118
    ds_write_b128 v21, v[136:139] offset:0
    v_lshl_or_b32 v140, v114, 16, v113
    v_lshl_or_b32 v141, v116, 16, v115
    v_lshl_or_b32 v142, v118, 16, v117
    v_lshl_or_b32 v143, v120, 16, v119
    ds_write_b128 v21, v[140:143] offset:4160
    v_lshl_or_b32 v144, v115, 16, v114
    v_lshl_or_b32 v145, v117, 16, v116
    v_lshl_or_b32 v146, v119, 16, v118
    v_lshl_or_b32 v147, v121, 16, v120
    ds_write_b128 v21, v[144:147] offset:8320
    v_lshl_or_b32 v148, v116, 16, v115
    v_lshl_or_b32 v149, v118, 16, v117
    v_lshl_or_b32 v150, v120, 16, v119
    v_lshl_or_b32 v151, v122, 16, v121
    ds_write_b128 v21, v[148:151] offset:12480
    s_waitcnt lgkmcnt(4)
    s_mov_b64 exec, 1
    ds_add_u32 v18, v19 offset:12
    s_mov_b64 exec, -1
    v_lshl_or_b32 v152, v125, 16, v124
    v_lshl_or_b32 v153, v127, 16, v126
    v_lshl_or_b32 v154, v129, 16, v128
    v_lshl_or_b32 v155, v131, 16, v130
    ds_write_b128 v21, v[152:155] offset:1024
    v_lshl_or_b32 v156, v126, 16, v125
    v_lshl_or_b32 v157, v128, 16, v127
    v_lshl_or_b32 v158, v130, 16, v129
    v_lshl_or_b32 v159, v132, 16, v131
    ds_write_b128 v21, v[156:159] offset:5184
    v_lshl_or_b32 v160, v127, 16, v126
    v_lshl_or_b32 v161, v129, 16, v128
    v_lshl_or_b32 v162, v131, 16, v130
    v_lshl_or_b32 v163, v133, 16, v132
    ds_write_b128 v21, v[160:163] offset:9344
    v_lshl_or_b32 v164, v128, 16, v127
    v_lshl_or_b32 v165, v130, 16, v129
    v_lshl_or_b32 v166, v132, 16, v131
    v_lshl_or_b32 v167, v134, 16, v133
    ds_write_b128 v21, v[164:167] offset:13504
    s_waitcnt lgkmcnt(0)
    s_waitcnt vmcnt(0)
    s_barrier
    ds_read_b128 v[100:103], v12 offset:384
    ds_read_b64 v[72:73], v13 offset:384
    ds_read_b64 v[74:75], v13 offset:392
    ds_read_b128 v[96:99], v12 offset:256
    ds_read_b64 v[76:77], v13 offset:256
    ds_read_b64 v[78:79], v13 offset:264
    ds_read_b128 v[92:95], v12 offset:128
    ds_read_b64 v[80:81], v13 offset:128
    ds_read_b64 v[82:83], v13 offset:136
    ds_read_b128 v[88:91], v12 offset:0
    ds_read_b64 v[84:85], v13 offset:0
    ds_read_b64 v[86:87], v13 offset:8
    s_waitcnt lgkmcnt(9)
    v_mfma_f32_16x16x32_f16 v[52:55], v[72:75], v[100:103], 0
    ds_read_b128 v[116:119], v12 offset:896
    ds_read_b64 v[56:57], v13 offset:896
    ds_read_b64 v[58:59], v13 offset:904
    s_waitcnt lgkmcnt(9)
    v_mfma_f32_16x16x32_f16 v[52:55], v[76:79], v[96:99], v[52:55]
    ds_read_b128 v[112:115], v12 offset:768
    ds_read_b64 v[60:61], v13 offset:768
    ds_read_b64 v[62:63], v13 offset:776
    s_waitcnt lgkmcnt(9)
    v_mfma_f32_16x16x32_f16 v[52:55], v[80:83], v[92:95], v[52:55]
    ds_read_b128 v[108:111], v12 offset:640
    ds_read_b64 v[64:65], v13 offset:640
    ds_read_b64 v[66:67], v13 offset:648
    s_waitcnt lgkmcnt(9)
    v_mfma_f32_16x16x32_f16 v[52:55], v[84:87], v[88:91], v[52:55]
    ds_read_b128 v[104:107], v12 offset:512
    ds_read_b64 v[68:69], v13 offset:512
    ds_read_b64 v[70:71], v13 offset:520
    s_waitcnt lgkmcnt(9)
    v_mfma_f32_16x16x32_f16 v[52:55], v[56:59], v[116:119], v[52:55]
    ds_read_b128 v[132:135], v12 offset:1408
    ds_read_b64 v[72:73], v13 offset:1408
    v_mfma_f32_16x16x32_f16 v[48:51], v[56:59], v[100:103], 0
    ds_read_b64 v[74:75], v13 offset:1416
    s_waitcnt lgkmcnt(9)
    v_mfma_f32_16x16x32_f16 v[52:55], v[60:63], v[112:115], v[52:55]
    ds_read_b128 v[128:131], v12 offset:1280
    ds_read_b64 v[76:77], v13 offset:1280
    v_mfma_f32_16x16x32_f16 v[48:51], v[60:63], v[96:99], v[48:51]
    ds_read_b64 v[78:79], v13 offset:1288
    s_waitcnt lgkmcnt(9)
    v_mfma_f32_16x16x32_f16 v[52:55], v[64:67], v[108:111], v[52:55]
    ds_read_b128 v[124:127], v12 offset:1152
    ds_read_b64 v[80:81], v13 offset:1152
    v_mfma_f32_16x16x32_f16 v[48:51], v[64:67], v[92:95], v[48:51]
    ds_read_b64 v[82:83], v13 offset:1160
    s_waitcnt lgkmcnt(9)
    v_mfma_f32_16x16x32_f16 v[52:55], v[68:71], v[104:107], v[52:55]
    ds_read_b128 v[120:123], v12 offset:1024
    ds_read_b64 v[84:85], v13 offset:1024
    v_mfma_f32_16x16x32_f16 v[48:51], v[68:71], v[88:91], v[48:51]
    ds_read_b64 v[86:87], v13 offset:1032
    s_waitcnt lgkmcnt(9)
    v_mfma_f32_16x16x32_f16 v[52:55], v[72:75], v[132:135], v[52:55]
    ds_read_b128 v[148:151], v12 offset:1920
    v_mfma_f32_16x16x32_f16 v[48:51], v[72:75], v[116:119], v[48:51]
    ds_read_b64 v[56:57], v13 offset:1920
    v_mfma_f32_16x16x32_f16 v[44:47], v[72:75], v[100:103], 0
    ds_read_b64 v[58:59], v13 offset:1928
    s_waitcnt lgkmcnt(9)
    v_mfma_f32_16x16x32_f16 v[52:55], v[76:79], v[128:131], v[52:55]
    ds_read_b128 v[144:147], v12 offset:1792
    v_mfma_f32_16x16x32_f16 v[48:51], v[76:79], v[112:115], v[48:51]
    ds_read_b64 v[60:61], v13 offset:1792
    v_mfma_f32_16x16x32_f16 v[44:47], v[76:79], v[96:99], v[44:47]
    ds_read_b64 v[62:63], v13 offset:1800
    s_waitcnt lgkmcnt(9)
    v_mfma_f32_16x16x32_f16 v[52:55], v[80:83], v[124:127], v[52:55]
    ds_read_b128 v[140:143], v12 offset:1664
    v_mfma_f32_16x16x32_f16 v[48:51], v[80:83], v[108:111], v[48:51]
    ds_read_b64 v[64:65], v13 offset:1664
    v_mfma_f32_16x16x32_f16 v[44:47], v[80:83], v[92:95], v[44:47]
    ds_read_b64 v[66:67], v13 offset:1672
    s_waitcnt lgkmcnt(9)
    v_mfma_f32_16x16x32_f16 v[52:55], v[84:87], v[120:123], v[52:55]
    ds_read_b128 v[136:139], v12 offset:1536
    v_mfma_f32_16x16x32_f16 v[48:51], v[84:87], v[104:107], v[48:51]
    ds_read_b64 v[68:69], v13 offset:1536
    v_mfma_f32_16x16x32_f16 v[44:47], v[84:87], v[88:91], v[44:47]
    ds_read_b64 v[70:71], v13 offset:1544
    s_waitcnt lgkmcnt(9)
    v_mfma_f32_16x16x32_f16 v[52:55], v[56:59], v[148:151], v[52:55]
    ds_read_b128 v[164:167], v12 offset:2432
    v_mfma_f32_16x16x32_f16 v[48:51], v[56:59], v[132:135], v[48:51]
    ds_read_b64 v[72:73], v13 offset:2432
    v_mfma_f32_16x16x32_f16 v[44:47], v[56:59], v[116:119], v[44:47]
    ds_read_b64 v[74:75], v13 offset:2440
    v_mfma_f32_16x16x32_f16 v[40:43], v[56:59], v[100:103], 0
    ds_read_b128 v[160:163], v12 offset:2304
    s_waitcnt lgkmcnt(10)
    v_mfma_f32_16x16x32_f16 v[52:55], v[60:63], v[144:147], v[52:55]
    ds_read_b64 v[76:77], v13 offset:2304
    v_mfma_f32_16x16x32_f16 v[48:51], v[60:63], v[128:131], v[48:51]
    ds_read_b64 v[78:79], v13 offset:2312
    v_mfma_f32_16x16x32_f16 v[44:47], v[60:63], v[112:115], v[44:47]
    ds_read_b128 v[156:159], v12 offset:2176
    v_mfma_f32_16x16x32_f16 v[40:43], v[60:63], v[96:99], v[40:43]
    ds_read_b64 v[80:81], v13 offset:2176
    s_waitcnt lgkmcnt(11)
    v_mfma_f32_16x16x32_f16 v[52:55], v[64:67], v[140:143], v[52:55]
    ds_read_b64 v[82:83], v13 offset:2184
    v_mfma_f32_16x16x32_f16 v[48:51], v[64:67], v[124:127], v[48:51]
    ds_read_b128 v[152:155], v12 offset:2048
    v_mfma_f32_16x16x32_f16 v[44:47], v[64:67], v[108:111], v[44:47]
    ds_read_b64 v[84:85], v13 offset:2048
    v_mfma_f32_16x16x32_f16 v[40:43], v[64:67], v[92:95], v[40:43]
    ds_read_b64 v[86:87], v13 offset:2056
    s_waitcnt lgkmcnt(12)
    v_mfma_f32_16x16x32_f16 v[52:55], v[68:71], v[136:139], v[52:55]
    ds_read_b64 v[216:217], v15 offset:0
    v_mfma_f32_16x16x32_f16 v[48:51], v[68:71], v[120:123], v[48:51]
    ds_read_b64 v[218:219], v15 offset:512
    v_mfma_f32_16x16x32_f16 v[44:47], v[68:71], v[104:107], v[44:47]
    ds_read_b64 v[220:221], v15 offset:1024
    v_mfma_f32_16x16x32_f16 v[40:43], v[68:71], v[88:91], v[40:43]
    ds_read_b64 v[222:223], v15 offset:1536
    s_waitcnt lgkmcnt(13)
    v_mfma_f32_16x16x32_f16 v[52:55], v[72:75], v[164:167], v[52:55]
    ds_read_b128 v[180:183], v12 offset:2944
    v_mfma_f32_16x16x32_f16 v[48:51], v[72:75], v[148:151], v[48:51]
    ds_read_b64 v[56:57], v13 offset:2944
    v_mfma_f32_16x16x32_f16 v[44:47], v[72:75], v[132:135], v[44:47]
    ds_read_b64 v[58:59], v13 offset:2952
    v_mfma_f32_16x16x32_f16 v[40:43], v[72:75], v[116:119], v[40:43]
    ds_read_b128 v[176:179], v12 offset:2816
    v_mfma_f32_16x16x32_f16 v[36:39], v[72:75], v[100:103], 0
    s_waitcnt lgkmcnt(14)
    v_mfma_f32_16x16x32_f16 v[52:55], v[76:79], v[160:163], v[52:55]
    ds_read_b64 v[60:61], v13 offset:2816
    v_mfma_f32_16x16x32_f16 v[48:51], v[76:79], v[144:147], v[48:51]
    ds_read_b64 v[62:63], v13 offset:2824
    v_mfma_f32_16x16x32_f16 v[44:47], v[76:79], v[128:131], v[44:47]
    ds_read_b128 v[172:175], v12 offset:2688
    v_mfma_f32_16x16x32_f16 v[40:43], v[76:79], v[112:115], v[40:43]
    ds_read_b64 v[64:65], v13 offset:2688
    v_mfma_f32_16x16x32_f16 v[36:39], v[76:79], v[96:99], v[36:39]
    s_waitcnt lgkmcnt(15)
    v_mfma_f32_16x16x32_f16 v[52:55], v[80:83], v[156:159], v[52:55]
    ds_read_b64 v[66:67], v13 offset:2696
    v_mfma_f32_16x16x32_f16 v[48:51], v[80:83], v[140:143], v[48:51]
    ds_read_b128 v[168:171], v12 offset:2560
    v_mfma_f32_16x16x32_f16 v[44:47], v[80:83], v[124:127], v[44:47]
    ds_read_b64 v[68:69], v13 offset:2560
    v_mfma_f32_16x16x32_f16 v[40:43], v[80:83], v[108:111], v[40:43]
    ds_read_b64 v[70:71], v13 offset:2568
    v_mfma_f32_16x16x32_f16 v[36:39], v[80:83], v[92:95], v[36:39]
    s_waitcnt lgkmcnt(15)
    v_mfma_f32_16x16x32_f16 v[52:55], v[84:87], v[152:155], v[52:55]
    ds_read_b64 v[232:233], v15 offset:4160
    v_mfma_f32_16x16x32_f16 v[48:51], v[84:87], v[136:139], v[48:51]
    ds_read_b64 v[234:235], v15 offset:4672
    v_mfma_f32_16x16x32_f16 v[44:47], v[84:87], v[120:123], v[44:47]
    ds_read_b64 v[236:237], v15 offset:5184
    v_mfma_f32_16x16x32_f16 v[40:43], v[84:87], v[104:107], v[40:43]
    ds_read_b64 v[238:239], v15 offset:5696
    v_mfma_f32_16x16x32_f16 v[36:39], v[84:87], v[88:91], v[36:39]
    s_waitcnt lgkmcnt(13)
    v_mfma_f32_16x16x32_f16 v[52:55], v[56:59], v[180:183], v[52:55]
    ds_read_b128 v[196:199], v12 offset:3456
    v_cvt_f32_f16 v224, v216
    v_mfma_f32_16x16x32_f16 v[48:51], v[56:59], v[164:167], v[48:51]
    v_cvt_f32_f16_sdwa v225, v216 dst_sel:DWORD dst_unused:UNUSED_PAD src0_sel:WORD_1
    v_mfma_f32_16x16x32_f16 v[44:47], v[56:59], v[148:151], v[44:47]
    ds_read_b64 v[72:73], v13 offset:3456
    v_mul_f32 v224, v20, v224
    v_mfma_f32_16x16x32_f16 v[40:43], v[56:59], v[132:135], v[40:43]
    v_mul_f32 v225, v20, v225
    v_mfma_f32_16x16x32_f16 v[36:39], v[56:59], v[116:119], v[36:39]
    ds_read_b64 v[74:75], v13 offset:3464
    v_cvt_pk_bf16_f32 v240, v224, v225
    v_mfma_f32_16x16x32_f16 v[32:35], v[56:59], v[100:103], 0
    v_cvt_f32_f16 v224, v217
    s_waitcnt lgkmcnt(13)
    v_mfma_f32_16x16x32_f16 v[52:55], v[60:63], v[176:179], v[52:55]
    ds_read_b128 v[192:195], v12 offset:3328
    v_cvt_f32_f16_sdwa v225, v217 dst_sel:DWORD dst_unused:UNUSED_PAD src0_sel:WORD_1
    v_mfma_f32_16x16x32_f16 v[48:51], v[60:63], v[160:163], v[48:51]
    v_mul_f32 v224, v20, v224
    v_mfma_f32_16x16x32_f16 v[44:47], v[60:63], v[144:147], v[44:47]
    ds_read_b64 v[76:77], v13 offset:3328
    v_mul_f32 v225, v20, v225
    v_mfma_f32_16x16x32_f16 v[40:43], v[60:63], v[128:131], v[40:43]
    v_cvt_pk_bf16_f32 v241, v224, v225
    v_mfma_f32_16x16x32_f16 v[36:39], v[60:63], v[112:115], v[36:39]
    ds_read_b64 v[78:79], v13 offset:3336
    v_cvt_f32_f16 v224, v218
    v_mfma_f32_16x16x32_f16 v[32:35], v[60:63], v[96:99], v[32:35]
    v_cvt_f32_f16_sdwa v225, v218 dst_sel:DWORD dst_unused:UNUSED_PAD src0_sel:WORD_1
    s_waitcnt lgkmcnt(13)
    v_mfma_f32_16x16x32_f16 v[52:55], v[64:67], v[172:175], v[52:55]
    ds_read_b128 v[188:191], v12 offset:3200
    v_mul_f32 v224, v20, v224
    v_mfma_f32_16x16x32_f16 v[48:51], v[64:67], v[156:159], v[48:51]
    v_mul_f32 v225, v20, v225
    v_mfma_f32_16x16x32_f16 v[44:47], v[64:67], v[140:143], v[44:47]
    ds_read_b64 v[80:81], v13 offset:3200
    v_cvt_pk_bf16_f32 v242, v224, v225
    v_mfma_f32_16x16x32_f16 v[40:43], v[64:67], v[124:127], v[40:43]
    v_cvt_f32_f16 v224, v219
    v_mfma_f32_16x16x32_f16 v[36:39], v[64:67], v[108:111], v[36:39]
    ds_read_b64 v[82:83], v13 offset:3208
    v_cvt_f32_f16_sdwa v225, v219 dst_sel:DWORD dst_unused:UNUSED_PAD src0_sel:WORD_1
    v_mfma_f32_16x16x32_f16 v[32:35], v[64:67], v[92:95], v[32:35]
    v_mul_f32 v224, v20, v224
    s_waitcnt lgkmcnt(13)
    v_mfma_f32_16x16x32_f16 v[52:55], v[68:71], v[168:171], v[52:55]
    ds_read_b128 v[184:187], v12 offset:3072
    v_mul_f32 v225, v20, v225
    v_mfma_f32_16x16x32_f16 v[48:51], v[68:71], v[152:155], v[48:51]
    v_cvt_pk_bf16_f32 v243, v224, v225
    v_mfma_f32_16x16x32_f16 v[44:47], v[68:71], v[136:139], v[44:47]
    ds_read_b64 v[84:85], v13 offset:3072
    v_cvt_f32_f16 v224, v220
    v_mfma_f32_16x16x32_f16 v[40:43], v[68:71], v[120:123], v[40:43]
    v_cvt_f32_f16_sdwa v225, v220 dst_sel:DWORD dst_unused:UNUSED_PAD src0_sel:WORD_1
    v_mfma_f32_16x16x32_f16 v[36:39], v[68:71], v[104:107], v[36:39]
    ds_read_b64 v[86:87], v13 offset:3080
    v_mul_f32 v224, v20, v224
    v_mfma_f32_16x16x32_f16 v[32:35], v[68:71], v[88:91], v[32:35]
    v_mul_f32 v225, v20, v225
    s_waitcnt lgkmcnt(9)
    v_mfma_f32_16x16x32_f16 v[52:55], v[72:75], v[196:199], v[52:55]
    ds_read_b128 v[212:215], v12 offset:3968
    v_cvt_pk_bf16_f32 v244, v224, v225
    v_mfma_f32_16x16x32_f16 v[48:51], v[72:75], v[180:183], v[48:51]
    v_cvt_f32_f16 v224, v221
    v_mfma_f32_16x16x32_f16 v[44:47], v[72:75], v[164:167], v[44:47]
    ds_read_b64 v[56:57], v13 offset:3968
    v_cvt_f32_f16_sdwa v225, v221 dst_sel:DWORD dst_unused:UNUSED_PAD src0_sel:WORD_1
    v_mfma_f32_16x16x32_f16 v[40:43], v[72:75], v[148:151], v[40:43]
    v_mul_f32 v224, v20, v224
    v_mfma_f32_16x16x32_f16 v[36:39], v[72:75], v[132:135], v[36:39]
    ds_read_b64 v[58:59], v13 offset:3976
    v_mul_f32 v225, v20, v225
    v_mfma_f32_16x16x32_f16 v[32:35], v[72:75], v[116:119], v[32:35]
    v_cvt_pk_bf16_f32 v245, v224, v225
    v_mfma_f32_16x16x32_f16 v[28:31], v[72:75], v[100:103], 0
    v_cvt_f32_f16 v224, v222
    s_waitcnt lgkmcnt(9)
    v_mfma_f32_16x16x32_f16 v[52:55], v[76:79], v[192:195], v[52:55]
    ds_read_b128 v[208:211], v12 offset:3840
    v_cvt_f32_f16_sdwa v225, v222 dst_sel:DWORD dst_unused:UNUSED_PAD src0_sel:WORD_1
    v_mfma_f32_16x16x32_f16 v[48:51], v[76:79], v[176:179], v[48:51]
    v_mul_f32 v224, v20, v224
    v_mfma_f32_16x16x32_f16 v[44:47], v[76:79], v[160:163], v[44:47]
    ds_read_b64 v[60:61], v13 offset:3840
    v_mul_f32 v225, v20, v225
    v_mfma_f32_16x16x32_f16 v[40:43], v[76:79], v[144:147], v[40:43]
    v_cvt_pk_bf16_f32 v246, v224, v225
    v_mfma_f32_16x16x32_f16 v[36:39], v[76:79], v[128:131], v[36:39]
    ds_read_b64 v[62:63], v13 offset:3848
    v_cvt_f32_f16 v224, v223
    v_mfma_f32_16x16x32_f16 v[32:35], v[76:79], v[112:115], v[32:35]
    v_cvt_f32_f16_sdwa v225, v223 dst_sel:DWORD dst_unused:UNUSED_PAD src0_sel:WORD_1
    v_mfma_f32_16x16x32_f16 v[28:31], v[76:79], v[96:99], v[28:31]
    v_mul_f32 v224, v20, v224
    s_waitcnt lgkmcnt(9)
    v_mfma_f32_16x16x32_f16 v[52:55], v[80:83], v[188:191], v[52:55]
    ds_read_b128 v[204:207], v12 offset:3712
    v_mul_f32 v225, v20, v225
    v_mfma_f32_16x16x32_f16 v[48:51], v[80:83], v[172:175], v[48:51]
    v_cvt_pk_bf16_f32 v247, v224, v225
    v_mfma_f32_16x16x32_f16 v[44:47], v[80:83], v[156:159], v[44:47]
    ds_read_b64 v[64:65], v13 offset:3712
    v_mfma_f32_16x16x32_f16 v[40:43], v[80:83], v[140:143], v[40:43]
    v_mfma_f32_16x16x32_f16 v[36:39], v[80:83], v[124:127], v[36:39]
    ds_read_b64 v[66:67], v13 offset:3720
    v_mfma_f32_16x16x32_f16 v[32:35], v[80:83], v[108:111], v[32:35]
    v_mfma_f32_16x16x32_f16 v[28:31], v[80:83], v[92:95], v[28:31]
    s_waitcnt lgkmcnt(9)
    v_mfma_f32_16x16x32_f16 v[52:55], v[84:87], v[184:187], v[52:55]
    ds_read_b128 v[200:203], v12 offset:3584
    v_mfma_f32_16x16x32_f16 v[48:51], v[84:87], v[168:171], v[48:51]
    v_mfma_f32_16x16x32_f16 v[44:47], v[84:87], v[152:155], v[44:47]
    ds_read_b64 v[68:69], v13 offset:3584
    v_mfma_f32_16x16x32_f16 v[40:43], v[84:87], v[136:139], v[40:43]
    v_mfma_f32_16x16x32_f16 v[36:39], v[84:87], v[120:123], v[36:39]
    ds_read_b64 v[70:71], v13 offset:3592
    v_mfma_f32_16x16x32_f16 v[32:35], v[84:87], v[104:107], v[32:35]
    v_mfma_f32_16x16x32_f16 v[28:31], v[84:87], v[88:91], v[28:31]
    s_cmp_eq_u32 s22, 1
    s_cbranch_scc1 K12_X1
    s_waitcnt lgkmcnt(9)
    v_mfma_f32_16x16x32_f16 v[40:43], v[56:59], v[164:167], v[40:43]
    v_mfma_f32_16x16x32_f16 v[44:47], v[56:59], v[180:183], v[44:47]
    v_mfma_f32_16x16x32_f16 v[48:51], v[56:59], v[196:199], v[48:51]
    v_mfma_f32_16x16x32_f16 v[52:55], v[56:59], v[212:215], v[52:55]
    s_waitcnt lgkmcnt(6)
    v_mfma_f32_16x16x32_f16 v[40:43], v[60:63], v[160:163], v[40:43]
    v_mfma_f32_16x16x32_f16 v[44:47], v[60:63], v[176:179], v[44:47]
    v_mfma_f32_16x16x32_f16 v[48:51], v[60:63], v[192:195], v[48:51]
    v_mfma_f32_16x16x32_f16 v[52:55], v[60:63], v[208:211], v[52:55]
    s_waitcnt lgkmcnt(3)
    v_mfma_f32_16x16x32_f16 v[40:43], v[64:67], v[156:159], v[40:43]
    v_mfma_f32_16x16x32_f16 v[44:47], v[64:67], v[172:175], v[44:47]
    v_mfma_f32_16x16x32_f16 v[48:51], v[64:67], v[188:191], v[48:51]
    v_mfma_f32_16x16x32_f16 v[52:55], v[64:67], v[204:207], v[52:55]
    s_waitcnt lgkmcnt(0)
    v_mfma_f32_16x16x32_f16 v[40:43], v[68:71], v[152:155], v[40:43]
    v_mfma_f32_16x16x32_f16 v[44:47], v[68:71], v[168:171], v[44:47]
    v_mfma_f32_16x16x32_f16 v[48:51], v[68:71], v[184:187], v[48:51]
    v_mfma_f32_16x16x32_f16 v[52:55], v[68:71], v[200:203], v[52:55]
    v_mfma_f32_16x16x32_f16 v[24:27], v[56:59], v[100:103], 0
    v_lshlrev_b32 v152, 16, v240
    v_and_b32 v153, s36, v240
    v_mfma_f32_16x16x32_f16 v[28:31], v[56:59], v[116:119], v[28:31]
    s_nop 0
    ds_write_b128 v16, v[40:43] offset:0
    v_lshlrev_b32 v168, 16, v232
    v_and_b32 v169, s36, v232
    v_mfma_f32_16x16x32_f16 v[32:35], v[56:59], v[132:135], v[32:35]
    ds_write_b128 v16, v[44:47] offset:1024
    v_lshlrev_b32 v154, 16, v241
    v_and_b32 v155, s36, v241
    v_mfma_f32_16x16x32_f16 v[36:39], v[56:59], v[148:151], v[36:39]
    ds_write_b128 v16, v[48:51] offset:2048
    v_lshlrev_b32 v170, 16, v233
    v_and_b32 v171, s36, v233
    v_mfma_f32_16x16x32_f16 v[24:27], v[60:63], v[96:99], v[24:27]
    ds_write_b128 v16, v[52:55] offset:3072
    s_mov_b64 exec, 1
    ds_add_u32 v18, v19 offset:8
    s_mov_b64 exec, -1
    s_memrealtime s[6:7]
    v_lshlrev_b32 v156, 16, v242
    v_and_b32 v157, s36, v242
    v_mfma_f32_16x16x32_f16 v[28:31], v[60:63], v[112:115], v[28:31]
    v_lshlrev_b32 v172, 16, v234
    v_and_b32 v173, s36, v234
    v_mfma_f32_16x16x32_f16 v[32:35], v[60:63], v[128:131], v[32:35]
    v_lshlrev_b32 v158, 16, v243
    v_and_b32 v159, s36, v243
    v_mfma_f32_16x16x32_f16 v[36:39], v[60:63], v[144:147], v[36:39]
    v_lshlrev_b32 v174, 16, v235
    v_and_b32 v175, s36, v235
    v_mfma_f32_16x16x32_f16 v[24:27], v[64:67], v[92:95], v[24:27]
    v_lshlrev_b32 v160, 16, v244
    v_and_b32 v161, s36, v244
    v_mfma_f32_16x16x32_f16 v[28:31], v[64:67], v[108:111], v[28:31]
    v_lshlrev_b32 v176, 16, v236
    v_and_b32 v177, s36, v236
    v_mfma_f32_16x16x32_f16 v[32:35], v[64:67], v[124:127], v[32:35]
    v_lshlrev_b32 v162, 16, v245
    v_and_b32 v163, s36, v245
    v_mfma_f32_16x16x32_f16 v[36:39], v[64:67], v[140:143], v[36:39]
    v_lshlrev_b32 v178, 16, v237
    v_and_b32 v179, s36, v237
    v_mfma_f32_16x16x32_f16 v[24:27], v[68:71], v[88:91], v[24:27]
    v_lshlrev_b32 v164, 16, v246
    v_and_b32 v165, s36, v246
    v_mfma_f32_16x16x32_f16 v[28:31], v[68:71], v[104:107], v[28:31]
    v_lshlrev_b32 v180, 16, v238
    v_and_b32 v181, s36, v238
    v_mfma_f32_16x16x32_f16 v[32:35], v[68:71], v[120:123], v[32:35]
    v_lshlrev_b32 v166, 16, v247
    v_and_b32 v167, s36, v247
    v_mfma_f32_16x16x32_f16 v[36:39], v[68:71], v[136:139], v[36:39]
    v_lshlrev_b32 v182, 16, v239
    v_and_b32 v183, s36, v239
XW_3:
    ds_read_b32 v224, v18 offset:8
    ds_read_b128 v[72:75], v17 offset:0
    ds_read_b128 v[76:79], v17 offset:1024
    ds_read_b128 v[80:83], v17 offset:2048
    ds_read_b128 v[84:87], v17 offset:3072
    s_waitcnt lgkmcnt(0)
    v_cmp_gt_u32 vcc, 2, v224
    s_cbranch_vccnz XW_3
    v_pk_add_f32 v[72:73], v[72:73], v[24:25]
    v_pk_add_f32 v[74:75], v[74:75], v[26:27]
    v_pk_add_f32 v[76:77], v[76:77], v[28:29]
    v_pk_add_f32 v[78:79], v[78:79], v[30:31]
    v_pk_add_f32 v[80:81], v[80:81], v[32:33]
    v_pk_add_f32 v[82:83], v[82:83], v[34:35]
    v_pk_add_f32 v[84:85], v[84:85], v[36:37]
    v_pk_add_f32 v[86:87], v[86:87], v[38:39]
    v_pk_mul_f32 v[72:73], v[72:73], v[22:23] op_sel_hi:[1,0]
    v_pk_mul_f32 v[74:75], v[74:75], v[22:23] op_sel_hi:[1,0]
    v_pk_mul_f32 v[76:77], v[76:77], v[22:23] op_sel_hi:[1,0]
    v_pk_mul_f32 v[78:79], v[78:79], v[22:23] op_sel_hi:[1,0]
    v_pk_mul_f32 v[80:81], v[80:81], v[22:23] op_sel_hi:[1,0]
    v_pk_mul_f32 v[82:83], v[82:83], v[22:23] op_sel_hi:[1,0]
    v_pk_mul_f32 v[84:85], v[84:85], v[22:23] op_sel_hi:[1,0]
    v_pk_mul_f32 v[86:87], v[86:87], v[22:23] op_sel_hi:[1,0]
    v_cvt_pk_bf16_f32 v24, v72, v73
    v_cvt_pk_bf16_f32 v25, v74, v75
    v_cvt_pk_bf16_f32 v26, v76, v77
    v_cvt_pk_bf16_f32 v27, v78, v79
    v_cvt_pk_bf16_f32 v28, v80, v81
    v_cvt_pk_bf16_f32 v29, v82, v83
    v_cvt_pk_bf16_f32 v30, v84, v85
    v_cvt_pk_bf16_f32 v31, v86, v87
    v_lshlrev_b32 v72, 16, v24
    v_and_b32 v73, s36, v24
    v_lshlrev_b32 v74, 16, v25
    v_and_b32 v75, s36, v25
    v_lshlrev_b32 v76, 16, v26
    v_and_b32 v77, s36, v26
    v_lshlrev_b32 v78, 16, v27
    v_and_b32 v79, s36, v27
    v_lshlrev_b32 v80, 16, v28
    v_and_b32 v81, s36, v28
    v_lshlrev_b32 v82, 16, v29
    v_and_b32 v83, s36, v29
    v_lshlrev_b32 v84, 16, v30
    v_and_b32 v85, s36, v30
    v_lshlrev_b32 v86, 16, v31
    v_and_b32 v87, s36, v31
    v_pk_add_f32 v[72:73], v[72:73], v[152:153]
    v_pk_add_f32 v[74:75], v[74:75], v[154:155]
    v_pk_add_f32 v[76:77], v[76:77], v[156:157]
    v_pk_add_f32 v[78:79], v[78:79], v[158:159]
    v_pk_add_f32 v[80:81], v[80:81], v[160:161]
    v_pk_add_f32 v[82:83], v[82:83], v[162:163]
    v_pk_add_f32 v[84:85], v[84:85], v[164:165]
    v_pk_add_f32 v[86:87], v[86:87], v[166:167]
    v_cvt_pk_bf16_f32 v24, v72, v73
    v_cvt_pk_bf16_f32 v25, v74, v75
    v_cvt_pk_bf16_f32 v26, v76, v77
    v_cvt_pk_bf16_f32 v27, v78, v79
    v_cvt_pk_bf16_f32 v28, v80, v81
    v_cvt_pk_bf16_f32 v29, v82, v83
    v_cvt_pk_bf16_f32 v30, v84, v85
    v_cvt_pk_bf16_f32 v31, v86, v87
    v_lshlrev_b32 v72, 16, v24
    v_and_b32 v73, s36, v24
    v_lshlrev_b32 v74, 16, v25
    v_and_b32 v75, s36, v25
    v_lshlrev_b32 v76, 16, v26
    v_and_b32 v77, s36, v26
    v_lshlrev_b32 v78, 16, v27
    v_and_b32 v79, s36, v27
    v_lshlrev_b32 v80, 16, v28
    v_and_b32 v81, s36, v28
    v_lshlrev_b32 v82, 16, v29
    v_and_b32 v83, s36, v29
    v_lshlrev_b32 v84, 16, v30
    v_and_b32 v85, s36, v30
    v_lshlrev_b32 v86, 16, v31
    v_and_b32 v87, s36, v31
    v_pk_add_f32 v[72:73], v[72:73], v[168:169]
    v_pk_add_f32 v[74:75], v[74:75], v[170:171]
    v_pk_add_f32 v[76:77], v[76:77], v[172:173]
    v_pk_add_f32 v[78:79], v[78:79], v[174:175]
    v_pk_add_f32 v[80:81], v[80:81], v[176:177]
    v_pk_add_f32 v[82:83], v[82:83], v[178:179]
    v_pk_add_f32 v[84:85], v[84:85], v[180:181]
    v_pk_add_f32 v[86:87], v[86:87], v[182:183]
    s_branch K12_EPI
K12_X1:
    s_waitcnt lgkmcnt(9)
    v_mfma_f32_16x16x32_f16 v[24:27], v[56:59], v[100:103], 0
    v_mfma_f32_16x16x32_f16 v[28:31], v[56:59], v[116:119], v[28:31]
    v_mfma_f32_16x16x32_f16 v[32:35], v[56:59], v[132:135], v[32:35]
    v_mfma_f32_16x16x32_f16 v[36:39], v[56:59], v[148:151], v[36:39]
    s_waitcnt lgkmcnt(6)
    v_mfma_f32_16x16x32_f16 v[24:27], v[60:63], v[96:99], v[24:27]
    v_mfma_f32_16x16x32_f16 v[28:31], v[60:63], v[112:115], v[28:31]
    v_mfma_f32_16x16x32_f16 v[32:35], v[60:63], v[128:131], v[32:35]
    v_mfma_f32_16x16x32_f16 v[36:39], v[60:63], v[144:147], v[36:39]
    s_waitcnt lgkmcnt(3)
    v_mfma_f32_16x16x32_f16 v[24:27], v[64:67], v[92:95], v[24:27]
    v_mfma_f32_16x16x32_f16 v[28:31], v[64:67], v[108:111], v[28:31]
    v_mfma_f32_16x16x32_f16 v[32:35], v[64:67], v[124:127], v[32:35]
    v_mfma_f32_16x16x32_f16 v[36:39], v[64:67], v[140:143], v[36:39]
    s_waitcnt lgkmcnt(0)
    v_mfma_f32_16x16x32_f16 v[24:27], v[68:71], v[88:91], v[24:27]
    v_mfma_f32_16x16x32_f16 v[28:31], v[68:71], v[104:107], v[28:31]
    v_mfma_f32_16x16x32_f16 v[32:35], v[68:71], v[120:123], v[32:35]
    v_mfma_f32_16x16x32_f16 v[36:39], v[68:71], v[136:139], v[36:39]
    v_mfma_f32_16x16x32_f16 v[40:43], v[56:59], v[164:167], v[40:43]
    v_lshlrev_b32 v88, 16, v240
    v_and_b32 v89, s36, v240
    v_mfma_f32_16x16x32_f16 v[44:47], v[56:59], v[180:183], v[44:47]
    s_nop 0
    ds_write_b128 v16, v[24:27] offset:0
    v_lshlrev_b32 v104, 16, v232
    v_and_b32 v105, s36, v232
    v_mfma_f32_16x16x32_f16 v[48:51], v[56:59], v[196:199], v[48:51]
    ds_write_b128 v16, v[28:31] offset:1024
    v_lshlrev_b32 v90, 16, v241
    v_and_b32 v91, s36, v241
    v_mfma_f32_16x16x32_f16 v[52:55], v[56:59], v[212:215], v[52:55]
    ds_write_b128 v16, v[32:35] offset:2048
    v_lshlrev_b32 v106, 16, v233
    v_and_b32 v107, s36, v233
    v_mfma_f32_16x16x32_f16 v[40:43], v[60:63], v[160:163], v[40:43]
    ds_write_b128 v16, v[36:39] offset:3072
    s_mov_b64 exec, 1
    ds_add_u32 v18, v19 offset:8
    s_mov_b64 exec, -1
    s_memrealtime s[6:7]
    v_lshlrev_b32 v92, 16, v242
    v_and_b32 v93, s36, v242
    v_mfma_f32_16x16x32_f16 v[44:47], v[60:63], v[176:179], v[44:47]
    v_lshlrev_b32 v108, 16, v234
    v_and_b32 v109, s36, v234
    v_mfma_f32_16x16x32_f16 v[48:51], v[60:63], v[192:195], v[48:51]
    v_lshlrev_b32 v94, 16, v243
    v_and_b32 v95, s36, v243
    v_mfma_f32_16x16x32_f16 v[52:55], v[60:63], v[208:211], v[52:55]
    v_lshlrev_b32 v110, 16, v235
    v_and_b32 v111, s36, v235
    v_mfma_f32_16x16x32_f16 v[40:43], v[64:67], v[156:159], v[40:43]
    v_lshlrev_b32 v96, 16, v244
    v_and_b32 v97, s36, v244
    v_mfma_f32_16x16x32_f16 v[44:47], v[64:67], v[172:175], v[44:47]
    v_lshlrev_b32 v112, 16, v236
    v_and_b32 v113, s36, v236
    v_mfma_f32_16x16x32_f16 v[48:51], v[64:67], v[188:191], v[48:51]
    v_lshlrev_b32 v98, 16, v245
    v_and_b32 v99, s36, v245
    v_mfma_f32_16x16x32_f16 v[52:55], v[64:67], v[204:207], v[52:55]
    v_lshlrev_b32 v114, 16, v237
    v_and_b32 v115, s36, v237
    v_mfma_f32_16x16x32_f16 v[40:43], v[68:71], v[152:155], v[40:43]
    v_lshlrev_b32 v100, 16, v246
    v_and_b32 v101, s36, v246
    v_mfma_f32_16x16x32_f16 v[44:47], v[68:71], v[168:171], v[44:47]
    v_lshlrev_b32 v116, 16, v238
    v_and_b32 v117, s36, v238
    v_mfma_f32_16x16x32_f16 v[48:51], v[68:71], v[184:187], v[48:51]
    v_lshlrev_b32 v102, 16, v247
    v_and_b32 v103, s36, v247
    v_mfma_f32_16x16x32_f16 v[52:55], v[68:71], v[200:203], v[52:55]
    v_lshlrev_b32 v118, 16, v239
    v_and_b32 v119, s36, v239
XW_4:
    ds_read_b32 v224, v18 offset:8
    ds_read_b128 v[72:75], v17 offset:0
    ds_read_b128 v[76:79], v17 offset:1024
    ds_read_b128 v[80:83], v17 offset:2048
    ds_read_b128 v[84:87], v17 offset:3072
    s_waitcnt lgkmcnt(0)
    v_cmp_gt_u32 vcc, 2, v224
    s_cbranch_vccnz XW_4
    v_pk_add_f32 v[72:73], v[72:73], v[40:41]
    v_pk_add_f32 v[74:75], v[74:75], v[42:43]
    v_pk_add_f32 v[76:77], v[76:77], v[44:45]
    v_pk_add_f32 v[78:79], v[78:79], v[46:47]
    v_pk_add_f32 v[80:81], v[80:81], v[48:49]
    v_pk_add_f32 v[82:83], v[82:83], v[50:51]
    v_pk_add_f32 v[84:85], v[84:85], v[52:53]
    v_pk_add_f32 v[86:87], v[86:87], v[54:55]
    v_pk_mul_f32 v[72:73], v[72:73], v[22:23] op_sel_hi:[1,0]
    v_pk_mul_f32 v[74:75], v[74:75], v[22:23] op_sel_hi:[1,0]
    v_pk_mul_f32 v[76:77], v[76:77], v[22:23] op_sel_hi:[1,0]
    v_pk_mul_f32 v[78:79], v[78:79], v[22:23] op_sel_hi:[1,0]
    v_pk_mul_f32 v[80:81], v[80:81], v[22:23] op_sel_hi:[1,0]
    v_pk_mul_f32 v[82:83], v[82:83], v[22:23] op_sel_hi:[1,0]
    v_pk_mul_f32 v[84:85], v[84:85], v[22:23] op_sel_hi:[1,0]
    v_pk_mul_f32 v[86:87], v[86:87], v[22:23] op_sel_hi:[1,0]
    v_cvt_pk_bf16_f32 v24, v72, v73
    v_cvt_pk_bf16_f32 v25, v74, v75
    v_cvt_pk_bf16_f32 v26, v76, v77
    v_cvt_pk_bf16_f32 v27, v78, v79
    v_cvt_pk_bf16_f32 v28, v80, v81
    v_cvt_pk_bf16_f32 v29, v82, v83
    v_cvt_pk_bf16_f32 v30, v84, v85
    v_cvt_pk_bf16_f32 v31, v86, v87
    v_lshlrev_b32 v72, 16, v24
    v_and_b32 v73, s36, v24
    v_lshlrev_b32 v74, 16, v25
    v_and_b32 v75, s36, v25
    v_lshlrev_b32 v76, 16, v26
    v_and_b32 v77, s36, v26
    v_lshlrev_b32 v78, 16, v27
    v_and_b32 v79, s36, v27
    v_lshlrev_b32 v80, 16, v28
    v_and_b32 v81, s36, v28
    v_lshlrev_b32 v82, 16, v29
    v_and_b32 v83, s36, v29
    v_lshlrev_b32 v84, 16, v30
    v_and_b32 v85, s36, v30
    v_lshlrev_b32 v86, 16, v31
    v_and_b32 v87, s36, v31
    v_pk_add_f32 v[72:73], v[72:73], v[88:89]
    v_pk_add_f32 v[74:75], v[74:75], v[90:91]
    v_pk_add_f32 v[76:77], v[76:77], v[92:93]
    v_pk_add_f32 v[78:79], v[78:79], v[94:95]
    v_pk_add_f32 v[80:81], v[80:81], v[96:97]
    v_pk_add_f32 v[82:83], v[82:83], v[98:99]
    v_pk_add_f32 v[84:85], v[84:85], v[100:101]
    v_pk_add_f32 v[86:87], v[86:87], v[102:103]
    v_cvt_pk_bf16_f32 v24, v72, v73
    v_cvt_pk_bf16_f32 v25, v74, v75
    v_cvt_pk_bf16_f32 v26, v76, v77
    v_cvt_pk_bf16_f32 v27, v78, v79
    v_cvt_pk_bf16_f32 v28, v80, v81
    v_cvt_pk_bf16_f32 v29, v82, v83
    v_cvt_pk_bf16_f32 v30, v84, v85
    v_cvt_pk_bf16_f32 v31, v86, v87
    v_lshlrev_b32 v72, 16, v24
    v_and_b32 v73, s36, v24
    v_lshlrev_b32 v74, 16, v25
    v_and_b32 v75, s36, v25
    v_lshlrev_b32 v76, 16, v26
    v_and_b32 v77, s36, v26
    v_lshlrev_b32 v78, 16, v27
    v_and_b32 v79, s36, v27
    v_lshlrev_b32 v80, 16, v28
    v_and_b32 v81, s36, v28
    v_lshlrev_b32 v82, 16, v29
    v_and_b32 v83, s36, v29
    v_lshlrev_b32 v84, 16, v30
    v_and_b32 v85, s36, v30
    v_lshlrev_b32 v86, 16, v31
    v_and_b32 v87, s36, v31
    v_pk_add_f32 v[72:73], v[72:73], v[104:105]
    v_pk_add_f32 v[74:75], v[74:75], v[106:107]
    v_pk_add_f32 v[76:77], v[76:77], v[108:109]
    v_pk_add_f32 v[78:79], v[78:79], v[110:111]
    v_pk_add_f32 v[80:81], v[80:81], v[112:113]
    v_pk_add_f32 v[82:83], v[82:83], v[114:115]
    v_pk_add_f32 v[84:85], v[84:85], v[116:117]
    v_pk_add_f32 v[86:87], v[86:87], v[118:119]
K12_EPI:
    v_cvt_pk_bf16_f32 v24, v72, v73
    v_cvt_pk_bf16_f32 v25, v74, v75
    v_cvt_pk_bf16_f32 v26, v76, v77
    v_cvt_pk_bf16_f32 v27, v78, v79
    v_cvt_pk_bf16_f32 v28, v80, v81
    v_cvt_pk_bf16_f32 v29, v82, v83
    v_cvt_pk_bf16_f32 v30, v84, v85
    v_cvt_pk_bf16_f32 v31, v86, v87
    v_min_u32 v24, -2, v24
    v_min_u32 v26, -2, v26
    v_min_u32 v28, -2, v28
    v_min_u32 v30, -2, v30
    global_store_dwordx2 v5, v[24:25], s[40:41] offset:0 sc1
    global_store_dwordx2 v5, v[26:27], s[40:41] offset:512 sc1
    global_store_dwordx2 v5, v[28:29], s[40:41] offset:1024 sc1
    global_store_dwordx2 v5, v[30:31], s[40:41] offset:1536 sc1
    s_branch FFN_ENTRY
FFN_ENTRY:
    s_setprio 0
    s_mov_b32 s5, 0
    s_mov_b64 exec, -1
    v_mbcnt_lo_u32_b32 v1, -1, 0
    v_mbcnt_hi_u32_b32 v1, -1, v1
    s_lshl_b32 s21, s20, 6
    v_add_u32 v0, s21, v1
    s_mov_b64 s[8:9], s[44:45]
    s_mov_b64 s[10:11], s[46:47]
    s_mov_b64 s[14:15], s[54:55]
    s_mov_b64 s[16:17], s[48:49]
    s_mov_b64 s[18:19], s[50:51]
    s_sub_u32 s58, 0, s56
    s_subb_u32 s59, 0, s57
    s_and_b32 s21, s2, 7
    s_lshr_b32 s22, s2, 3
    s_mov_b32 s37, 0xffff0000
    s_lshl_b32 s63, s21, 1
    s_lshr_b32 s60, s21, 1
    s_lshl_b32 s60, s60, 3
    s_and_b32 s61, s22, 7
    s_or_b32 s60, s60, s61
    s_and_b32 s61, s21, 1
    s_lshl_b32 s61, s61, 2
    s_lshr_b32 s62, s22, 3
    s_or_b32 s61, s61, s62
    s_cmp_lt_u32 s22, 4
    s_cbranch_scc1 K3_SPARE
    s_sub_u32 s22, s22, 4
    s_lshr_b32 s23, s21, 1
    s_lshl_b32 s23, s23, 2
    s_and_b32 s24, s22, 3
    s_or_b32 s23, s23, s24
    s_and_b32 s24, s21, 1
    s_mul_i32 s24, s24, 7
    s_lshr_b32 s25, s22, 2
    s_add_u32 s24, s24, s25
    s_cmp_lt_u32 s20, 4
    s_cbranch_scc1 K3_COMP
    s_sub_u32 s26, s20, 4
    v_lshrrev_b32 v4, 4, v1
    v_and_b32 v5, 15, v1
    v_lshlrev_b32 v6, 1, v4
    v_xor_b32 v6, v6, v5
    v_xor_b32 v7, 8, v6
    s_cmp_eq_u32 s20, 7
    s_cbranch_scc1 K3_HELP
    s_mul_i32 s29, s26, 49152
    v_lshrrev_b32 v29, 3, v1
    v_and_b32 v30, 7, v1
    v_and_b32 v31, 2, v29
    v_lshlrev_b32 v31, 1, v31
    v_xor_b32 v30, v30, v31
    v_bfe_u32 v31, v29, 2, 1
    v_lshlrev_b32 v31, 1, v31
    v_xor_b32 v30, v30, v31
    v_lshlrev_b32 v31, 10, v29
    v_lshl_add_u32 v24, v30, 4, v31
    v_add_u32 v25, 7168, v24
    v_add_u32 v26, 14336, v24
    v_add_u32 v27, 21504, v24
    s_lshl_b32 s35, s61, 7
    s_add_u32 s44, s16, s35
    s_addc_u32 s45, s17, 0
    s_sub_u32 s46, 1835008, s35
    s_mov_b32 s47, 0x20000
    s_lshl_b32 s35, s26, 16
    v_lshl_add_u32 v28, v1, 4, s29
    s_cmp_eq_u32 s26, 0
    s_cbranch_scc1 K3_H0
    v_mul_u32_u24 v9, 3584, v4
    v_lshl_add_u32 v6, v6, 4, v9
    v_lshl_add_u32 v7, v7, 4, v9
    v_add_u32 v16, 0, v6
    v_add_u32 v17, 13312, v7
    v_add_u32 v18, 26624, v6
    v_add_u32 v19, 39936, v7
    v_add_u32 v20, 57344, v6
    v_add_u32 v21, 70656, v7
    v_add_u32 v22, 83968, v6
    v_add_u32 v23, 97280, v7
    s_lshl_b32 s31, s24, 8
    s_cmp_eq_u32 s26, 1
    s_cselect_b32 s40, s8, s10
    s_cselect_b32 s41, s9, s11
    s_add_u32 s40, s40, s31
    s_addc_u32 s41, s41, 0
    s_sub_u32 s42, 1835008, s31
    s_mov_b32 s43, 0x20000
    s_add_u32 m0, s29, 0
    s_add_u32 s33, s63, 0
    s_and_b32 s33, s33, 15
    s_mul_i32 s33, s33, 114688
    buffer_load_dwordx4 v16, s[40:43], s33 offen offset:0 lds
    s_add_u32 m0, s29, 0
    s_nop 0
    buffer_load_dwordx4 v17, s[40:43], s33 offen offset:1024 lds
    s_add_u32 m0, s29, 0
    s_nop 0
    buffer_load_dwordx4 v18, s[40:43], s33 offen offset:2048 lds
    s_add_u32 m0, s29, 0
    s_nop 0
    buffer_load_dwordx4 v19, s[40:43], s33 offen offset:3072 lds
    s_add_u32 m0, s29, 4096
    s_nop 0
    buffer_load_dwordx4 v20, s[40:43], s33 offen offset:0 lds
    s_add_u32 m0, s29, 4096
    s_nop 0
    buffer_load_dwordx4 v21, s[40:43], s33 offen offset:1024 lds
    s_add_u32 m0, s29, 4096
    s_nop 0
    buffer_load_dwordx4 v22, s[40:43], s33 offen offset:2048 lds
    s_add_u32 m0, s29, 4096
    s_nop 0
    buffer_load_dwordx4 v23, s[40:43], s33 offen offset:3072 lds
    s_add_u32 m0, s29, 8192
    s_add_u32 s33, s63, 1
    s_and_b32 s33, s33, 15
    s_mul_i32 s33, s33, 114688
    buffer_load_dwordx4 v16, s[40:43], s33 offen offset:0 lds
    s_add_u32 m0, s29, 8192
    s_nop 0
    buffer_load_dwordx4 v17, s[40:43], s33 offen offset:1024 lds
    s_add_u32 m0, s29, 8192
    s_nop 0
    buffer_load_dwordx4 v18, s[40:43], s33 offen offset:2048 lds
    s_add_u32 m0, s29, 8192
    s_nop 0
    buffer_load_dwordx4 v19, s[40:43], s33 offen offset:3072 lds
    s_add_u32 m0, s29, 12288
    s_nop 0
    buffer_load_dwordx4 v20, s[40:43], s33 offen offset:0 lds
    s_add_u32 m0, s29, 12288
    s_nop 0
    buffer_load_dwordx4 v21, s[40:43], s33 offen offset:1024 lds
    s_add_u32 m0, s29, 12288
    s_nop 0
    buffer_load_dwordx4 v22, s[40:43], s33 offen offset:2048 lds
    s_add_u32 m0, s29, 12288
    s_nop 0
    buffer_load_dwordx4 v23, s[40:43], s33 offen offset:3072 lds
    s_add_u32 m0, s29, 16384
    s_add_u32 s33, s63, 2
    s_and_b32 s33, s33, 15
    s_mul_i32 s33, s33, 114688
    buffer_load_dwordx4 v16, s[40:43], s33 offen offset:0 lds
    s_add_u32 m0, s29, 16384
    s_nop 0
    buffer_load_dwordx4 v17, s[40:43], s33 offen offset:1024 lds
    s_add_u32 m0, s29, 16384
    s_nop 0
    buffer_load_dwordx4 v18, s[40:43], s33 offen offset:2048 lds
    s_add_u32 m0, s29, 16384
    s_nop 0
    buffer_load_dwordx4 v19, s[40:43], s33 offen offset:3072 lds
    s_add_u32 m0, s29, 20480
    s_nop 0
    buffer_load_dwordx4 v20, s[40:43], s33 offen offset:0 lds
    s_add_u32 m0, s29, 20480
    s_nop 0
    buffer_load_dwordx4 v21, s[40:43], s33 offen offset:1024 lds
    s_add_u32 m0, s29, 20480
    s_nop 0
    buffer_load_dwordx4 v22, s[40:43], s33 offen offset:2048 lds
    s_add_u32 m0, s29, 20480
    s_nop 0
    buffer_load_dwordx4 v23, s[40:43], s33 offen offset:3072 lds
    s_barrier
    s_waitcnt vmcnt(16)
    s_barrier
    s_add_u32 m0, s29, 24576
    s_add_u32 s33, s63, 3
    s_and_b32 s33, s33, 15
    s_mul_i32 s33, s33, 114688
    buffer_load_dwordx4 v16, s[40:43], s33 offen offset:0 lds
    s_add_u32 m0, s29, 24576
    s_nop 0
    buffer_load_dwordx4 v17, s[40:43], s33 offen offset:1024 lds
    s_add_u32 m0, s29, 24576
    s_nop 0
    buffer_load_dwordx4 v18, s[40:43], s33 offen offset:2048 lds
    s_add_u32 m0, s29, 24576
    s_nop 0
    buffer_load_dwordx4 v19, s[40:43], s33 offen offset:3072 lds
    s_add_u32 m0, s29, 28672
    s_nop 0
    buffer_load_dwordx4 v20, s[40:43], s33 offen offset:0 lds
    s_add_u32 m0, s29, 28672
    s_nop 0
    buffer_load_dwordx4 v21, s[40:43], s33 offen offset:1024 lds
    s_add_u32 m0, s29, 28672
    s_nop 0
    buffer_load_dwordx4 v22, s[40:43], s33 offen offset:2048 lds
    s_add_u32 m0, s29, 28672
    s_nop 0
    buffer_load_dwordx4 v23, s[40:43], s33 offen offset:3072 lds
    s_waitcnt vmcnt(16)
    s_barrier
    s_add_u32 m0, s29, 32768
    s_add_u32 s33, s63, 4
    s_and_b32 s33, s33, 15
    s_mul_i32 s33, s33, 114688
    buffer_load_dwordx4 v16, s[40:43], s33 offen offset:0 lds
    s_add_u32 m0, s29, 32768
    s_nop 0
    buffer_load_dwordx4 v17, s[40:43], s33 offen offset:1024 lds
    s_add_u32 m0, s29, 32768
    s_nop 0
    buffer_load_dwordx4 v18, s[40:43], s33 offen offset:2048 lds
    s_add_u32 m0, s29, 32768
    s_nop 0
    buffer_load_dwordx4 v19, s[40:43], s33 offen offset:3072 lds
    s_add_u32 m0, s29, 36864
    s_nop 0
    buffer_load_dwordx4 v20, s[40:43], s33 offen offset:0 lds
    s_add_u32 m0, s29, 36864
    s_nop 0
    buffer_load_dwordx4 v21, s[40:43], s33 offen offset:1024 lds
    s_add_u32 m0, s29, 36864
    s_nop 0
    buffer_load_dwordx4 v22, s[40:43], s33 offen offset:2048 lds
    s_add_u32 m0, s29, 36864
    s_nop 0
    buffer_load_dwordx4 v23, s[40:43], s33 offen offset:3072 lds
    s_waitcnt vmcnt(8)
    s_barrier
    s_add_u32 m0, s29, 40960
    s_add_u32 s33, s63, 5
    s_and_b32 s33, s33, 15
    s_mul_i32 s33, s33, 114688
    buffer_load_dwordx4 v16, s[40:43], s33 offen offset:0 lds
    s_add_u32 m0, s29, 40960
    s_nop 0
    buffer_load_dwordx4 v17, s[40:43], s33 offen offset:1024 lds
    s_add_u32 m0, s29, 40960
    s_nop 0
    buffer_load_dwordx4 v18, s[40:43], s33 offen offset:2048 lds
    s_add_u32 m0, s29, 40960
    s_nop 0
    buffer_load_dwordx4 v19, s[40:43], s33 offen offset:3072 lds
    s_add_u32 m0, s29, 45056
    s_nop 0
    buffer_load_dwordx4 v20, s[40:43], s33 offen offset:0 lds
    s_add_u32 m0, s29, 45056
    s_nop 0
    buffer_load_dwordx4 v21, s[40:43], s33 offen offset:1024 lds
    s_add_u32 m0, s29, 45056
    s_nop 0
    buffer_load_dwordx4 v22, s[40:43], s33 offen offset:2048 lds
    s_add_u32 m0, s29, 45056
    s_nop 0
    buffer_load_dwordx4 v23, s[40:43], s33 offen offset:3072 lds
    s_add_u32 m0, s29, 0
    s_add_u32 s33, s63, 6
    s_and_b32 s33, s33, 15
    s_mul_i32 s33, s33, 114688
    buffer_load_dwordx4 v16, s[40:43], s33 offen offset:0 lds
    s_add_u32 m0, s29, 0
    s_nop 0
    buffer_load_dwordx4 v17, s[40:43], s33 offen offset:1024 lds
    s_add_u32 m0, s29, 0
    s_nop 0
    buffer_load_dwordx4 v18, s[40:43], s33 offen offset:2048 lds
    s_add_u32 m0, s29, 0
    s_nop 0
    buffer_load_dwordx4 v19, s[40:43], s33 offen offset:3072 lds
    s_add_u32 m0, s29, 4096
    s_nop 0
    buffer_load_dwordx4 v20, s[40:43], s33 offen offset:0 lds
    s_add_u32 m0, s29, 4096
    s_nop 0
    buffer_load_dwordx4 v21, s[40:43], s33 offen offset:1024 lds
    s_add_u32 m0, s29, 4096
    s_nop 0
    buffer_load_dwordx4 v22, s[40:43], s33 offen offset:2048 lds
    s_add_u32 m0, s29, 4096
    s_nop 0
    buffer_load_dwordx4 v23, s[40:43], s33 offen offset:3072 lds
    s_waitcnt vmcnt(8)
    s_barrier
    s_add_u32 m0, s29, 8192
    s_add_u32 s33, s63, 7
    s_and_b32 s33, s33, 15
    s_mul_i32 s33, s33, 114688
    buffer_load_dwordx4 v16, s[40:43], s33 offen offset:0 lds
    s_add_u32 m0, s29, 8192
    s_nop 0
    buffer_load_dwordx4 v17, s[40:43], s33 offen offset:1024 lds
    s_add_u32 m0, s29, 8192
    s_nop 0
    buffer_load_dwordx4 v18, s[40:43], s33 offen offset:2048 lds
    s_add_u32 m0, s29, 8192
    s_nop 0
    buffer_load_dwordx4 v19, s[40:43], s33 offen offset:3072 lds
    s_add_u32 m0, s29, 12288
    s_nop 0
    buffer_load_dwordx4 v20, s[40:43], s33 offen offset:0 lds
    s_add_u32 m0, s29, 12288
    s_nop 0
    buffer_load_dwordx4 v21, s[40:43], s33 offen offset:1024 lds
    s_add_u32 m0, s29, 12288
    s_nop 0
    buffer_load_dwordx4 v22, s[40:43], s33 offen offset:2048 lds
    s_add_u32 m0, s29, 12288
    s_nop 0
    buffer_load_dwordx4 v23, s[40:43], s33 offen offset:3072 lds
    s_add_u32 m0, s29, 16384
    s_add_u32 s33, s63, 8
    s_and_b32 s33, s33, 15
    s_mul_i32 s33, s33, 114688
    buffer_load_dwordx4 v16, s[40:43], s33 offen offset:0 lds
    s_add_u32 m0, s29, 16384
    s_nop 0
    buffer_load_dwordx4 v17, s[40:43], s33 offen offset:1024 lds
    s_add_u32 m0, s29, 16384
    s_nop 0
    buffer_load_dwordx4 v18, s[40:43], s33 offen offset:2048 lds
    s_add_u32 m0, s29, 16384
    s_nop 0
    buffer_load_dwordx4 v19, s[40:43], s33 offen offset:3072 lds
    s_add_u32 m0, s29, 20480
    s_nop 0
    buffer_load_dwordx4 v20, s[40:43], s33 offen offset:0 lds
    s_add_u32 m0, s29, 20480
    s_nop 0
    buffer_load_dwordx4 v21, s[40:43], s33 offen offset:1024 lds
    s_add_u32 m0, s29, 20480
    s_nop 0
    buffer_load_dwordx4 v22, s[40:43], s33 offen offset:2048 lds
    s_add_u32 m0, s29, 20480
    s_nop 0
    buffer_load_dwordx4 v23, s[40:43], s33 offen offset:3072 lds
    s_add_u32 m0, s29, 24576
    s_add_u32 s33, s63, 9
    s_and_b32 s33, s33, 15
    s_mul_i32 s33, s33, 114688
    buffer_load_dwordx4 v16, s[40:43], s33 offen offset:0 lds
    s_add_u32 m0, s29, 24576
    s_nop 0
    buffer_load_dwordx4 v17, s[40:43], s33 offen offset:1024 lds
    s_add_u32 m0, s29, 24576
    s_nop 0
    buffer_load_dwordx4 v18, s[40:43], s33 offen offset:2048 lds
    s_add_u32 m0, s29, 24576
    s_nop 0
    buffer_load_dwordx4 v19, s[40:43], s33 offen offset:3072 lds
    s_add_u32 m0, s29, 28672
    s_nop 0
    buffer_load_dwordx4 v20, s[40:43], s33 offen offset:0 lds
    s_add_u32 m0, s29, 28672
    s_nop 0
    buffer_load_dwordx4 v21, s[40:43], s33 offen offset:1024 lds
    s_add_u32 m0, s29, 28672
    s_nop 0
    buffer_load_dwordx4 v22, s[40:43], s33 offen offset:2048 lds
    s_add_u32 m0, s29, 28672
    s_nop 0
    buffer_load_dwordx4 v23, s[40:43], s33 offen offset:3072 lds
    s_waitcnt vmcnt(16)
    s_barrier
    s_add_u32 m0, s29, 32768
    s_add_u32 s33, s63, 10
    s_and_b32 s33, s33, 15
    s_mul_i32 s33, s33, 114688
    buffer_load_dwordx4 v16, s[40:43], s33 offen offset:0 lds
    s_add_u32 m0, s29, 32768
    s_nop 0
    buffer_load_dwordx4 v17, s[40:43], s33 offen offset:1024 lds
    s_add_u32 m0, s29, 32768
    s_nop 0
    buffer_load_dwordx4 v18, s[40:43], s33 offen offset:2048 lds
    s_add_u32 m0, s29, 32768
    s_nop 0
    buffer_load_dwordx4 v19, s[40:43], s33 offen offset:3072 lds
    s_add_u32 m0, s29, 36864
    s_nop 0
    buffer_load_dwordx4 v20, s[40:43], s33 offen offset:0 lds
    s_add_u32 m0, s29, 36864
    s_nop 0
    buffer_load_dwordx4 v21, s[40:43], s33 offen offset:1024 lds
    s_add_u32 m0, s29, 36864
    s_nop 0
    buffer_load_dwordx4 v22, s[40:43], s33 offen offset:2048 lds
    s_add_u32 m0, s29, 36864
    s_nop 0
    buffer_load_dwordx4 v23, s[40:43], s33 offen offset:3072 lds
    s_add_u32 m0, s29, 40960
    s_add_u32 s33, s63, 11
    s_and_b32 s33, s33, 15
    s_mul_i32 s33, s33, 114688
    buffer_load_dwordx4 v16, s[40:43], s33 offen offset:0 lds
    s_add_u32 m0, s29, 40960
    s_nop 0
    buffer_load_dwordx4 v17, s[40:43], s33 offen offset:1024 lds
    s_add_u32 m0, s29, 40960
    s_nop 0
    buffer_load_dwordx4 v18, s[40:43], s33 offen offset:2048 lds
    s_add_u32 m0, s29, 40960
    s_nop 0
    buffer_load_dwordx4 v19, s[40:43], s33 offen offset:3072 lds
    s_add_u32 m0, s29, 45056
    s_nop 0
    buffer_load_dwordx4 v20, s[40:43], s33 offen offset:0 lds
    s_add_u32 m0, s29, 45056
    s_nop 0
    buffer_load_dwordx4 v21, s[40:43], s33 offen offset:1024 lds
    s_add_u32 m0, s29, 45056
    s_nop 0
    buffer_load_dwordx4 v22, s[40:43], s33 offen offset:2048 lds
    s_add_u32 m0, s29, 45056
    s_nop 0
    buffer_load_dwordx4 v23, s[40:43], s33 offen offset:3072 lds
    s_waitcnt vmcnt(16)
    s_barrier
    s_add_u32 m0, s29, 0
    s_add_u32 s33, s63, 12
    s_and_b32 s33, s33, 15
    s_mul_i32 s33, s33, 114688
    buffer_load_dwordx4 v16, s[40:43], s33 offen offset:0 lds
    s_add_u32 m0, s29, 0
    s_nop 0
    buffer_load_dwordx4 v17, s[40:43], s33 offen offset:1024 lds
    s_add_u32 m0, s29, 0
    s_nop 0
    buffer_load_dwordx4 v18, s[40:43], s33 offen offset:2048 lds
    s_add_u32 m0, s29, 0
    s_nop 0
    buffer_load_dwordx4 v19, s[40:43], s33 offen offset:3072 lds
    s_add_u32 m0, s29, 4096
    s_nop 0
    buffer_load_dwordx4 v20, s[40:43], s33 offen offset:0 lds
    s_add_u32 m0, s29, 4096
    s_nop 0
    buffer_load_dwordx4 v21, s[40:43], s33 offen offset:1024 lds
    s_add_u32 m0, s29, 4096
    s_nop 0
    buffer_load_dwordx4 v22, s[40:43], s33 offen offset:2048 lds
    s_add_u32 m0, s29, 4096
    s_nop 0
    buffer_load_dwordx4 v23, s[40:43], s33 offen offset:3072 lds
    s_add_u32 m0, s29, 8192
    s_add_u32 s33, s63, 13
    s_and_b32 s33, s33, 15
    s_mul_i32 s33, s33, 114688
    buffer_load_dwordx4 v16, s[40:43], s33 offen offset:0 lds
    s_add_u32 m0, s29, 8192
    s_nop 0
    buffer_load_dwordx4 v17, s[40:43], s33 offen offset:1024 lds
    s_add_u32 m0, s29, 8192
    s_nop 0
    buffer_load_dwordx4 v18, s[40:43], s33 offen offset:2048 lds
    s_add_u32 m0, s29, 8192
    s_nop 0
    buffer_load_dwordx4 v19, s[40:43], s33 offen offset:3072 lds
    s_add_u32 m0, s29, 12288
    s_nop 0
    buffer_load_dwordx4 v20, s[40:43], s33 offen offset:0 lds
    s_add_u32 m0, s29, 12288
    s_nop 0
    buffer_load_dwordx4 v21, s[40:43], s33 offen offset:1024 lds
    s_add_u32 m0, s29, 12288
    s_nop 0
    buffer_load_dwordx4 v22, s[40:43], s33 offen offset:2048 lds
    s_add_u32 m0, s29, 12288
    s_nop 0
    buffer_load_dwordx4 v23, s[40:43], s33 offen offset:3072 lds
    s_waitcnt vmcnt(16)
    s_barrier
    s_add_u32 m0, s29, 16384
    s_add_u32 s33, s63, 14
    s_and_b32 s33, s33, 15
    s_mul_i32 s33, s33, 114688
    buffer_load_dwordx4 v16, s[40:43], s33 offen offset:0 lds
    s_add_u32 m0, s29, 16384
    s_nop 0
    buffer_load_dwordx4 v17, s[40:43], s33 offen offset:1024 lds
    s_add_u32 m0, s29, 16384
    s_nop 0
    buffer_load_dwordx4 v18, s[40:43], s33 offen offset:2048 lds
    s_add_u32 m0, s29, 16384
    s_nop 0
    buffer_load_dwordx4 v19, s[40:43], s33 offen offset:3072 lds
    s_add_u32 m0, s29, 20480
    s_nop 0
    buffer_load_dwordx4 v20, s[40:43], s33 offen offset:0 lds
    s_add_u32 m0, s29, 20480
    s_nop 0
    buffer_load_dwordx4 v21, s[40:43], s33 offen offset:1024 lds
    s_add_u32 m0, s29, 20480
    s_nop 0
    buffer_load_dwordx4 v22, s[40:43], s33 offen offset:2048 lds
    s_add_u32 m0, s29, 20480
    s_nop 0
    buffer_load_dwordx4 v23, s[40:43], s33 offen offset:3072 lds
    s_add_u32 m0, s29, 24576
    s_add_u32 s33, s63, 15
    s_and_b32 s33, s33, 15
    s_mul_i32 s33, s33, 114688
    buffer_load_dwordx4 v16, s[40:43], s33 offen offset:0 lds
    s_add_u32 m0, s29, 24576
    s_nop 0
    buffer_load_dwordx4 v17, s[40:43], s33 offen offset:1024 lds
    s_add_u32 m0, s29, 24576
    s_nop 0
    buffer_load_dwordx4 v18, s[40:43], s33 offen offset:2048 lds
    s_add_u32 m0, s29, 24576
    s_nop 0
    buffer_load_dwordx4 v19, s[40:43], s33 offen offset:3072 lds
    s_add_u32 m0, s29, 28672
    s_nop 0
    buffer_load_dwordx4 v20, s[40:43], s33 offen offset:0 lds
    s_add_u32 m0, s29, 28672
    s_nop 0
    buffer_load_dwordx4 v21, s[40:43], s33 offen offset:1024 lds
    s_add_u32 m0, s29, 28672
    s_nop 0
    buffer_load_dwordx4 v22, s[40:43], s33 offen offset:2048 lds
    s_add_u32 m0, s29, 28672
    s_nop 0
    buffer_load_dwordx4 v23, s[40:43], s33 offen offset:3072 lds
    s_waitcnt vmcnt(0)
    s_barrier
    s_branch K3_LT13
K3_H0:
    v_lshlrev_b32 v9, 12, v4
    v_lshl_add_u32 v6, v6, 4, v9
    v_lshl_add_u32 v7, v7, 4, v9
    v_add_u32 v16, 0, v6
    v_add_u32 v17, 15360, v7
    v_add_u32 v18, 30720, v6
    v_add_u32 v19, 46080, v7
    v_lshlrev_b32 v20, 4, v1
    v_add_u32 v20, 0, v20
    s_lshl_b32 s28, s23, 8
    s_add_u32 s30, s28, 0x800000
    s_add_u32 s40, s14, s30
    s_addc_u32 s41, s15, 0
    s_sub_u32 s42, 0x200000, s28
    s_mov_b32 s43, 0x20000
    s_barrier
    v_and_b32 v146, 7, v1
    s_lshl_b32 s30, s23, 3
    v_add_u32 v146, s30, v146
    v_mul_u32_u24 v146, 57344, v146
    s_lshl_b32 s30, s24, 12
    s_add_u32 s30, s30, 0xa00000
    v_add_u32 v146, s30, v146
    s_lshl_b32 s30, s60, 16
    s_add_u32 s30, s30, 0
    v_mov_b32 v147, s30
    s_mov_b64 exec, 0xff
    global_load_dword v148, v146, s[14:15]
    s_mov_b64 exec, 1
    global_load_dword v148, v147, s[18:19]
    s_mov_b64 exec, -1
    s_waitcnt vmcnt(0)
    s_mov_b32 m0, 0
    s_add_u32 s33, s63, 0
    s_and_b32 s33, s33, 15
    s_lshl_b32 s33, s33, 17
    buffer_load_dwordx4 v16, s[40:43], s33 offen offset:0 sc1 lds
    buffer_load_dwordx4 v17, s[40:43], s33 offen offset:1024 sc1 lds
    buffer_load_dwordx4 v18, s[40:43], s33 offen offset:2048 sc1 lds
    buffer_load_dwordx4 v19, s[40:43], s33 offen offset:3072 sc1 lds
    s_mov_b32 m0, 8192
    s_add_u32 s33, s63, 1
    s_and_b32 s33, s33, 15
    s_lshl_b32 s33, s33, 17
    buffer_load_dwordx4 v16, s[40:43], s33 offen offset:0 sc1 lds
    buffer_load_dwordx4 v17, s[40:43], s33 offen offset:1024 sc1 lds
    buffer_load_dwordx4 v18, s[40:43], s33 offen offset:2048 sc1 lds
    buffer_load_dwordx4 v19, s[40:43], s33 offen offset:3072 sc1 lds
    s_cmp_eq_u32 s4, 0
    s_cbranch_scc1 CSF_7
    s_lshl_b32 s30, s2, 3
    s_and_b32 s31, s20, 0
    s_lshl_b32 s31, s31, 3
    s_add_u32 s30, s30, s31
    s_add_u32 s30, s30, 0x1140800
    v_mov_b32 v146, s30
    v_mov_b32 v148, s6
    v_mov_b32 v149, s7
    s_mov_b64 exec, 1
    global_store_dwordx2 v146, v[148:149], s[14:15] sc1
    s_mov_b64 exec, -1
CSF_7:
    s_setprio 3
    s_waitcnt vmcnt(4)
    ds_read_b128 v[128:131], v20 offset:0
    ds_read_b128 v[132:135], v20 offset:1024
    ds_read_b128 v[136:139], v20 offset:2048
    ds_read_b128 v[140:143], v20 offset:3072
    s_waitcnt lgkmcnt(2)
    v_max3_u32 v21, v128, v130, v132
    s_waitcnt lgkmcnt(0)
    v_max3_u32 v22, v136, v138, v140
    v_max3_u32 v21, v21, v134, v142
    v_max_u32 v21, v21, v22
    v_cmp_eq_u32 vcc, -1, v21
    s_cbranch_vccnz K3_HR0_0
K3_HO0_0:
    s_barrier
    s_mov_b32 m0, 16384
    s_add_u32 s33, s63, 2
    s_and_b32 s33, s33, 15
    s_lshl_b32 s33, s33, 17
    buffer_load_dwordx4 v16, s[40:43], s33 offen offset:0 sc1 lds
    buffer_load_dwordx4 v17, s[40:43], s33 offen offset:1024 sc1 lds
    buffer_load_dwordx4 v18, s[40:43], s33 offen offset:2048 sc1 lds
    buffer_load_dwordx4 v19, s[40:43], s33 offen offset:3072 sc1 lds
    s_mov_b32 m0, 24576
    s_add_u32 s33, s63, 3
    s_and_b32 s33, s33, 15
    s_lshl_b32 s33, s33, 17
    buffer_load_dwordx4 v16, s[40:43], s33 offen offset:0 sc1 lds
    buffer_load_dwordx4 v17, s[40:43], s33 offen offset:1024 sc1 lds
    buffer_load_dwordx4 v18, s[40:43], s33 offen offset:2048 sc1 lds
    buffer_load_dwordx4 v19, s[40:43], s33 offen offset:3072 sc1 lds
    s_waitcnt vmcnt(8)
    ds_read_b128 v[128:131], v20 offset:8192
    ds_read_b128 v[132:135], v20 offset:9216
    ds_read_b128 v[136:139], v20 offset:10240
    ds_read_b128 v[140:143], v20 offset:11264
    s_waitcnt lgkmcnt(2)
    v_max3_u32 v21, v128, v130, v132
    s_waitcnt lgkmcnt(0)
    v_max3_u32 v22, v136, v138, v140
    v_max3_u32 v21, v21, v134, v142
    v_max_u32 v21, v21, v22
    v_cmp_eq_u32 vcc, -1, v21
    s_cbranch_vccnz K3_HR0_1
K3_HO0_1:
    s_barrier
    s_mov_b32 m0, 32768
    s_add_u32 s33, s63, 4
    s_and_b32 s33, s33, 15
    s_lshl_b32 s33, s33, 17
    buffer_load_dwordx4 v16, s[40:43], s33 offen offset:0 sc1 lds
    buffer_load_dwordx4 v17, s[40:43], s33 offen offset:1024 sc1 lds
    buffer_load_dwordx4 v18, s[40:43], s33 offen offset:2048 sc1 lds
    buffer_load_dwordx4 v19, s[40:43], s33 offen offset:3072 sc1 lds
    s_mov_b32 m0, 40960
    s_add_u32 s33, s63, 5
    s_and_b32 s33, s33, 15
    s_lshl_b32 s33, s33, 17
    buffer_load_dwordx4 v16, s[40:43], s33 offen offset:0 sc1 lds
    buffer_load_dwordx4 v17, s[40:43], s33 offen offset:1024 sc1 lds
    buffer_load_dwordx4 v18, s[40:43], s33 offen offset:2048 sc1 lds
    buffer_load_dwordx4 v19, s[40:43], s33 offen offset:3072 sc1 lds
    s_waitcnt vmcnt(12)
    ds_read_b128 v[128:131], v20 offset:16384
    ds_read_b128 v[132:135], v20 offset:17408
    ds_read_b128 v[136:139], v20 offset:18432
    ds_read_b128 v[140:143], v20 offset:19456
    s_waitcnt lgkmcnt(2)
    v_max3_u32 v21, v128, v130, v132
    s_waitcnt lgkmcnt(0)
    v_max3_u32 v22, v136, v138, v140
    v_max3_u32 v21, v21, v134, v142
    v_max_u32 v21, v21, v22
    v_cmp_eq_u32 vcc, -1, v21
    s_cbranch_vccnz K3_HR0_2
K3_HO0_2:
    s_waitcnt vmcnt(8)
    ds_read_b128 v[128:131], v20 offset:24576
    ds_read_b128 v[132:135], v20 offset:25600
    ds_read_b128 v[136:139], v20 offset:26624
    ds_read_b128 v[140:143], v20 offset:27648
    s_waitcnt lgkmcnt(2)
    v_max3_u32 v21, v128, v130, v132
    s_waitcnt lgkmcnt(0)
    v_max3_u32 v22, v136, v138, v140
    v_max3_u32 v21, v21, v134, v142
    v_max_u32 v21, v21, v22
    v_cmp_eq_u32 vcc, -1, v21
    s_cbranch_vccnz K3_HR0_3
K3_HO0_3:
    s_barrier
    s_mov_b32 m0, 0
    s_add_u32 s33, s63, 6
    s_and_b32 s33, s33, 15
    s_lshl_b32 s33, s33, 17
    buffer_load_dwordx4 v16, s[40:43], s33 offen offset:0 sc1 lds
    buffer_load_dwordx4 v17, s[40:43], s33 offen offset:1024 sc1 lds
    buffer_load_dwordx4 v18, s[40:43], s33 offen offset:2048 sc1 lds
    buffer_load_dwordx4 v19, s[40:43], s33 offen offset:3072 sc1 lds
    s_mov_b32 m0, 8192
    s_add_u32 s33, s63, 7
    s_and_b32 s33, s33, 15
    s_lshl_b32 s33, s33, 17
    buffer_load_dwordx4 v16, s[40:43], s33 offen offset:0 sc1 lds
    buffer_load_dwordx4 v17, s[40:43], s33 offen offset:1024 sc1 lds
    buffer_load_dwordx4 v18, s[40:43], s33 offen offset:2048 sc1 lds
    buffer_load_dwordx4 v19, s[40:43], s33 offen offset:3072 sc1 lds
    s_waitcnt vmcnt(12)
    ds_read_b128 v[128:131], v20 offset:32768
    ds_read_b128 v[132:135], v20 offset:33792
    ds_read_b128 v[136:139], v20 offset:34816
    ds_read_b128 v[140:143], v20 offset:35840
    s_waitcnt lgkmcnt(2)
    v_max3_u32 v21, v128, v130, v132
    s_waitcnt lgkmcnt(0)
    v_max3_u32 v22, v136, v138, v140
    v_max3_u32 v21, v21, v134, v142
    v_max_u32 v21, v21, v22
    v_cmp_eq_u32 vcc, -1, v21
    s_cbranch_vccnz K3_HR0_4
K3_HO0_4:
    s_waitcnt vmcnt(8)
    ds_read_b128 v[128:131], v20 offset:40960
    ds_read_b128 v[132:135], v20 offset:41984
    ds_read_b128 v[136:139], v20 offset:43008
    ds_read_b128 v[140:143], v20 offset:44032
    s_waitcnt lgkmcnt(2)
    v_max3_u32 v21, v128, v130, v132
    s_waitcnt lgkmcnt(0)
    v_max3_u32 v22, v136, v138, v140
    v_max3_u32 v21, v21, v134, v142
    v_max_u32 v21, v21, v22
    v_cmp_eq_u32 vcc, -1, v21
    s_cbranch_vccnz K3_HR0_5
K3_HO0_5:
    s_barrier
    s_mov_b32 m0, 16384
    s_add_u32 s33, s63, 8
    s_and_b32 s33, s33, 15
    s_lshl_b32 s33, s33, 17
    buffer_load_dwordx4 v16, s[40:43], s33 offen offset:0 sc1 lds
    buffer_load_dwordx4 v17, s[40:43], s33 offen offset:1024 sc1 lds
    buffer_load_dwordx4 v18, s[40:43], s33 offen offset:2048 sc1 lds
    buffer_load_dwordx4 v19, s[40:43], s33 offen offset:3072 sc1 lds
    s_mov_b32 m0, 24576
    s_add_u32 s33, s63, 9
    s_and_b32 s33, s33, 15
    s_lshl_b32 s33, s33, 17
    buffer_load_dwordx4 v16, s[40:43], s33 offen offset:0 sc1 lds
    buffer_load_dwordx4 v17, s[40:43], s33 offen offset:1024 sc1 lds
    buffer_load_dwordx4 v18, s[40:43], s33 offen offset:2048 sc1 lds
    buffer_load_dwordx4 v19, s[40:43], s33 offen offset:3072 sc1 lds
    s_waitcnt vmcnt(12)
    ds_read_b128 v[128:131], v20 offset:0
    ds_read_b128 v[132:135], v20 offset:1024
    ds_read_b128 v[136:139], v20 offset:2048
    ds_read_b128 v[140:143], v20 offset:3072
    s_waitcnt lgkmcnt(2)
    v_max3_u32 v21, v128, v130, v132
    s_waitcnt lgkmcnt(0)
    v_max3_u32 v22, v136, v138, v140
    v_max3_u32 v21, v21, v134, v142
    v_max_u32 v21, v21, v22
    v_cmp_eq_u32 vcc, -1, v21
    s_cbranch_vccnz K3_HR0_6
K3_HO0_6:
    s_waitcnt vmcnt(8)
    ds_read_b128 v[128:131], v20 offset:8192
    ds_read_b128 v[132:135], v20 offset:9216
    ds_read_b128 v[136:139], v20 offset:10240
    ds_read_b128 v[140:143], v20 offset:11264
    s_waitcnt lgkmcnt(2)
    v_max3_u32 v21, v128, v130, v132
    s_waitcnt lgkmcnt(0)
    v_max3_u32 v22, v136, v138, v140
    v_max3_u32 v21, v21, v134, v142
    v_max_u32 v21, v21, v22
    v_cmp_eq_u32 vcc, -1, v21
    s_cbranch_vccnz K3_HR0_7
K3_HO0_7:
    s_barrier
    s_mov_b32 m0, 32768
    s_add_u32 s33, s63, 10
    s_and_b32 s33, s33, 15
    s_lshl_b32 s33, s33, 17
    buffer_load_dwordx4 v16, s[40:43], s33 offen offset:0 sc1 lds
    buffer_load_dwordx4 v17, s[40:43], s33 offen offset:1024 sc1 lds
    buffer_load_dwordx4 v18, s[40:43], s33 offen offset:2048 sc1 lds
    buffer_load_dwordx4 v19, s[40:43], s33 offen offset:3072 sc1 lds
    s_mov_b32 m0, 40960
    s_add_u32 s33, s63, 11
    s_and_b32 s33, s33, 15
    s_lshl_b32 s33, s33, 17
    buffer_load_dwordx4 v16, s[40:43], s33 offen offset:0 sc1 lds
    buffer_load_dwordx4 v17, s[40:43], s33 offen offset:1024 sc1 lds
    buffer_load_dwordx4 v18, s[40:43], s33 offen offset:2048 sc1 lds
    buffer_load_dwordx4 v19, s[40:43], s33 offen offset:3072 sc1 lds
    s_waitcnt vmcnt(12)
    ds_read_b128 v[128:131], v20 offset:16384
    ds_read_b128 v[132:135], v20 offset:17408
    ds_read_b128 v[136:139], v20 offset:18432
    ds_read_b128 v[140:143], v20 offset:19456
    s_waitcnt lgkmcnt(2)
    v_max3_u32 v21, v128, v130, v132
    s_waitcnt lgkmcnt(0)
    v_max3_u32 v22, v136, v138, v140
    v_max3_u32 v21, v21, v134, v142
    v_max_u32 v21, v21, v22
    v_cmp_eq_u32 vcc, -1, v21
    s_cbranch_vccnz K3_HR0_8
K3_HO0_8:
    s_waitcnt vmcnt(8)
    ds_read_b128 v[128:131], v20 offset:24576
    ds_read_b128 v[132:135], v20 offset:25600
    ds_read_b128 v[136:139], v20 offset:26624
    ds_read_b128 v[140:143], v20 offset:27648
    s_waitcnt lgkmcnt(2)
    v_max3_u32 v21, v128, v130, v132
    s_waitcnt lgkmcnt(0)
    v_max3_u32 v22, v136, v138, v140
    v_max3_u32 v21, v21, v134, v142
    v_max_u32 v21, v21, v22
    v_cmp_eq_u32 vcc, -1, v21
    s_cbranch_vccnz K3_HR0_9
K3_HO0_9:
    s_barrier
    s_mov_b32 m0, 0
    s_add_u32 s33, s63, 12
    s_and_b32 s33, s33, 15
    s_lshl_b32 s33, s33, 17
    buffer_load_dwordx4 v16, s[40:43], s33 offen offset:0 sc1 lds
    buffer_load_dwordx4 v17, s[40:43], s33 offen offset:1024 sc1 lds
    buffer_load_dwordx4 v18, s[40:43], s33 offen offset:2048 sc1 lds
    buffer_load_dwordx4 v19, s[40:43], s33 offen offset:3072 sc1 lds
    s_mov_b32 m0, 8192
    s_add_u32 s33, s63, 13
    s_and_b32 s33, s33, 15
    s_lshl_b32 s33, s33, 17
    buffer_load_dwordx4 v16, s[40:43], s33 offen offset:0 sc1 lds
    buffer_load_dwordx4 v17, s[40:43], s33 offen offset:1024 sc1 lds
    buffer_load_dwordx4 v18, s[40:43], s33 offen offset:2048 sc1 lds
    buffer_load_dwordx4 v19, s[40:43], s33 offen offset:3072 sc1 lds
    s_waitcnt vmcnt(12)
    ds_read_b128 v[128:131], v20 offset:32768
    ds_read_b128 v[132:135], v20 offset:33792
    ds_read_b128 v[136:139], v20 offset:34816
    ds_read_b128 v[140:143], v20 offset:35840
    s_waitcnt lgkmcnt(2)
    v_max3_u32 v21, v128, v130, v132
    s_waitcnt lgkmcnt(0)
    v_max3_u32 v22, v136, v138, v140
    v_max3_u32 v21, v21, v134, v142
    v_max_u32 v21, v21, v22
    v_cmp_eq_u32 vcc, -1, v21
    s_cbranch_vccnz K3_HR0_10
K3_HO0_10:
    s_waitcnt vmcnt(8)
    ds_read_b128 v[128:131], v20 offset:40960
    ds_read_b128 v[132:135], v20 offset:41984
    ds_read_b128 v[136:139], v20 offset:43008
    ds_read_b128 v[140:143], v20 offset:44032
    s_waitcnt lgkmcnt(2)
    v_max3_u32 v21, v128, v130, v132
    s_waitcnt lgkmcnt(0)
    v_max3_u32 v22, v136, v138, v140
    v_max3_u32 v21, v21, v134, v142
    v_max_u32 v21, v21, v22
    v_cmp_eq_u32 vcc, -1, v21
    s_cbranch_vccnz K3_HR0_11
K3_HO0_11:
    s_barrier
    s_mov_b32 m0, 16384
    s_add_u32 s33, s63, 14
    s_and_b32 s33, s33, 15
    s_lshl_b32 s33, s33, 17
    buffer_load_dwordx4 v16, s[40:43], s33 offen offset:0 sc1 lds
    buffer_load_dwordx4 v17, s[40:43], s33 offen offset:1024 sc1 lds
    buffer_load_dwordx4 v18, s[40:43], s33 offen offset:2048 sc1 lds
    buffer_load_dwordx4 v19, s[40:43], s33 offen offset:3072 sc1 lds
    s_mov_b32 m0, 24576
    s_add_u32 s33, s63, 15
    s_and_b32 s33, s33, 15
    s_lshl_b32 s33, s33, 17
    buffer_load_dwordx4 v16, s[40:43], s33 offen offset:0 sc1 lds
    buffer_load_dwordx4 v17, s[40:43], s33 offen offset:1024 sc1 lds
    buffer_load_dwordx4 v18, s[40:43], s33 offen offset:2048 sc1 lds
    buffer_load_dwordx4 v19, s[40:43], s33 offen offset:3072 sc1 lds
    s_waitcnt vmcnt(12)
    ds_read_b128 v[128:131], v20 offset:0
    ds_read_b128 v[132:135], v20 offset:1024
    ds_read_b128 v[136:139], v20 offset:2048
    ds_read_b128 v[140:143], v20 offset:3072
    s_waitcnt lgkmcnt(2)
    v_max3_u32 v21, v128, v130, v132
    s_waitcnt lgkmcnt(0)
    v_max3_u32 v22, v136, v138, v140
    v_max3_u32 v21, v21, v134, v142
    v_max_u32 v21, v21, v22
    v_cmp_eq_u32 vcc, -1, v21
    s_cbranch_vccnz K3_HR0_12
K3_HO0_12:
    s_waitcnt vmcnt(8)
    ds_read_b128 v[128:131], v20 offset:8192
    ds_read_b128 v[132:135], v20 offset:9216
    ds_read_b128 v[136:139], v20 offset:10240
    ds_read_b128 v[140:143], v20 offset:11264
    s_waitcnt lgkmcnt(2)
    v_max3_u32 v21, v128, v130, v132
    s_waitcnt lgkmcnt(0)
    v_max3_u32 v22, v136, v138, v140
    v_max3_u32 v21, v21, v134, v142
    v_max_u32 v21, v21, v22
    v_cmp_eq_u32 vcc, -1, v21
    s_cbranch_vccnz K3_HR0_13
K3_HO0_13:
    s_waitcnt vmcnt(4)
    ds_read_b128 v[128:131], v20 offset:16384
    ds_read_b128 v[132:135], v20 offset:17408
    ds_read_b128 v[136:139], v20 offset:18432
    ds_read_b128 v[140:143], v20 offset:19456
    s_waitcnt lgkmcnt(2)
    v_max3_u32 v21, v128, v130, v132
    s_waitcnt lgkmcnt(0)
    v_max3_u32 v22, v136, v138, v140
    v_max3_u32 v21, v21, v134, v142
    v_max_u32 v21, v21, v22
    v_cmp_eq_u32 vcc, -1, v21
    s_cbranch_vccnz K3_HR0_14
K3_HO0_14:
    s_waitcnt vmcnt(0)
    ds_read_b128 v[128:131], v20 offset:24576
    ds_read_b128 v[132:135], v20 offset:25600
    ds_read_b128 v[136:139], v20 offset:26624
    ds_read_b128 v[140:143], v20 offset:27648
    s_waitcnt lgkmcnt(2)
    v_max3_u32 v21, v128, v130, v132
    s_waitcnt lgkmcnt(0)
    v_max3_u32 v22, v136, v138, v140
    v_max3_u32 v21, v21, v134, v142
    v_max_u32 v21, v21, v22
    v_cmp_eq_u32 vcc, -1, v21
    s_cbranch_vccnz K3_HR0_15
K3_HO0_15:
    s_barrier
    s_setprio 0
K3_LT13A:
K3_LT13:
    s_add_u32 m0, s29, 32768
    s_add_u32 s36, s35, 0
    buffer_load_dwordx4 v24, s[44:47], s36 offen offset:0  lds
    buffer_load_dwordx4 v25, s[44:47], s36 offen offset:1024  lds
    buffer_load_dwordx4 v26, s[44:47], s36 offen offset:2048  lds
    buffer_load_dwordx4 v27, s[44:47], s36 offen offset:3072  lds
    s_add_u32 m0, s29, 36864
    s_add_u32 s36, s35, 32768
    buffer_load_dwordx4 v24, s[44:47], s36 offen offset:0  lds
    buffer_load_dwordx4 v25, s[44:47], s36 offen offset:1024  lds
    buffer_load_dwordx4 v26, s[44:47], s36 offen offset:2048  lds
    buffer_load_dwordx4 v27, s[44:47], s36 offen offset:3072  lds
    s_add_u32 m0, s29, 40960
    s_add_u32 s36, s35, 196608
    buffer_load_dwordx4 v24, s[44:47], s36 offen offset:0  lds
    buffer_load_dwordx4 v25, s[44:47], s36 offen offset:1024  lds
    buffer_load_dwordx4 v26, s[44:47], s36 offen offset:2048  lds
    buffer_load_dwordx4 v27, s[44:47], s36 offen offset:3072  lds
    s_add_u32 m0, s29, 45056
    s_add_u32 s36, s35, 229376
    buffer_load_dwordx4 v24, s[44:47], s36 offen offset:0  lds
    buffer_load_dwordx4 v25, s[44:47], s36 offen offset:1024  lds
    buffer_load_dwordx4 v26, s[44:47], s36 offen offset:2048  lds
    buffer_load_dwordx4 v27, s[44:47], s36 offen offset:3072  lds
    s_add_u32 s36, s35, 1179648
    buffer_load_dwordx4 v[32:35], v24, s[44:47], s36 offen offset:0
    buffer_load_dwordx4 v[36:39], v25, s[44:47], s36 offen offset:1024
    buffer_load_dwordx4 v[40:43], v26, s[44:47], s36 offen offset:2048
    buffer_load_dwordx4 v[44:47], v27, s[44:47], s36 offen offset:3072
    s_add_u32 s36, s35, 1212416
    buffer_load_dwordx4 v[48:51], v24, s[44:47], s36 offen offset:0
    buffer_load_dwordx4 v[52:55], v25, s[44:47], s36 offen offset:1024
    buffer_load_dwordx4 v[56:59], v26, s[44:47], s36 offen offset:2048
    buffer_load_dwordx4 v[60:63], v27, s[44:47], s36 offen offset:3072
    s_add_u32 s36, s35, 1376256
    buffer_load_dwordx4 v[64:67], v24, s[44:47], s36 offen offset:0
    buffer_load_dwordx4 v[68:71], v25, s[44:47], s36 offen offset:1024
    buffer_load_dwordx4 v[72:75], v26, s[44:47], s36 offen offset:2048
    buffer_load_dwordx4 v[76:79], v27, s[44:47], s36 offen offset:3072
    s_add_u32 s36, s35, 1409024
    buffer_load_dwordx4 v[80:83], v24, s[44:47], s36 offen offset:0
    buffer_load_dwordx4 v[84:87], v25, s[44:47], s36 offen offset:1024
    buffer_load_dwordx4 v[88:91], v26, s[44:47], s36 offen offset:2048
    buffer_load_dwordx4 v[92:95], v27, s[44:47], s36 offen offset:3072
    s_add_u32 s36, s35, 1572864
    buffer_load_dwordx4 v[96:99], v24, s[44:47], s36 offen offset:0
    buffer_load_dwordx4 v[100:103], v25, s[44:47], s36 offen offset:1024
    buffer_load_dwordx4 v[104:107], v26, s[44:47], s36 offen offset:2048
    buffer_load_dwordx4 v[108:111], v27, s[44:47], s36 offen offset:3072
    s_add_u32 s36, s35, 1605632
    buffer_load_dwordx4 v[112:115], v24, s[44:47], s36 offen offset:0
    buffer_load_dwordx4 v[116:119], v25, s[44:47], s36 offen offset:1024
    buffer_load_dwordx4 v[120:123], v26, s[44:47], s36 offen offset:2048
    buffer_load_dwordx4 v[124:127], v27, s[44:47], s36 offen offset:3072
    s_barrier
    s_add_u32 m0, s29, 0
    s_add_u32 s36, s35, 393216
    buffer_load_dwordx4 v24, s[44:47], s36 offen offset:0  lds
    buffer_load_dwordx4 v25, s[44:47], s36 offen offset:1024  lds
    buffer_load_dwordx4 v26, s[44:47], s36 offen offset:2048  lds
    buffer_load_dwordx4 v27, s[44:47], s36 offen offset:3072  lds
    s_add_u32 m0, s29, 4096
    s_add_u32 s36, s35, 425984
    buffer_load_dwordx4 v24, s[44:47], s36 offen offset:0  lds
    buffer_load_dwordx4 v25, s[44:47], s36 offen offset:1024  lds
    buffer_load_dwordx4 v26, s[44:47], s36 offen offset:2048  lds
    buffer_load_dwordx4 v27, s[44:47], s36 offen offset:3072  lds
    s_add_u32 m0, s29, 8192
    s_add_u32 s36, s35, 589824
    buffer_load_dwordx4 v24, s[44:47], s36 offen offset:0  lds
    buffer_load_dwordx4 v25, s[44:47], s36 offen offset:1024  lds
    buffer_load_dwordx4 v26, s[44:47], s36 offen offset:2048  lds
    buffer_load_dwordx4 v27, s[44:47], s36 offen offset:3072  lds
    s_add_u32 m0, s29, 12288
    s_add_u32 s36, s35, 622592
    buffer_load_dwordx4 v24, s[44:47], s36 offen offset:0  lds
    buffer_load_dwordx4 v25, s[44:47], s36 offen offset:1024  lds
    buffer_load_dwordx4 v26, s[44:47], s36 offen offset:2048  lds
    buffer_load_dwordx4 v27, s[44:47], s36 offen offset:3072  lds
    s_barrier
    s_add_u32 m0, s29, 16384
    s_add_u32 s36, s35, 786432
    buffer_load_dwordx4 v24, s[44:47], s36 offen offset:0  lds
    buffer_load_dwordx4 v25, s[44:47], s36 offen offset:1024  lds
    buffer_load_dwordx4 v26, s[44:47], s36 offen offset:2048  lds
    buffer_load_dwordx4 v27, s[44:47], s36 offen offset:3072  lds
    s_add_u32 m0, s29, 20480
    s_add_u32 s36, s35, 819200
    buffer_load_dwordx4 v24, s[44:47], s36 offen offset:0  lds
    buffer_load_dwordx4 v25, s[44:47], s36 offen offset:1024  lds
    buffer_load_dwordx4 v26, s[44:47], s36 offen offset:2048  lds
    buffer_load_dwordx4 v27, s[44:47], s36 offen offset:3072  lds
    s_add_u32 m0, s29, 24576
    s_add_u32 s36, s35, 983040
    buffer_load_dwordx4 v24, s[44:47], s36 offen offset:0  lds
    buffer_load_dwordx4 v25, s[44:47], s36 offen offset:1024  lds
    buffer_load_dwordx4 v26, s[44:47], s36 offen offset:2048  lds
    buffer_load_dwordx4 v27, s[44:47], s36 offen offset:3072  lds
    s_add_u32 m0, s29, 28672
    s_add_u32 s36, s35, 1015808
    buffer_load_dwordx4 v24, s[44:47], s36 offen offset:0  lds
    buffer_load_dwordx4 v25, s[44:47], s36 offen offset:1024  lds
    buffer_load_dwordx4 v26, s[44:47], s36 offen offset:2048  lds
    buffer_load_dwordx4 v27, s[44:47], s36 offen offset:3072  lds
    s_waitcnt vmcnt(0)
    s_barrier
    s_barrier
    ds_write_b128 v28, v[32:35] offset:32768
    ds_write_b128 v28, v[36:39] offset:33792
    ds_write_b128 v28, v[40:43] offset:34816
    ds_write_b128 v28, v[44:47] offset:35840
    ds_write_b128 v28, v[48:51] offset:36864
    ds_write_b128 v28, v[52:55] offset:37888
    ds_write_b128 v28, v[56:59] offset:38912
    ds_write_b128 v28, v[60:63] offset:39936
    ds_write_b128 v28, v[64:67] offset:40960
    ds_write_b128 v28, v[68:71] offset:41984
    ds_write_b128 v28, v[72:75] offset:43008
    ds_write_b128 v28, v[76:79] offset:44032
    ds_write_b128 v28, v[80:83] offset:45056
    ds_write_b128 v28, v[84:87] offset:46080
    ds_write_b128 v28, v[88:91] offset:47104
    ds_write_b128 v28, v[92:95] offset:48128
    s_barrier
    ds_write_b128 v28, v[96:99] offset:0
    ds_write_b128 v28, v[100:103] offset:1024
    ds_write_b128 v28, v[104:107] offset:2048
    ds_write_b128 v28, v[108:111] offset:3072
    ds_write_b128 v28, v[112:115] offset:4096
    ds_write_b128 v28, v[116:119] offset:5120
    ds_write_b128 v28, v[120:123] offset:6144
    ds_write_b128 v28, v[124:127] offset:7168
    s_waitcnt lgkmcnt(0)
    s_barrier
    s_endpgm
K3_HELP:
    s_mov_b32 s26, 0
    s_mov_b32 s29, 0
    v_lshrrev_b32 v29, 3, v1
    v_and_b32 v30, 7, v1
    v_and_b32 v31, 2, v29
    v_lshlrev_b32 v31, 1, v31
    v_xor_b32 v30, v30, v31
    v_bfe_u32 v31, v29, 2, 1
    v_lshlrev_b32 v31, 1, v31
    v_xor_b32 v30, v30, v31
    v_lshlrev_b32 v31, 10, v29
    v_lshl_add_u32 v24, v30, 4, v31
    v_add_u32 v25, 7168, v24
    v_add_u32 v26, 14336, v24
    v_add_u32 v27, 21504, v24
    s_lshl_b32 s35, s61, 7
    s_add_u32 s44, s16, s35
    s_addc_u32 s45, s17, 0
    s_sub_u32 s46, 1835008, s35
    s_mov_b32 s47, 0x20000
    s_lshl_b32 s35, s26, 16
    v_lshl_add_u32 v28, v1, 4, s29
    v_lshlrev_b32 v31, 12, v29
    v_lshl_add_u32 v12, v30, 4, v31
    v_add_u32 v13, 31744, v12
    v_add_u32 v14, 63488, v12
    v_add_u32 v15, 95232, v12
    s_lshl_b32 s30, s61, 18
    s_lshl_b32 s31, s60, 7
    s_add_u32 s30, s30, s31
    s_add_u32 s31, s30, 0x800000
    s_add_u32 s48, s14, s31
    s_addc_u32 s49, s15, 0
    s_sub_u32 s50, 0x200000, s30
    s_mov_b32 s51, 0x20000
    s_lshl_b32 s30, s60, 7
    s_add_u32 s30, s30, 0x1104000
    v_mov_b32 v2, s30
    s_lshl_b32 s30, s23, 8
    s_add_u32 s30, s30, 0x1104000
    v_writelane_b32 v2, s30, 1
    s_add_u32 s30, s30, 128
    v_writelane_b32 v2, s30, 2
    s_lshl_b32 s27, s23, 11
    s_add_u32 s27, s27, 0x1108000
    v_lshlrev_b32 v3, 4, v1
    v_add_u32 v10, 147456, v3
    v_add_u32 v11, s27, v3
    v_lshrrev_b32 v8, 5, v1
    v_mul_u32_u24 v8, 6656, v8
    s_lshl_b32 s28, s24, 9
    s_add_u32 s28, s28, 0x1120000
    v_add3_u32 v8, v8, v3, s28
    v_and_b32 v23, 7, v1
    v_lshlrev_b32 v23, 3, v23
    v_bfe_u32 v9, v1, 3, 1
    v_mul_u32_u24 v9, 896, v9
    s_lshl_b32 s28, s24, 6
    s_add_u32 s28, s28, 0x1140800
    v_add3_u32 v23, v23, v9, s28
    v_lshlrev_b32 v9, 12, v4
    v_lshl_add_u32 v6, v6, 4, v9
    v_lshl_add_u32 v7, v7, 4, v9
    v_add_u32 v16, 65536, v6
    v_add_u32 v17, 80896, v7
    v_add_u32 v18, 96256, v6
    v_add_u32 v19, 111616, v7
    v_lshlrev_b32 v20, 4, v1
    v_add_u32 v20, 4096, v20
    s_lshl_b32 s28, s23, 8
    s_add_u32 s30, s28, 0x800000
    s_add_u32 s40, s14, s30
    s_addc_u32 s41, s15, 0
    s_sub_u32 s42, 0x200000, s28
    s_mov_b32 s43, 0x20000
    v_mov_b32 v150, 35456
    v_lshlrev_b32 v151, 4, v1
    v_add_u32 v151, 0x1140000, v151
SY_8:
    s_sleep 2
    ds_read_b32 v152, v150 offset:8
    s_waitcnt lgkmcnt(0)
    v_cmp_gt_u32 vcc, 1, v152
    s_cbranch_vccnz SY_8
    global_load_dwordx4 v[152:155], v151, s[14:15] offset:0 sc1
    global_load_dwordx4 v[156:159], v151, s[14:15] offset:1024 sc1
    s_waitcnt vmcnt(0)
K3_PA:
    v_lshl_add_u64 v[152:153], v[152:153], 0, s[58:59]
    v_lshl_add_u64 v[154:155], v[154:155], 0, s[58:59]
    v_lshl_add_u64 v[156:157], v[156:157], 0, s[58:59]
    v_lshl_add_u64 v[158:159], v[158:159], 0, s[58:59]
    v_or3_b32 v153, v153, v155, v157
    v_or_b32 v153, v153, v159
    v_cmp_ne_u32 vcc, 0, v153
    s_cbranch_vccz K3_PA_OK
    s_add_u32 s5, s5, 1
    s_cmp_gt_u32 s5, 0x200000
    s_cbranch_scc1 K3_PA_OK
    s_sleep 2
    global_load_dwordx4 v[152:155], v151, s[14:15] offset:0 sc1
    global_load_dwordx4 v[156:159], v151, s[14:15] offset:1024 sc1
    s_waitcnt vmcnt(0)
    s_branch K3_PA
K3_PA_OK:
    s_barrier
    v_and_b32 v146, 7, v1
    s_lshl_b32 s30, s23, 3
    v_add_u32 v146, s30, v146
    v_mul_u32_u24 v146, 57344, v146
    s_lshl_b32 s30, s24, 12
    s_add_u32 s30, s30, 0xa00800
    v_add_u32 v146, s30, v146
    s_lshl_b32 s30, s60, 16
    s_add_u32 s30, s30, 32768
    v_mov_b32 v147, s30
    s_mov_b64 exec, 0xff
    global_load_dword v148, v146, s[14:15]
    s_mov_b64 exec, 1
    global_load_dword v148, v147, s[18:19]
    s_mov_b64 exec, -1
    s_waitcnt vmcnt(0)
    s_mov_b32 m0, 4096
    s_add_u32 s33, s63, 0
    s_and_b32 s33, s33, 15
    s_lshl_b32 s33, s33, 17
    buffer_load_dwordx4 v16, s[40:43], s33 offen offset:0 sc1 lds
    buffer_load_dwordx4 v17, s[40:43], s33 offen offset:1024 sc1 lds
    buffer_load_dwordx4 v18, s[40:43], s33 offen offset:2048 sc1 lds
    buffer_load_dwordx4 v19, s[40:43], s33 offen offset:3072 sc1 lds
    s_mov_b32 m0, 12288
    s_add_u32 s33, s63, 1
    s_and_b32 s33, s33, 15
    s_lshl_b32 s33, s33, 17
    buffer_load_dwordx4 v16, s[40:43], s33 offen offset:0 sc1 lds
    buffer_load_dwordx4 v17, s[40:43], s33 offen offset:1024 sc1 lds
    buffer_load_dwordx4 v18, s[40:43], s33 offen offset:2048 sc1 lds
    buffer_load_dwordx4 v19, s[40:43], s33 offen offset:3072 sc1 lds
    s_cmp_eq_u32 s4, 0
    s_cbranch_scc1 CSF_9
    s_lshl_b32 s30, s2, 3
    s_and_b32 s31, s20, 0
    s_lshl_b32 s31, s31, 3
    s_add_u32 s30, s30, s31
    s_add_u32 s30, s30, 0x1140800
    v_mov_b32 v146, s30
    v_mov_b32 v148, s6
    v_mov_b32 v149, s7
    s_mov_b64 exec, 1
    global_store_dwordx2 v146, v[148:149], s[14:15] sc1
    s_mov_b64 exec, -1
CSF_9:
    s_setprio 3
    s_waitcnt vmcnt(4)
    ds_read_b128 v[128:131], v20 offset:0
    ds_read_b128 v[132:135], v20 offset:1024
    ds_read_b128 v[136:139], v20 offset:2048
    ds_read_b128 v[140:143], v20 offset:3072
    s_waitcnt lgkmcnt(2)
    v_max3_u32 v21, v128, v130, v132
    s_waitcnt lgkmcnt(0)
    v_max3_u32 v22, v136, v138, v140
    v_max3_u32 v21, v21, v134, v142
    v_max_u32 v21, v21, v22
    v_cmp_eq_u32 vcc, -1, v21
    s_cbranch_vccnz K3_HR1_0
K3_HO1_0:
    s_barrier
    s_mov_b32 m0, 20480
    s_add_u32 s33, s63, 2
    s_and_b32 s33, s33, 15
    s_lshl_b32 s33, s33, 17
    buffer_load_dwordx4 v16, s[40:43], s33 offen offset:0 sc1 lds
    buffer_load_dwordx4 v17, s[40:43], s33 offen offset:1024 sc1 lds
    buffer_load_dwordx4 v18, s[40:43], s33 offen offset:2048 sc1 lds
    buffer_load_dwordx4 v19, s[40:43], s33 offen offset:3072 sc1 lds
    s_mov_b32 m0, 28672
    s_add_u32 s33, s63, 3
    s_and_b32 s33, s33, 15
    s_lshl_b32 s33, s33, 17
    buffer_load_dwordx4 v16, s[40:43], s33 offen offset:0 sc1 lds
    buffer_load_dwordx4 v17, s[40:43], s33 offen offset:1024 sc1 lds
    buffer_load_dwordx4 v18, s[40:43], s33 offen offset:2048 sc1 lds
    buffer_load_dwordx4 v19, s[40:43], s33 offen offset:3072 sc1 lds
    s_waitcnt vmcnt(8)
    ds_read_b128 v[128:131], v20 offset:8192
    ds_read_b128 v[132:135], v20 offset:9216
    ds_read_b128 v[136:139], v20 offset:10240
    ds_read_b128 v[140:143], v20 offset:11264
    s_waitcnt lgkmcnt(2)
    v_max3_u32 v21, v128, v130, v132
    s_waitcnt lgkmcnt(0)
    v_max3_u32 v22, v136, v138, v140
    v_max3_u32 v21, v21, v134, v142
    v_max_u32 v21, v21, v22
    v_cmp_eq_u32 vcc, -1, v21
    s_cbranch_vccnz K3_HR1_1
K3_HO1_1:
    s_barrier
    s_mov_b32 m0, 36864
    s_add_u32 s33, s63, 4
    s_and_b32 s33, s33, 15
    s_lshl_b32 s33, s33, 17
    buffer_load_dwordx4 v16, s[40:43], s33 offen offset:0 sc1 lds
    buffer_load_dwordx4 v17, s[40:43], s33 offen offset:1024 sc1 lds
    buffer_load_dwordx4 v18, s[40:43], s33 offen offset:2048 sc1 lds
    buffer_load_dwordx4 v19, s[40:43], s33 offen offset:3072 sc1 lds
    s_mov_b32 m0, 45056
    s_add_u32 s33, s63, 5
    s_and_b32 s33, s33, 15
    s_lshl_b32 s33, s33, 17
    buffer_load_dwordx4 v16, s[40:43], s33 offen offset:0 sc1 lds
    buffer_load_dwordx4 v17, s[40:43], s33 offen offset:1024 sc1 lds
    buffer_load_dwordx4 v18, s[40:43], s33 offen offset:2048 sc1 lds
    buffer_load_dwordx4 v19, s[40:43], s33 offen offset:3072 sc1 lds
    s_waitcnt vmcnt(12)
    ds_read_b128 v[128:131], v20 offset:16384
    ds_read_b128 v[132:135], v20 offset:17408
    ds_read_b128 v[136:139], v20 offset:18432
    ds_read_b128 v[140:143], v20 offset:19456
    s_waitcnt lgkmcnt(2)
    v_max3_u32 v21, v128, v130, v132
    s_waitcnt lgkmcnt(0)
    v_max3_u32 v22, v136, v138, v140
    v_max3_u32 v21, v21, v134, v142
    v_max_u32 v21, v21, v22
    v_cmp_eq_u32 vcc, -1, v21
    s_cbranch_vccnz K3_HR1_2
K3_HO1_2:
    s_waitcnt vmcnt(8)
    ds_read_b128 v[128:131], v20 offset:24576
    ds_read_b128 v[132:135], v20 offset:25600
    ds_read_b128 v[136:139], v20 offset:26624
    ds_read_b128 v[140:143], v20 offset:27648
    s_waitcnt lgkmcnt(2)
    v_max3_u32 v21, v128, v130, v132
    s_waitcnt lgkmcnt(0)
    v_max3_u32 v22, v136, v138, v140
    v_max3_u32 v21, v21, v134, v142
    v_max_u32 v21, v21, v22
    v_cmp_eq_u32 vcc, -1, v21
    s_cbranch_vccnz K3_HR1_3
K3_HO1_3:
    s_barrier
    s_mov_b32 m0, 4096
    s_add_u32 s33, s63, 6
    s_and_b32 s33, s33, 15
    s_lshl_b32 s33, s33, 17
    buffer_load_dwordx4 v16, s[40:43], s33 offen offset:0 sc1 lds
    buffer_load_dwordx4 v17, s[40:43], s33 offen offset:1024 sc1 lds
    buffer_load_dwordx4 v18, s[40:43], s33 offen offset:2048 sc1 lds
    buffer_load_dwordx4 v19, s[40:43], s33 offen offset:3072 sc1 lds
    s_mov_b32 m0, 12288
    s_add_u32 s33, s63, 7
    s_and_b32 s33, s33, 15
    s_lshl_b32 s33, s33, 17
    buffer_load_dwordx4 v16, s[40:43], s33 offen offset:0 sc1 lds
    buffer_load_dwordx4 v17, s[40:43], s33 offen offset:1024 sc1 lds
    buffer_load_dwordx4 v18, s[40:43], s33 offen offset:2048 sc1 lds
    buffer_load_dwordx4 v19, s[40:43], s33 offen offset:3072 sc1 lds
    s_waitcnt vmcnt(12)
    ds_read_b128 v[128:131], v20 offset:32768
    ds_read_b128 v[132:135], v20 offset:33792
    ds_read_b128 v[136:139], v20 offset:34816
    ds_read_b128 v[140:143], v20 offset:35840
    s_waitcnt lgkmcnt(2)
    v_max3_u32 v21, v128, v130, v132
    s_waitcnt lgkmcnt(0)
    v_max3_u32 v22, v136, v138, v140
    v_max3_u32 v21, v21, v134, v142
    v_max_u32 v21, v21, v22
    v_cmp_eq_u32 vcc, -1, v21
    s_cbranch_vccnz K3_HR1_4
K3_HO1_4:
    s_waitcnt vmcnt(8)
    ds_read_b128 v[128:131], v20 offset:40960
    ds_read_b128 v[132:135], v20 offset:41984
    ds_read_b128 v[136:139], v20 offset:43008
    ds_read_b128 v[140:143], v20 offset:44032
    s_waitcnt lgkmcnt(2)
    v_max3_u32 v21, v128, v130, v132
    s_waitcnt lgkmcnt(0)
    v_max3_u32 v22, v136, v138, v140
    v_max3_u32 v21, v21, v134, v142
    v_max_u32 v21, v21, v22
    v_cmp_eq_u32 vcc, -1, v21
    s_cbranch_vccnz K3_HR1_5
K3_HO1_5:
    s_barrier
    s_mov_b32 m0, 20480
    s_add_u32 s33, s63, 8
    s_and_b32 s33, s33, 15
    s_lshl_b32 s33, s33, 17
    buffer_load_dwordx4 v16, s[40:43], s33 offen offset:0 sc1 lds
    buffer_load_dwordx4 v17, s[40:43], s33 offen offset:1024 sc1 lds
    buffer_load_dwordx4 v18, s[40:43], s33 offen offset:2048 sc1 lds
    buffer_load_dwordx4 v19, s[40:43], s33 offen offset:3072 sc1 lds
    s_mov_b32 m0, 28672
    s_add_u32 s33, s63, 9
    s_and_b32 s33, s33, 15
    s_lshl_b32 s33, s33, 17
    buffer_load_dwordx4 v16, s[40:43], s33 offen offset:0 sc1 lds
    buffer_load_dwordx4 v17, s[40:43], s33 offen offset:1024 sc1 lds
    buffer_load_dwordx4 v18, s[40:43], s33 offen offset:2048 sc1 lds
    buffer_load_dwordx4 v19, s[40:43], s33 offen offset:3072 sc1 lds
    global_load_dwordx2 v[108:109], v23, s[14:15] sc1
    s_waitcnt vmcnt(13)
    ds_read_b128 v[128:131], v20 offset:0
    ds_read_b128 v[132:135], v20 offset:1024
    ds_read_b128 v[136:139], v20 offset:2048
    ds_read_b128 v[140:143], v20 offset:3072
    s_waitcnt lgkmcnt(2)
    v_max3_u32 v21, v128, v130, v132
    s_waitcnt lgkmcnt(0)
    v_max3_u32 v22, v136, v138, v140
    v_max3_u32 v21, v21, v134, v142
    v_max_u32 v21, v21, v22
    v_cmp_eq_u32 vcc, -1, v21
    s_cbranch_vccnz K3_HR1_6
K3_HO1_6:
    s_waitcnt vmcnt(9)
    ds_read_b128 v[128:131], v20 offset:8192
    ds_read_b128 v[132:135], v20 offset:9216
    ds_read_b128 v[136:139], v20 offset:10240
    ds_read_b128 v[140:143], v20 offset:11264
    s_waitcnt lgkmcnt(2)
    v_max3_u32 v21, v128, v130, v132
    s_waitcnt lgkmcnt(0)
    v_max3_u32 v22, v136, v138, v140
    v_max3_u32 v21, v21, v134, v142
    v_max_u32 v21, v21, v22
    v_cmp_eq_u32 vcc, -1, v21
    s_cbranch_vccnz K3_HR1_7
K3_HO1_7:
    s_barrier
    s_mov_b32 m0, 36864
    s_add_u32 s33, s63, 10
    s_and_b32 s33, s33, 15
    s_lshl_b32 s33, s33, 17
    buffer_load_dwordx4 v16, s[40:43], s33 offen offset:0 sc1 lds
    buffer_load_dwordx4 v17, s[40:43], s33 offen offset:1024 sc1 lds
    buffer_load_dwordx4 v18, s[40:43], s33 offen offset:2048 sc1 lds
    buffer_load_dwordx4 v19, s[40:43], s33 offen offset:3072 sc1 lds
    s_mov_b32 m0, 45056
    s_add_u32 s33, s63, 11
    s_and_b32 s33, s33, 15
    s_lshl_b32 s33, s33, 17
    buffer_load_dwordx4 v16, s[40:43], s33 offen offset:0 sc1 lds
    buffer_load_dwordx4 v17, s[40:43], s33 offen offset:1024 sc1 lds
    buffer_load_dwordx4 v18, s[40:43], s33 offen offset:2048 sc1 lds
    buffer_load_dwordx4 v19, s[40:43], s33 offen offset:3072 sc1 lds
    s_waitcnt vmcnt(8)
K3_PG:
    v_lshl_add_u64 v[108:109], v[108:109], 0, s[58:59]
    v_cmp_ne_u32 vcc, 0, v109
    s_cbranch_vccz K3_PG_OK
    s_add_u32 s5, s5, 1
    s_cmp_gt_u32 s5, 0x200000
    s_cbranch_scc1 K3_PG_OK
    s_sleep 4
    global_load_dwordx2 v[108:109], v23, s[14:15] sc1
    s_waitcnt vmcnt(0)
    s_branch K3_PG
K3_PG_OK:
    global_load_dwordx4 v[64:67], v8, s[14:15] sc1
    v_add_u32 v8, 14336, v8
    global_load_dwordx4 v[68:71], v8, s[14:15] sc1
    v_add_u32 v8, 14336, v8
    global_load_dwordx4 v[72:75], v8, s[14:15] sc1
    v_add_u32 v8, 14336, v8
    global_load_dwordx4 v[76:79], v8, s[14:15] sc1
    v_add_u32 v8, 14336, v8
    s_waitcnt vmcnt(17)
    ds_read_b128 v[128:131], v20 offset:16384
    ds_read_b128 v[132:135], v20 offset:17408
    ds_read_b128 v[136:139], v20 offset:18432
    ds_read_b128 v[140:143], v20 offset:19456
    s_waitcnt lgkmcnt(2)
    v_max3_u32 v21, v128, v130, v132
    s_waitcnt lgkmcnt(0)
    v_max3_u32 v22, v136, v138, v140
    v_max3_u32 v21, v21, v134, v142
    v_max_u32 v21, v21, v22
    v_cmp_eq_u32 vcc, -1, v21
    s_cbranch_vccnz K3_HR1_8
K3_HO1_8:
    s_waitcnt vmcnt(13)
    ds_read_b128 v[128:131], v20 offset:24576
    ds_read_b128 v[132:135], v20 offset:25600
    ds_read_b128 v[136:139], v20 offset:26624
    ds_read_b128 v[140:143], v20 offset:27648
    s_waitcnt lgkmcnt(2)
    v_max3_u32 v21, v128, v130, v132
    s_waitcnt lgkmcnt(0)
    v_max3_u32 v22, v136, v138, v140
    v_max3_u32 v21, v21, v134, v142
    v_max_u32 v21, v21, v22
    v_cmp_eq_u32 vcc, -1, v21
    s_cbranch_vccnz K3_HR1_9
K3_HO1_9:
    s_barrier
    s_mov_b32 m0, 4096
    s_add_u32 s33, s63, 12
    s_and_b32 s33, s33, 15
    s_lshl_b32 s33, s33, 17
    buffer_load_dwordx4 v16, s[40:43], s33 offen offset:0 sc1 lds
    buffer_load_dwordx4 v17, s[40:43], s33 offen offset:1024 sc1 lds
    buffer_load_dwordx4 v18, s[40:43], s33 offen offset:2048 sc1 lds
    buffer_load_dwordx4 v19, s[40:43], s33 offen offset:3072 sc1 lds
    s_mov_b32 m0, 12288
    s_add_u32 s33, s63, 13
    s_and_b32 s33, s33, 15
    s_lshl_b32 s33, s33, 17
    buffer_load_dwordx4 v16, s[40:43], s33 offen offset:0 sc1 lds
    buffer_load_dwordx4 v17, s[40:43], s33 offen offset:1024 sc1 lds
    buffer_load_dwordx4 v18, s[40:43], s33 offen offset:2048 sc1 lds
    buffer_load_dwordx4 v19, s[40:43], s33 offen offset:3072 sc1 lds
    global_load_dwordx4 v[80:83], v8, s[14:15] sc1
    v_add_u32 v8, 14336, v8
    global_load_dwordx4 v[84:87], v8, s[14:15] sc1
    v_add_u32 v8, 14336, v8
    global_load_dwordx4 v[88:91], v8, s[14:15] sc1
    v_add_u32 v8, 14336, v8
    global_load_dwordx4 v[92:95], v8, s[14:15] sc1
    v_add_u32 v8, 14336, v8
    s_waitcnt vmcnt(20)
    ds_read_b128 v[128:131], v20 offset:32768
    ds_read_b128 v[132:135], v20 offset:33792
    ds_read_b128 v[136:139], v20 offset:34816
    ds_read_b128 v[140:143], v20 offset:35840
    s_waitcnt lgkmcnt(2)
    v_max3_u32 v21, v128, v130, v132
    s_waitcnt lgkmcnt(0)
    v_max3_u32 v22, v136, v138, v140
    v_max3_u32 v21, v21, v134, v142
    v_max_u32 v21, v21, v22
    v_cmp_eq_u32 vcc, -1, v21
    s_cbranch_vccnz K3_HR1_10
K3_HO1_10:
    s_waitcnt vmcnt(16)
    ds_read_b128 v[128:131], v20 offset:40960
    ds_read_b128 v[132:135], v20 offset:41984
    ds_read_b128 v[136:139], v20 offset:43008
    ds_read_b128 v[140:143], v20 offset:44032
    s_waitcnt lgkmcnt(2)
    v_max3_u32 v21, v128, v130, v132
    s_waitcnt lgkmcnt(0)
    v_max3_u32 v22, v136, v138, v140
    v_max3_u32 v21, v21, v134, v142
    v_max_u32 v21, v21, v22
    v_cmp_eq_u32 vcc, -1, v21
    s_cbranch_vccnz K3_HR1_11
K3_HO1_11:
    s_barrier
    s_mov_b32 m0, 20480
    s_add_u32 s33, s63, 14
    s_and_b32 s33, s33, 15
    s_lshl_b32 s33, s33, 17
    buffer_load_dwordx4 v16, s[40:43], s33 offen offset:0 sc1 lds
    buffer_load_dwordx4 v17, s[40:43], s33 offen offset:1024 sc1 lds
    buffer_load_dwordx4 v18, s[40:43], s33 offen offset:2048 sc1 lds
    buffer_load_dwordx4 v19, s[40:43], s33 offen offset:3072 sc1 lds
    s_mov_b32 m0, 28672
    s_add_u32 s33, s63, 15
    s_and_b32 s33, s33, 15
    s_lshl_b32 s33, s33, 17
    buffer_load_dwordx4 v16, s[40:43], s33 offen offset:0 sc1 lds
    buffer_load_dwordx4 v17, s[40:43], s33 offen offset:1024 sc1 lds
    buffer_load_dwordx4 v18, s[40:43], s33 offen offset:2048 sc1 lds
    buffer_load_dwordx4 v19, s[40:43], s33 offen offset:3072 sc1 lds
    global_load_dwordx2 v[104:105], v2, s[14:15] sc1
    s_waitcnt vmcnt(17)
    ds_read_b128 v[128:131], v20 offset:0
    ds_read_b128 v[132:135], v20 offset:1024
    ds_read_b128 v[136:139], v20 offset:2048
    ds_read_b128 v[140:143], v20 offset:3072
    s_waitcnt lgkmcnt(2)
    v_max3_u32 v21, v128, v130, v132
    s_waitcnt lgkmcnt(0)
    v_max3_u32 v22, v136, v138, v140
    v_max3_u32 v21, v21, v134, v142
    v_max_u32 v21, v21, v22
    v_cmp_eq_u32 vcc, -1, v21
    s_cbranch_vccnz K3_HR1_12
K3_HO1_12:
    s_waitcnt vmcnt(13)
    ds_read_b128 v[128:131], v20 offset:8192
    ds_read_b128 v[132:135], v20 offset:9216
    ds_read_b128 v[136:139], v20 offset:10240
    ds_read_b128 v[140:143], v20 offset:11264
    s_waitcnt lgkmcnt(2)
    v_max3_u32 v21, v128, v130, v132
    s_waitcnt lgkmcnt(0)
    v_max3_u32 v22, v136, v138, v140
    v_max3_u32 v21, v21, v134, v142
    v_max_u32 v21, v21, v22
    v_cmp_eq_u32 vcc, -1, v21
    s_cbranch_vccnz K3_HR1_13
K3_HO1_13:
    s_waitcnt vmcnt(5)
    ds_read_b128 v[128:131], v20 offset:16384
    ds_read_b128 v[132:135], v20 offset:17408
    ds_read_b128 v[136:139], v20 offset:18432
    ds_read_b128 v[140:143], v20 offset:19456
    s_waitcnt lgkmcnt(2)
    v_max3_u32 v21, v128, v130, v132
    s_waitcnt lgkmcnt(0)
    v_max3_u32 v22, v136, v138, v140
    v_max3_u32 v21, v21, v134, v142
    v_max_u32 v21, v21, v22
    v_cmp_eq_u32 vcc, -1, v21
    s_cbranch_vccnz K3_HR1_14
K3_HO1_14:
    s_waitcnt vmcnt(1)
    ds_read_b128 v[128:131], v20 offset:24576
    ds_read_b128 v[132:135], v20 offset:25600
    ds_read_b128 v[136:139], v20 offset:26624
    ds_read_b128 v[140:143], v20 offset:27648
    s_waitcnt lgkmcnt(2)
    v_max3_u32 v21, v128, v130, v132
    s_waitcnt lgkmcnt(0)
    v_max3_u32 v22, v136, v138, v140
    v_max3_u32 v21, v21, v134, v142
    v_max_u32 v21, v21, v22
    v_cmp_eq_u32 vcc, -1, v21
    s_cbranch_vccnz K3_HR1_15
K3_HO1_15:
    s_barrier
    s_waitcnt vmcnt(0)
K3_PS:
    v_lshl_add_u64 v[104:105], v[104:105], 0, s[58:59]
    v_cmp_ne_u32 vcc, 0, v105
    s_cbranch_vccz K3_PS_OK
    s_add_u32 s5, s5, 1
    s_cmp_gt_u32 s5, 0x200000
    s_cbranch_scc1 K3_PS_OK
    s_sleep 4
    global_load_dwordx2 v[104:105], v2, s[14:15] sc1
    s_waitcnt vmcnt(0)
    s_branch K3_PS
K3_PS_OK:
    global_load_dwordx4 v[96:99], v11, s[14:15] sc1
    global_load_dwordx4 v[100:103], v11, s[14:15] offset:1024 sc1
    s_mov_b32 m0, 150528
    s_mov_b32 s36, 0
    buffer_load_dwordx4 v12, s[48:51], s36 offen offset:0 sc1 lds
    buffer_load_dwordx4 v13, s[48:51], s36 offen offset:1024 sc1 lds
    buffer_load_dwordx4 v14, s[48:51], s36 offen offset:2048 sc1 lds
    buffer_load_dwordx4 v15, s[48:51], s36 offen offset:3072 sc1 lds
    s_mov_b32 m0, 154624
    s_mov_b32 s36, 131072
    buffer_load_dwordx4 v12, s[48:51], s36 offen offset:0 sc1 lds
    buffer_load_dwordx4 v13, s[48:51], s36 offen offset:1024 sc1 lds
    buffer_load_dwordx4 v14, s[48:51], s36 offen offset:2048 sc1 lds
    buffer_load_dwordx4 v15, s[48:51], s36 offen offset:3072 sc1 lds
    s_setprio 0
    s_waitcnt vmcnt(10)
    v_add_f32 v64, v64, v80
    v_add_f32 v65, v65, v81
    v_add_f32 v66, v66, v82
    v_add_f32 v67, v67, v83
    v_add_f32 v68, v68, v84
    v_add_f32 v69, v69, v85
    v_add_f32 v70, v70, v86
    v_add_f32 v71, v71, v87
    v_add_f32 v72, v72, v88
    v_add_f32 v73, v73, v89
    v_add_f32 v74, v74, v90
    v_add_f32 v75, v75, v91
    v_add_f32 v76, v76, v92
    v_add_f32 v77, v77, v93
    v_add_f32 v78, v78, v94
    v_add_f32 v79, v79, v95
    v_add_f32 v64, v64, v72
    v_add_f32 v65, v65, v73
    v_add_f32 v66, v66, v74
    v_add_f32 v67, v67, v75
    v_add_f32 v68, v68, v76
    v_add_f32 v69, v69, v77
    v_add_f32 v70, v70, v78
    v_add_f32 v71, v71, v79
    v_add_f32 v64, v64, v68
    v_add_f32 v65, v65, v69
    v_add_f32 v66, v66, v70
    v_add_f32 v67, v67, v71
    ds_write_b128 v10, v[64:67] offset:2048
    s_waitcnt vmcnt(8)
    ds_write_b128 v10, v[96:99]
    ds_write_b128 v10, v[100:103] offset:1024
K3_HT2:
    s_waitcnt vmcnt(0) lgkmcnt(0)
    s_barrier
    s_mov_b32 s36, 1769472
    buffer_load_dwordx4 v[32:35], v24, s[44:47], s36 offen offset:0
    buffer_load_dwordx4 v[36:39], v25, s[44:47], s36 offen offset:1024
    buffer_load_dwordx4 v[40:43], v26, s[44:47], s36 offen offset:2048
    buffer_load_dwordx4 v[44:47], v27, s[44:47], s36 offen offset:3072
    s_mov_b32 s36, 1802240
    buffer_load_dwordx4 v[48:51], v24, s[44:47], s36 offen offset:0
    buffer_load_dwordx4 v[52:55], v25, s[44:47], s36 offen offset:1024
    buffer_load_dwordx4 v[56:59], v26, s[44:47], s36 offen offset:2048
    buffer_load_dwordx4 v[60:63], v27, s[44:47], s36 offen offset:3072
    s_barrier
    s_barrier
    s_barrier
    s_barrier
    s_waitcnt vmcnt(0)
    ds_write_b128 v28, v[32:35] offset:8192
    ds_write_b128 v28, v[36:39] offset:9216
    ds_write_b128 v28, v[40:43] offset:10240
    ds_write_b128 v28, v[44:47] offset:11264
    ds_write_b128 v28, v[48:51] offset:12288
    ds_write_b128 v28, v[52:55] offset:13312
    ds_write_b128 v28, v[56:59] offset:14336
    ds_write_b128 v28, v[60:63] offset:15360
    s_waitcnt lgkmcnt(0)
    s_barrier
    s_endpgm
K3_SPARE:
    s_lshl_b32 s23, s21, 2
    s_add_u32 s23, s23, s22
    v_lshrrev_b32 v2, 3, v1
    v_and_b32 v3, 7, v1
    v_lshlrev_b32 v4, 12, v2
    v_lshl_add_u32 v4, v3, 4, v4
    s_lshl_b32 s24, s20, 18
    s_lshl_b32 s25, s23, 7
    s_add_u32 s24, s24, s25
    s_add_u32 s24, s24, 0x800000
    s_add_u32 s40, s14, s24
    s_addc_u32 s41, s15, 0
    s_mov_b32 s42, 262144
    s_mov_b32 s43, 0x20000
    v_lshrrev_b32 v5, 2, v1
    v_and_b32 v6, 3, v1
    v_lshlrev_b32 v5, 10, v5
    v_lshl_add_u32 v5, v6, 7, v5
    s_mul_i32 s24, s22, 458752
    s_mul_i32 s25, s20, 57344
    s_add_u32 s24, s24, s25
    s_and_b32 s25, s21, 1
    s_lshl_b32 s25, s25, 9
    s_add_u32 s24, s24, s25
    s_add_u32 s52, s16, s24
    s_addc_u32 s53, s17, 0
    s_sub_u32 s54, 1835008, s24
    s_min_u32 s54, s54, 57344
    s_mov_b32 s55, 0x20000
    s_cmp_lg_u32 s20, 7
    s_cbranch_scc1 K3_SP0
    v_mov_b32 v150, 35456
    v_lshlrev_b32 v151, 4, v1
    v_add_u32 v151, 0x1140000, v151
SY_10:
    s_sleep 2
    ds_read_b32 v152, v150 offset:8
    s_waitcnt lgkmcnt(0)
    v_cmp_gt_u32 vcc, 1, v152
    s_cbranch_vccnz SY_10
    global_load_dwordx4 v[152:155], v151, s[14:15] offset:0 sc1
    global_load_dwordx4 v[156:159], v151, s[14:15] offset:1024 sc1
    s_waitcnt vmcnt(0)
K3_PB:
    v_lshl_add_u64 v[152:153], v[152:153], 0, s[58:59]
    v_lshl_add_u64 v[154:155], v[154:155], 0, s[58:59]
    v_lshl_add_u64 v[156:157], v[156:157], 0, s[58:59]
    v_lshl_add_u64 v[158:159], v[158:159], 0, s[58:59]
    v_or3_b32 v153, v153, v155, v157
    v_or_b32 v153, v153, v159
    v_cmp_ne_u32 vcc, 0, v153
    s_cbranch_vccz K3_PB_OK
    s_add_u32 s5, s5, 1
    s_cmp_gt_u32 s5, 0x200000
    s_cbranch_scc1 K3_PB_OK
    s_sleep 2
    global_load_dwordx4 v[152:155], v151, s[14:15] offset:0 sc1
    global_load_dwordx4 v[156:159], v151, s[14:15] offset:1024 sc1
    s_waitcnt vmcnt(0)
    s_branch K3_PB
K3_PB_OK:
K3_SP0:
    s_waitcnt vmcnt(0)
    s_barrier
    s_cmp_lt_u32 s20, 4
    s_cbranch_scc1 K3_SP1
    s_cmp_eq_u32 s4, 0
    s_cbranch_scc1 CSF_11
    s_lshl_b32 s30, s2, 3
    s_and_b32 s31, s20, 0
    s_lshl_b32 s31, s31, 3
    s_add_u32 s30, s30, s31
    s_add_u32 s30, s30, 0x1140800
    v_mov_b32 v146, s30
    v_mov_b32 v148, s6
    v_mov_b32 v149, s7
    s_mov_b64 exec, 1
    global_store_dwordx2 v146, v[148:149], s[14:15] sc1
    s_mov_b64 exec, -1
CSF_11:
K3_SP1:
    s_mov_b32 s26, 0
    buffer_load_dword v8, v5, s[52:55], s26 offen
    s_waitcnt vmcnt(0)
K3_SPL:
    s_mov_b32 s26, 0
    buffer_load_dwordx4 v[16:19], v4, s[40:43], s26 offen sc1
    s_mov_b32 s26, 32768
    buffer_load_dwordx4 v[20:23], v4, s[40:43], s26 offen sc1
    s_mov_b32 s26, 65536
    buffer_load_dwordx4 v[24:27], v4, s[40:43], s26 offen sc1
    s_mov_b32 s26, 98304
    buffer_load_dwordx4 v[28:31], v4, s[40:43], s26 offen sc1
    s_mov_b32 s26, 131072
    buffer_load_dwordx4 v[32:35], v4, s[40:43], s26 offen sc1
    s_mov_b32 s26, 163840
    buffer_load_dwordx4 v[36:39], v4, s[40:43], s26 offen sc1
    s_mov_b32 s26, 196608
    buffer_load_dwordx4 v[40:43], v4, s[40:43], s26 offen sc1
    s_mov_b32 s26, 229376
    buffer_load_dwordx4 v[44:47], v4, s[40:43], s26 offen sc1
    v_mov_b32 v72, 0
    v_mov_b32 v48, 0
    v_mov_b32 v49, 0
    v_mov_b32 v50, 0
    v_mov_b32 v51, 0
    v_mov_b32 v52, 0
    v_mov_b32 v53, 0
    v_mov_b32 v54, 0
    v_mov_b32 v55, 0
    v_mov_b32 v56, 0
    v_mov_b32 v57, 0
    v_mov_b32 v58, 0
    v_mov_b32 v59, 0
    v_mov_b32 v60, 0
    v_mov_b32 v61, 0
    v_mov_b32 v62, 0
    v_mov_b32 v63, 0
    s_waitcnt vmcnt(7)
    v_max3_u32 v72, v72, v16, v18
    v_lshlrev_b32 v64, 16, v16
    v_and_b32 v65, s37, v16
    v_lshlrev_b32 v66, 16, v17
    v_and_b32 v67, s37, v17
    v_lshlrev_b32 v68, 16, v18
    v_and_b32 v69, s37, v18
    v_lshlrev_b32 v70, 16, v19
    v_and_b32 v71, s37, v19
    v_pk_add_f32 v[48:49], v[48:49], v[64:65]
    v_pk_fma_f32 v[56:57], v[64:65], v[64:65], v[56:57]
    v_pk_add_f32 v[50:51], v[50:51], v[66:67]
    v_pk_fma_f32 v[58:59], v[66:67], v[66:67], v[58:59]
    v_pk_add_f32 v[52:53], v[52:53], v[68:69]
    v_pk_fma_f32 v[60:61], v[68:69], v[68:69], v[60:61]
    v_pk_add_f32 v[54:55], v[54:55], v[70:71]
    v_pk_fma_f32 v[62:63], v[70:71], v[70:71], v[62:63]
    s_waitcnt vmcnt(6)
    v_max3_u32 v72, v72, v20, v22
    v_lshlrev_b32 v64, 16, v20
    v_and_b32 v65, s37, v20
    v_lshlrev_b32 v66, 16, v21
    v_and_b32 v67, s37, v21
    v_lshlrev_b32 v68, 16, v22
    v_and_b32 v69, s37, v22
    v_lshlrev_b32 v70, 16, v23
    v_and_b32 v71, s37, v23
    v_pk_add_f32 v[48:49], v[48:49], v[64:65]
    v_pk_fma_f32 v[56:57], v[64:65], v[64:65], v[56:57]
    v_pk_add_f32 v[50:51], v[50:51], v[66:67]
    v_pk_fma_f32 v[58:59], v[66:67], v[66:67], v[58:59]
    v_pk_add_f32 v[52:53], v[52:53], v[68:69]
    v_pk_fma_f32 v[60:61], v[68:69], v[68:69], v[60:61]
    v_pk_add_f32 v[54:55], v[54:55], v[70:71]
    v_pk_fma_f32 v[62:63], v[70:71], v[70:71], v[62:63]
    s_waitcnt vmcnt(5)
    v_max3_u32 v72, v72, v24, v26
    v_lshlrev_b32 v64, 16, v24
    v_and_b32 v65, s37, v24
    v_lshlrev_b32 v66, 16, v25
    v_and_b32 v67, s37, v25
    v_lshlrev_b32 v68, 16, v26
    v_and_b32 v69, s37, v26
    v_lshlrev_b32 v70, 16, v27
    v_and_b32 v71, s37, v27
    v_pk_add_f32 v[48:49], v[48:49], v[64:65]
    v_pk_fma_f32 v[56:57], v[64:65], v[64:65], v[56:57]
    v_pk_add_f32 v[50:51], v[50:51], v[66:67]
    v_pk_fma_f32 v[58:59], v[66:67], v[66:67], v[58:59]
    v_pk_add_f32 v[52:53], v[52:53], v[68:69]
    v_pk_fma_f32 v[60:61], v[68:69], v[68:69], v[60:61]
    v_pk_add_f32 v[54:55], v[54:55], v[70:71]
    v_pk_fma_f32 v[62:63], v[70:71], v[70:71], v[62:63]
    s_waitcnt vmcnt(4)
    v_max3_u32 v72, v72, v28, v30
    v_lshlrev_b32 v64, 16, v28
    v_and_b32 v65, s37, v28
    v_lshlrev_b32 v66, 16, v29
    v_and_b32 v67, s37, v29
    v_lshlrev_b32 v68, 16, v30
    v_and_b32 v69, s37, v30
    v_lshlrev_b32 v70, 16, v31
    v_and_b32 v71, s37, v31
    v_pk_add_f32 v[48:49], v[48:49], v[64:65]
    v_pk_fma_f32 v[56:57], v[64:65], v[64:65], v[56:57]
    v_pk_add_f32 v[50:51], v[50:51], v[66:67]
    v_pk_fma_f32 v[58:59], v[66:67], v[66:67], v[58:59]
    v_pk_add_f32 v[52:53], v[52:53], v[68:69]
    v_pk_fma_f32 v[60:61], v[68:69], v[68:69], v[60:61]
    v_pk_add_f32 v[54:55], v[54:55], v[70:71]
    v_pk_fma_f32 v[62:63], v[70:71], v[70:71], v[62:63]
    s_waitcnt vmcnt(3)
    v_max3_u32 v72, v72, v32, v34
    v_lshlrev_b32 v64, 16, v32
    v_and_b32 v65, s37, v32
    v_lshlrev_b32 v66, 16, v33
    v_and_b32 v67, s37, v33
    v_lshlrev_b32 v68, 16, v34
    v_and_b32 v69, s37, v34
    v_lshlrev_b32 v70, 16, v35
    v_and_b32 v71, s37, v35
    v_pk_add_f32 v[48:49], v[48:49], v[64:65]
    v_pk_fma_f32 v[56:57], v[64:65], v[64:65], v[56:57]
    v_pk_add_f32 v[50:51], v[50:51], v[66:67]
    v_pk_fma_f32 v[58:59], v[66:67], v[66:67], v[58:59]
    v_pk_add_f32 v[52:53], v[52:53], v[68:69]
    v_pk_fma_f32 v[60:61], v[68:69], v[68:69], v[60:61]
    v_pk_add_f32 v[54:55], v[54:55], v[70:71]
    v_pk_fma_f32 v[62:63], v[70:71], v[70:71], v[62:63]
    s_waitcnt vmcnt(2)
    v_max3_u32 v72, v72, v36, v38
    v_lshlrev_b32 v64, 16, v36
    v_and_b32 v65, s37, v36
    v_lshlrev_b32 v66, 16, v37
    v_and_b32 v67, s37, v37
    v_lshlrev_b32 v68, 16, v38
    v_and_b32 v69, s37, v38
    v_lshlrev_b32 v70, 16, v39
    v_and_b32 v71, s37, v39
    v_pk_add_f32 v[48:49], v[48:49], v[64:65]
    v_pk_fma_f32 v[56:57], v[64:65], v[64:65], v[56:57]
    v_pk_add_f32 v[50:51], v[50:51], v[66:67]
    v_pk_fma_f32 v[58:59], v[66:67], v[66:67], v[58:59]
    v_pk_add_f32 v[52:53], v[52:53], v[68:69]
    v_pk_fma_f32 v[60:61], v[68:69], v[68:69], v[60:61]
    v_pk_add_f32 v[54:55], v[54:55], v[70:71]
    v_pk_fma_f32 v[62:63], v[70:71], v[70:71], v[62:63]
    s_waitcnt vmcnt(1)
    v_max3_u32 v72, v72, v40, v42
    v_lshlrev_b32 v64, 16, v40
    v_and_b32 v65, s37, v40
    v_lshlrev_b32 v66, 16, v41
    v_and_b32 v67, s37, v41
    v_lshlrev_b32 v68, 16, v42
    v_and_b32 v69, s37, v42
    v_lshlrev_b32 v70, 16, v43
    v_and_b32 v71, s37, v43
    v_pk_add_f32 v[48:49], v[48:49], v[64:65]
    v_pk_fma_f32 v[56:57], v[64:65], v[64:65], v[56:57]
    v_pk_add_f32 v[50:51], v[50:51], v[66:67]
    v_pk_fma_f32 v[58:59], v[66:67], v[66:67], v[58:59]
    v_pk_add_f32 v[52:53], v[52:53], v[68:69]
    v_pk_fma_f32 v[60:61], v[68:69], v[68:69], v[60:61]
    v_pk_add_f32 v[54:55], v[54:55], v[70:71]
    v_pk_fma_f32 v[62:63], v[70:71], v[70:71], v[62:63]
    s_waitcnt vmcnt(0)
    v_max3_u32 v72, v72, v44, v46
    v_lshlrev_b32 v64, 16, v44
    v_and_b32 v65, s37, v44
    v_lshlrev_b32 v66, 16, v45
    v_and_b32 v67, s37, v45
    v_lshlrev_b32 v68, 16, v46
    v_and_b32 v69, s37, v46
    v_lshlrev_b32 v70, 16, v47
    v_and_b32 v71, s37, v47
    v_pk_add_f32 v[48:49], v[48:49], v[64:65]
    v_pk_fma_f32 v[56:57], v[64:65], v[64:65], v[56:57]
    v_pk_add_f32 v[50:51], v[50:51], v[66:67]
    v_pk_fma_f32 v[58:59], v[66:67], v[66:67], v[58:59]
    v_pk_add_f32 v[52:53], v[52:53], v[68:69]
    v_pk_fma_f32 v[60:61], v[68:69], v[68:69], v[60:61]
    v_pk_add_f32 v[54:55], v[54:55], v[70:71]
    v_pk_fma_f32 v[62:63], v[70:71], v[70:71], v[62:63]
    s_add_u32 s5, s5, 1
    s_cmp_gt_u32 s5, 0x200000
    s_cbranch_scc1 K3_SPX
    v_cmp_eq_u32 vcc, -1, v72
    s_cbranch_vccnz K3_SPL
K3_SPX:
    v_lshrrev_b32 v6, 3, v0
    v_lshlrev_b32 v6, 9, v6
    v_lshl_add_u32 v6, v3, 5, v6
    ds_write_b128 v6, v[48:51]
    ds_write_b128 v6, v[52:55] offset:16
    ds_write_b128 v6, v[56:59] offset:256
    ds_write_b128 v6, v[60:63] offset:272
    s_lshl_b32 s24, s20, 12
    v_lshl_add_u32 v7, v1, 2, s24
    s_lshl_b32 s24, s20, 9
    s_add_u32 s24, s24, 32768
    v_lshl_add_u32 v12, v1, 3, s24
    v_lshlrev_b32 v13, 3, v1
    s_waitcnt lgkmcnt(0)
    s_barrier
    ds_read2st64_b32 v[16:17], v7 offset0:0 offset1:1
    ds_read2st64_b32 v[18:19], v7 offset0:2 offset1:3
    ds_read2st64_b32 v[20:21], v7 offset0:4 offset1:5
    ds_read2st64_b32 v[22:23], v7 offset0:6 offset1:7
    ds_read2st64_b32 v[24:25], v7 offset0:8 offset1:9
    ds_read2st64_b32 v[26:27], v7 offset0:10 offset1:11
    ds_read2st64_b32 v[28:29], v7 offset0:12 offset1:13
    ds_read2st64_b32 v[30:31], v7 offset0:14 offset1:15
    s_waitcnt lgkmcnt(0)
    v_pk_add_f32 v[16:17], v[16:17], v[24:25]
    v_pk_add_f32 v[18:19], v[18:19], v[26:27]
    v_pk_add_f32 v[20:21], v[20:21], v[28:29]
    v_pk_add_f32 v[22:23], v[22:23], v[30:31]
    v_pk_add_f32 v[16:17], v[16:17], v[20:21]
    v_pk_add_f32 v[18:19], v[18:19], v[22:23]
    v_pk_add_f32 v[16:17], v[16:17], v[18:19]
    ds_write_b64 v12, v[16:17]
    s_waitcnt lgkmcnt(0)
    s_barrier
    s_cmp_lg_u32 s20, 0
    s_cbranch_scc1 K3_SP2
    ds_read_b64 v[32:33], v13 offset:32768
    ds_read_b64 v[34:35], v13 offset:33280
    ds_read_b64 v[36:37], v13 offset:33792
    ds_read_b64 v[38:39], v13 offset:34304
    ds_read_b64 v[40:41], v13 offset:34816
    ds_read_b64 v[42:43], v13 offset:35328
    ds_read_b64 v[44:45], v13 offset:35840
    ds_read_b64 v[46:47], v13 offset:36352
    s_lshl_b32 s24, s23, 10
    s_add_u32 s24, s24, 0x1108000
    v_lshl_add_u32 v14, v1, 4, s24
    s_lshl_b32 s24, s23, 7
    s_add_u32 s24, s24, 0x1104000
    v_mov_b32 v250, s24
    s_waitcnt lgkmcnt(0)
    v_pk_add_f32 v[32:33], v[32:33], v[40:41]
    v_pk_add_f32 v[34:35], v[34:35], v[42:43]
    v_pk_add_f32 v[36:37], v[36:37], v[44:45]
    v_pk_add_f32 v[38:39], v[38:39], v[46:47]
    v_pk_add_f32 v[32:33], v[32:33], v[36:37]
    v_pk_add_f32 v[34:35], v[34:35], v[38:39]
    v_pk_add_f32 v[32:33], v[32:33], v[34:35]
    v_mul_f32 v32, 0x3b000000, v32
    v_mul_f32 v33, 0x3b000000, v33
    v_fma_f32 v33, -v32, v32, v33
    v_max_f32 v33, 0, v33
    v_cvt_pk_bf16_f32 v34, -v32, v33
    v_lshlrev_b32 v36, 16, v34
    v_and_b32 v34, s37, v34
    v_add_f32 v34, 0x3727c5ac, v34
    v_cvt_pk_bf16_f32 v34, v34, v34
    v_lshlrev_b32 v34, 16, v34
    v_sqrt_f32 v34, v34
    s_nop 0
    v_cvt_pk_bf16_f32 v34, v34, v34
    v_lshlrev_b32 v34, 16, v34
    v_rcp_f32 v38, v34
    v_mul_f32 v39, v34, v34
    v_mov_b32 v37, 0
    v_mul_f32 v38, 0xbfb8aa3b, v38
    global_store_dwordx4 v14, v[36:39], s[14:15] sc1
    v_mov_b32 v252, s6
    v_mov_b32 v253, s7
    s_waitcnt vmcnt(0)
    s_mov_b64 exec, 1
    global_store_dwordx2 v250, v[252:253], s[14:15] sc1
    s_mov_b64 exec, -1
K3_SP2:
    s_barrier
    s_mov_b32 s26, 16384
    buffer_load_dword v9, v5, s[52:55], s26 offen
    s_mov_b32 s26, 32768
    buffer_load_dword v10, v5, s[52:55], s26 offen
    s_mov_b32 s26, 49152
    buffer_load_dword v11, v5, s[52:55], s26 offen
    s_waitcnt vmcnt(0)
    s_cmp_lt_u32 s20, 4
    s_cbranch_scc1 K3_SP3
    s_cmp_eq_u32 s20, 7
    s_cbranch_scc1 K3_SP4
    s_sub_u32 s26, s20, 4
    s_mul_i32 s29, s26, 49152
    v_lshrrev_b32 v29, 3, v1
    v_and_b32 v30, 7, v1
    v_and_b32 v31, 2, v29
    v_lshlrev_b32 v31, 1, v31
    v_xor_b32 v30, v30, v31
    v_bfe_u32 v31, v29, 2, 1
    v_lshlrev_b32 v31, 1, v31
    v_xor_b32 v30, v30, v31
    v_lshlrev_b32 v31, 10, v29
    v_lshl_add_u32 v24, v30, 4, v31
    v_add_u32 v25, 7168, v24
    v_add_u32 v26, 14336, v24
    v_add_u32 v27, 21504, v24
    s_lshl_b32 s35, s61, 7
    s_add_u32 s44, s16, s35
    s_addc_u32 s45, s17, 0
    s_sub_u32 s46, 1835008, s35
    s_mov_b32 s47, 0x20000
    s_lshl_b32 s35, s26, 16
    v_lshl_add_u32 v28, v1, 4, s29
    s_branch K3_LT13A
K3_SP4:
    s_mov_b32 s26, 0
    s_mov_b32 s29, 0
    v_lshrrev_b32 v29, 3, v1
    v_and_b32 v30, 7, v1
    v_and_b32 v31, 2, v29
    v_lshlrev_b32 v31, 1, v31
    v_xor_b32 v30, v30, v31
    v_bfe_u32 v31, v29, 2, 1
    v_lshlrev_b32 v31, 1, v31
    v_xor_b32 v30, v30, v31
    v_lshlrev_b32 v31, 10, v29
    v_lshl_add_u32 v24, v30, 4, v31
    v_add_u32 v25, 7168, v24
    v_add_u32 v26, 14336, v24
    v_add_u32 v27, 21504, v24
    s_lshl_b32 s35, s61, 7
    s_add_u32 s44, s16, s35
    s_addc_u32 s45, s17, 0
    s_sub_u32 s46, 1835008, s35
    s_mov_b32 s47, 0x20000
    s_lshl_b32 s35, s26, 16
    v_lshl_add_u32 v28, v1, 4, s29
    v_lshlrev_b32 v31, 12, v29
    v_lshl_add_u32 v12, v30, 4, v31
    v_add_u32 v13, 31744, v12
    v_add_u32 v14, 63488, v12
    v_add_u32 v15, 95232, v12
    s_lshl_b32 s30, s61, 18
    s_lshl_b32 s31, s60, 7
    s_add_u32 s30, s30, s31
    s_add_u32 s31, s30, 0x800000
    s_add_u32 s48, s14, s31
    s_addc_u32 s49, s15, 0
    s_sub_u32 s50, 0x200000, s30
    s_mov_b32 s51, 0x20000
    s_lshl_b32 s30, s60, 7
    s_add_u32 s30, s30, 0x1104000
    v_mov_b32 v2, s30
    global_load_dwordx2 v[104:105], v2, s[14:15] sc1
    s_waitcnt vmcnt(0)
K3_PT:
    v_lshl_add_u64 v[104:105], v[104:105], 0, s[58:59]
    v_cmp_ne_u32 vcc, 0, v105
    s_cbranch_vccz K3_PT_OK
    s_add_u32 s5, s5, 1
    s_cmp_gt_u32 s5, 0x200000
    s_cbranch_scc1 K3_PT_OK
    s_sleep 4
    global_load_dwordx2 v[104:105], v2, s[14:15] sc1
    s_waitcnt vmcnt(0)
    s_branch K3_PT
K3_PT_OK:
    s_mov_b32 m0, 150528
    s_mov_b32 s36, 0
    buffer_load_dwordx4 v12, s[48:51], s36 offen offset:0 sc1 lds
    buffer_load_dwordx4 v13, s[48:51], s36 offen offset:1024 sc1 lds
    buffer_load_dwordx4 v14, s[48:51], s36 offen offset:2048 sc1 lds
    buffer_load_dwordx4 v15, s[48:51], s36 offen offset:3072 sc1 lds
    s_mov_b32 m0, 154624
    s_mov_b32 s36, 131072
    buffer_load_dwordx4 v12, s[48:51], s36 offen offset:0 sc1 lds
    buffer_load_dwordx4 v13, s[48:51], s36 offen offset:1024 sc1 lds
    buffer_load_dwordx4 v14, s[48:51], s36 offen offset:2048 sc1 lds
    buffer_load_dwordx4 v15, s[48:51], s36 offen offset:3072 sc1 lds
    s_branch K3_HT2
K3_SP3:
    s_barrier
    s_branch K3_P2
K3_COMP:
    s_and_b32 s26, s20, 1
    s_lshr_b32 s27, s20, 1
    v_lshrrev_b32 v17, 2, v1
    v_and_b32 v18, 3, v1
    v_and_b32 v19, 7, v17
    v_lshlrev_b32 v20, 8, v17
    v_lshl_add_u32 v20, v18, 3, v20
    s_lshl_b32 s28, s26, 2
    s_lshl_b32 s30, s27, 2
    s_add_u32 s29, s28, 0
    v_xor_b32 v21, s29, v19
    v_lshl_add_u32 v2, v21, 5, v20
    s_add_u32 s29, s30, 0
    v_xor_b32 v21, s29, v19
    v_lshl_add_u32 v21, v21, 5, v20
    v_add_u32 v6, 49152, v21
    v_add_u32 v10, 98304, v21
    s_add_u32 s29, s28, 1
    v_xor_b32 v21, s29, v19
    v_lshl_add_u32 v3, v21, 5, v20
    s_add_u32 s29, s30, 1
    v_xor_b32 v21, s29, v19
    v_lshl_add_u32 v21, v21, 5, v20
    v_add_u32 v7, 49152, v21
    v_add_u32 v11, 98304, v21
    s_add_u32 s29, s28, 2
    v_xor_b32 v21, s29, v19
    v_lshl_add_u32 v4, v21, 5, v20
    s_add_u32 s29, s30, 2
    v_xor_b32 v21, s29, v19
    v_lshl_add_u32 v21, v21, 5, v20
    v_add_u32 v8, 49152, v21
    v_add_u32 v12, 98304, v21
    s_add_u32 s29, s28, 3
    v_xor_b32 v21, s29, v19
    v_lshl_add_u32 v5, v21, 5, v20
    s_add_u32 s29, s30, 3
    v_xor_b32 v21, s29, v19
    v_lshl_add_u32 v21, v21, 5, v20
    v_add_u32 v9, 49152, v21
    v_add_u32 v13, 98304, v21
    v_lshrrev_b32 v17, 4, v1
    v_and_b32 v18, 15, v1
    s_lshl_b32 s28, s27, 8
    s_add_u32 s28, s28, 149504
    v_lshl_add_u32 v14, v17, 4, s28
    s_lshl_b32 s29, s26, 10
    s_add_u32 s29, s29, 147456
    v_lshl_add_u32 v15, v18, 4, s29
    v_lshlrev_b32 v16, 4, v1
    s_lshl_b32 s29, s23, 3
    s_lshl_b32 s30, s26, 2
    s_add_u32 s29, s29, s30
    s_mul_i32 s29, s29, 57344
    s_lshl_b32 s30, s24, 12
    s_add_u32 s29, s29, s30
    s_lshl_b32 s30, s27, 11
    s_add_u32 s29, s29, s30
    s_add_u32 s29, s29, 0xa00000
    s_add_u32 s42, s14, s29
    s_addc_u32 s43, s15, 0
    s_add_u32 s44, s42, 0xe000
    s_addc_u32 s45, s43, 0
    s_add_u32 s46, s44, 0xe000
    s_addc_u32 s47, s45, 0
    s_add_u32 s48, s46, 0xe000
    s_addc_u32 s49, s47, 0
    s_waitcnt vmcnt(0)
    s_barrier
    s_barrier
    ds_read_b64_tr_b16 v[160:161], v2 offset:0
    ds_read_b64_tr_b16 v[162:163], v2 offset:4096
    ds_read_b64_tr_b16 v[176:177], v6 offset:0
    ds_read_b64_tr_b16 v[178:179], v6 offset:4096
    ds_read_b64_tr_b16 v[164:165], v3 offset:0
    ds_read_b64_tr_b16 v[166:167], v3 offset:4096
    ds_read_b64_tr_b16 v[168:169], v4 offset:0
    ds_read_b64_tr_b16 v[170:171], v4 offset:4096
    ds_read_b64_tr_b16 v[172:173], v5 offset:0
    ds_read_b64_tr_b16 v[174:175], v5 offset:4096
    ds_read_b64_tr_b16 v[192:193], v10 offset:0
    ds_read_b64_tr_b16 v[194:195], v10 offset:4096
    ds_read_b64_tr_b16 v[180:181], v7 offset:0
    ds_read_b64_tr_b16 v[182:183], v7 offset:4096
    ds_read_b64_tr_b16 v[196:197], v11 offset:0
    ds_read_b64_tr_b16 v[198:199], v11 offset:4096
    ds_read_b64_tr_b16 v[184:185], v8 offset:0
    ds_read_b64_tr_b16 v[186:187], v8 offset:4096
    ds_read_b64_tr_b16 v[200:201], v12 offset:0
    ds_read_b64_tr_b16 v[202:203], v12 offset:4096
    ds_read_b64_tr_b16 v[188:189], v9 offset:0
    ds_read_b64_tr_b16 v[190:191], v9 offset:4096
    ds_read_b64_tr_b16 v[204:205], v13 offset:0
    ds_read_b64_tr_b16 v[206:207], v13 offset:4096
    s_waitcnt lgkmcnt(0)
    s_barrier
    v_mfma_f32_16x16x32_bf16 v[32:35], v[176:179], v[160:163], 0
    ds_read_b64_tr_b16 v[208:209], v2 offset:8192
    v_mfma_f32_16x16x32_bf16 v[36:39], v[176:179], v[164:167], 0
    ds_read_b64_tr_b16 v[210:211], v2 offset:12288
    v_mfma_f32_16x16x32_bf16 v[40:43], v[176:179], v[168:171], 0
    ds_read_b64_tr_b16 v[224:225], v6 offset:8192
    v_mfma_f32_16x16x32_bf16 v[44:47], v[176:179], v[172:175], 0
    ds_read_b64_tr_b16 v[226:227], v6 offset:12288
    v_mfma_f32_16x16x32_bf16 v[96:99], v[192:195], v[160:163], 0
    ds_read_b64_tr_b16 v[212:213], v3 offset:8192
    v_mfma_f32_16x16x32_bf16 v[100:103], v[192:195], v[164:167], 0
    ds_read_b64_tr_b16 v[214:215], v3 offset:12288
    v_mfma_f32_16x16x32_bf16 v[104:107], v[192:195], v[168:171], 0
    ds_read_b64_tr_b16 v[216:217], v4 offset:8192
    v_mfma_f32_16x16x32_bf16 v[108:111], v[192:195], v[172:175], 0
    ds_read_b64_tr_b16 v[218:219], v4 offset:12288
    v_mfma_f32_16x16x32_bf16 v[48:51], v[180:183], v[160:163], 0
    ds_read_b64_tr_b16 v[220:221], v5 offset:8192
    v_mfma_f32_16x16x32_bf16 v[52:55], v[180:183], v[164:167], 0
    ds_read_b64_tr_b16 v[222:223], v5 offset:12288
    v_mfma_f32_16x16x32_bf16 v[56:59], v[180:183], v[168:171], 0
    ds_read_b64_tr_b16 v[240:241], v10 offset:8192
    v_mfma_f32_16x16x32_bf16 v[60:63], v[180:183], v[172:175], 0
    ds_read_b64_tr_b16 v[242:243], v10 offset:12288
    v_mfma_f32_16x16x32_bf16 v[112:115], v[196:199], v[160:163], 0
    ds_read_b64_tr_b16 v[228:229], v7 offset:8192
    v_mfma_f32_16x16x32_bf16 v[116:119], v[196:199], v[164:167], 0
    ds_read_b64_tr_b16 v[230:231], v7 offset:12288
    v_mfma_f32_16x16x32_bf16 v[120:123], v[196:199], v[168:171], 0
    ds_read_b64_tr_b16 v[244:245], v11 offset:8192
    v_mfma_f32_16x16x32_bf16 v[124:127], v[196:199], v[172:175], 0
    ds_read_b64_tr_b16 v[246:247], v11 offset:12288
    v_mfma_f32_16x16x32_bf16 v[64:67], v[184:187], v[160:163], 0
    ds_read_b64_tr_b16 v[232:233], v8 offset:8192
    v_mfma_f32_16x16x32_bf16 v[68:71], v[184:187], v[164:167], 0
    ds_read_b64_tr_b16 v[234:235], v8 offset:12288
    v_mfma_f32_16x16x32_bf16 v[72:75], v[184:187], v[168:171], 0
    ds_read_b64_tr_b16 v[248:249], v12 offset:8192
    v_mfma_f32_16x16x32_bf16 v[76:79], v[184:187], v[172:175], 0
    ds_read_b64_tr_b16 v[250:251], v12 offset:12288
    v_mfma_f32_16x16x32_bf16 v[128:131], v[200:203], v[160:163], 0
    ds_read_b64_tr_b16 v[236:237], v9 offset:8192
    v_mfma_f32_16x16x32_bf16 v[132:135], v[200:203], v[164:167], 0
    ds_read_b64_tr_b16 v[238:239], v9 offset:12288
    v_mfma_f32_16x16x32_bf16 v[136:139], v[200:203], v[168:171], 0
    ds_read_b64_tr_b16 v[252:253], v13 offset:8192
    v_mfma_f32_16x16x32_bf16 v[140:143], v[200:203], v[172:175], 0
    ds_read_b64_tr_b16 v[254:255], v13 offset:12288
    v_mfma_f32_16x16x32_bf16 v[80:83], v[188:191], v[160:163], 0
    v_mfma_f32_16x16x32_bf16 v[84:87], v[188:191], v[164:167], 0
    v_mfma_f32_16x16x32_bf16 v[88:91], v[188:191], v[168:171], 0
    v_mfma_f32_16x16x32_bf16 v[92:95], v[188:191], v[172:175], 0
    v_mfma_f32_16x16x32_bf16 v[144:147], v[204:207], v[160:163], 0
    v_mfma_f32_16x16x32_bf16 v[148:151], v[204:207], v[164:167], 0
    v_mfma_f32_16x16x32_bf16 v[152:155], v[204:207], v[168:171], 0
    v_mfma_f32_16x16x32_bf16 v[156:159], v[204:207], v[172:175], 0
    s_waitcnt lgkmcnt(0)
    s_barrier
    v_mfma_f32_16x16x32_bf16 v[32:35], v[224:227], v[208:211], v[32:35]
    ds_read_b64_tr_b16 v[160:161], v2 offset:16384
    v_mfma_f32_16x16x32_bf16 v[36:39], v[224:227], v[212:215], v[36:39]
    ds_read_b64_tr_b16 v[162:163], v2 offset:20480
    v_mfma_f32_16x16x32_bf16 v[40:43], v[224:227], v[216:219], v[40:43]
    ds_read_b64_tr_b16 v[176:177], v6 offset:16384
    v_mfma_f32_16x16x32_bf16 v[44:47], v[224:227], v[220:223], v[44:47]
    ds_read_b64_tr_b16 v[178:179], v6 offset:20480
    v_mfma_f32_16x16x32_bf16 v[96:99], v[240:243], v[208:211], v[96:99]
    ds_read_b64_tr_b16 v[164:165], v3 offset:16384
    v_mfma_f32_16x16x32_bf16 v[100:103], v[240:243], v[212:215], v[100:103]
    ds_read_b64_tr_b16 v[166:167], v3 offset:20480
    v_mfma_f32_16x16x32_bf16 v[104:107], v[240:243], v[216:219], v[104:107]
    ds_read_b64_tr_b16 v[168:169], v4 offset:16384
    v_mfma_f32_16x16x32_bf16 v[108:111], v[240:243], v[220:223], v[108:111]
    ds_read_b64_tr_b16 v[170:171], v4 offset:20480
    v_mfma_f32_16x16x32_bf16 v[48:51], v[228:231], v[208:211], v[48:51]
    ds_read_b64_tr_b16 v[172:173], v5 offset:16384
    v_mfma_f32_16x16x32_bf16 v[52:55], v[228:231], v[212:215], v[52:55]
    ds_read_b64_tr_b16 v[174:175], v5 offset:20480
    v_mfma_f32_16x16x32_bf16 v[56:59], v[228:231], v[216:219], v[56:59]
    ds_read_b64_tr_b16 v[192:193], v10 offset:16384
    v_mfma_f32_16x16x32_bf16 v[60:63], v[228:231], v[220:223], v[60:63]
    ds_read_b64_tr_b16 v[194:195], v10 offset:20480
    v_mfma_f32_16x16x32_bf16 v[112:115], v[244:247], v[208:211], v[112:115]
    ds_read_b64_tr_b16 v[180:181], v7 offset:16384
    v_mfma_f32_16x16x32_bf16 v[116:119], v[244:247], v[212:215], v[116:119]
    ds_read_b64_tr_b16 v[182:183], v7 offset:20480
    v_mfma_f32_16x16x32_bf16 v[120:123], v[244:247], v[216:219], v[120:123]
    ds_read_b64_tr_b16 v[196:197], v11 offset:16384
    v_mfma_f32_16x16x32_bf16 v[124:127], v[244:247], v[220:223], v[124:127]
    ds_read_b64_tr_b16 v[198:199], v11 offset:20480
    v_mfma_f32_16x16x32_bf16 v[64:67], v[232:235], v[208:211], v[64:67]
    ds_read_b64_tr_b16 v[184:185], v8 offset:16384
    v_mfma_f32_16x16x32_bf16 v[68:71], v[232:235], v[212:215], v[68:71]
    ds_read_b64_tr_b16 v[186:187], v8 offset:20480
    v_mfma_f32_16x16x32_bf16 v[72:75], v[232:235], v[216:219], v[72:75]
    ds_read_b64_tr_b16 v[200:201], v12 offset:16384
    v_mfma_f32_16x16x32_bf16 v[76:79], v[232:235], v[220:223], v[76:79]
    ds_read_b64_tr_b16 v[202:203], v12 offset:20480
    v_mfma_f32_16x16x32_bf16 v[128:131], v[248:251], v[208:211], v[128:131]
    ds_read_b64_tr_b16 v[188:189], v9 offset:16384
    v_mfma_f32_16x16x32_bf16 v[132:135], v[248:251], v[212:215], v[132:135]
    ds_read_b64_tr_b16 v[190:191], v9 offset:20480
    v_mfma_f32_16x16x32_bf16 v[136:139], v[248:251], v[216:219], v[136:139]
    ds_read_b64_tr_b16 v[204:205], v13 offset:16384
    v_mfma_f32_16x16x32_bf16 v[140:143], v[248:251], v[220:223], v[140:143]
    ds_read_b64_tr_b16 v[206:207], v13 offset:20480
    v_mfma_f32_16x16x32_bf16 v[80:83], v[236:239], v[208:211], v[80:83]
    v_mfma_f32_16x16x32_bf16 v[84:87], v[236:239], v[212:215], v[84:87]
    v_mfma_f32_16x16x32_bf16 v[88:91], v[236:239], v[216:219], v[88:91]
    v_mfma_f32_16x16x32_bf16 v[92:95], v[236:239], v[220:223], v[92:95]
    v_mfma_f32_16x16x32_bf16 v[144:147], v[252:255], v[208:211], v[144:147]
    v_mfma_f32_16x16x32_bf16 v[148:151], v[252:255], v[212:215], v[148:151]
    v_mfma_f32_16x16x32_bf16 v[152:155], v[252:255], v[216:219], v[152:155]
    v_mfma_f32_16x16x32_bf16 v[156:159], v[252:255], v[220:223], v[156:159]
    s_waitcnt lgkmcnt(0)
    v_mfma_f32_16x16x32_bf16 v[32:35], v[176:179], v[160:163], v[32:35]
    ds_read_b64_tr_b16 v[208:209], v2 offset:24576
    v_mfma_f32_16x16x32_bf16 v[36:39], v[176:179], v[164:167], v[36:39]
    ds_read_b64_tr_b16 v[210:211], v2 offset:28672
    v_mfma_f32_16x16x32_bf16 v[40:43], v[176:179], v[168:171], v[40:43]
    ds_read_b64_tr_b16 v[224:225], v6 offset:24576
    v_mfma_f32_16x16x32_bf16 v[44:47], v[176:179], v[172:175], v[44:47]
    ds_read_b64_tr_b16 v[226:227], v6 offset:28672
    v_mfma_f32_16x16x32_bf16 v[96:99], v[192:195], v[160:163], v[96:99]
    ds_read_b64_tr_b16 v[212:213], v3 offset:24576
    v_mfma_f32_16x16x32_bf16 v[100:103], v[192:195], v[164:167], v[100:103]
    ds_read_b64_tr_b16 v[214:215], v3 offset:28672
    v_mfma_f32_16x16x32_bf16 v[104:107], v[192:195], v[168:171], v[104:107]
    ds_read_b64_tr_b16 v[216:217], v4 offset:24576
    v_mfma_f32_16x16x32_bf16 v[108:111], v[192:195], v[172:175], v[108:111]
    ds_read_b64_tr_b16 v[218:219], v4 offset:28672
    v_mfma_f32_16x16x32_bf16 v[48:51], v[180:183], v[160:163], v[48:51]
    ds_read_b64_tr_b16 v[220:221], v5 offset:24576
    v_mfma_f32_16x16x32_bf16 v[52:55], v[180:183], v[164:167], v[52:55]
    ds_read_b64_tr_b16 v[222:223], v5 offset:28672
    v_mfma_f32_16x16x32_bf16 v[56:59], v[180:183], v[168:171], v[56:59]
    ds_read_b64_tr_b16 v[240:241], v10 offset:24576
    v_mfma_f32_16x16x32_bf16 v[60:63], v[180:183], v[172:175], v[60:63]
    ds_read_b64_tr_b16 v[242:243], v10 offset:28672
    v_mfma_f32_16x16x32_bf16 v[112:115], v[196:199], v[160:163], v[112:115]
    ds_read_b64_tr_b16 v[228:229], v7 offset:24576
    v_mfma_f32_16x16x32_bf16 v[116:119], v[196:199], v[164:167], v[116:119]
    ds_read_b64_tr_b16 v[230:231], v7 offset:28672
    v_mfma_f32_16x16x32_bf16 v[120:123], v[196:199], v[168:171], v[120:123]
    ds_read_b64_tr_b16 v[244:245], v11 offset:24576
    v_mfma_f32_16x16x32_bf16 v[124:127], v[196:199], v[172:175], v[124:127]
    ds_read_b64_tr_b16 v[246:247], v11 offset:28672
    v_mfma_f32_16x16x32_bf16 v[64:67], v[184:187], v[160:163], v[64:67]
    ds_read_b64_tr_b16 v[232:233], v8 offset:24576
    v_mfma_f32_16x16x32_bf16 v[68:71], v[184:187], v[164:167], v[68:71]
    ds_read_b64_tr_b16 v[234:235], v8 offset:28672
    v_mfma_f32_16x16x32_bf16 v[72:75], v[184:187], v[168:171], v[72:75]
    ds_read_b64_tr_b16 v[248:249], v12 offset:24576
    v_mfma_f32_16x16x32_bf16 v[76:79], v[184:187], v[172:175], v[76:79]
    ds_read_b64_tr_b16 v[250:251], v12 offset:28672
    v_mfma_f32_16x16x32_bf16 v[128:131], v[200:203], v[160:163], v[128:131]
    ds_read_b64_tr_b16 v[236:237], v9 offset:24576
    v_mfma_f32_16x16x32_bf16 v[132:135], v[200:203], v[164:167], v[132:135]
    ds_read_b64_tr_b16 v[238:239], v9 offset:28672
    v_mfma_f32_16x16x32_bf16 v[136:139], v[200:203], v[168:171], v[136:139]
    ds_read_b64_tr_b16 v[252:253], v13 offset:24576
    v_mfma_f32_16x16x32_bf16 v[140:143], v[200:203], v[172:175], v[140:143]
    ds_read_b64_tr_b16 v[254:255], v13 offset:28672
    v_mfma_f32_16x16x32_bf16 v[80:83], v[188:191], v[160:163], v[80:83]
    v_mfma_f32_16x16x32_bf16 v[84:87], v[188:191], v[164:167], v[84:87]
    v_mfma_f32_16x16x32_bf16 v[88:91], v[188:191], v[168:171], v[88:91]
    v_mfma_f32_16x16x32_bf16 v[92:95], v[188:191], v[172:175], v[92:95]
    v_mfma_f32_16x16x32_bf16 v[144:147], v[204:207], v[160:163], v[144:147]
    v_mfma_f32_16x16x32_bf16 v[148:151], v[204:207], v[164:167], v[148:151]
    v_mfma_f32_16x16x32_bf16 v[152:155], v[204:207], v[168:171], v[152:155]
    v_mfma_f32_16x16x32_bf16 v[156:159], v[204:207], v[172:175], v[156:159]
    s_waitcnt lgkmcnt(0)
    s_barrier
    v_mfma_f32_16x16x32_bf16 v[32:35], v[224:227], v[208:211], v[32:35]
    ds_read_b64_tr_b16 v[160:161], v2 offset:32768
    v_mfma_f32_16x16x32_bf16 v[36:39], v[224:227], v[212:215], v[36:39]
    ds_read_b64_tr_b16 v[162:163], v2 offset:36864
    v_mfma_f32_16x16x32_bf16 v[40:43], v[224:227], v[216:219], v[40:43]
    ds_read_b64_tr_b16 v[176:177], v6 offset:32768
    v_mfma_f32_16x16x32_bf16 v[44:47], v[224:227], v[220:223], v[44:47]
    ds_read_b64_tr_b16 v[178:179], v6 offset:36864
    v_mfma_f32_16x16x32_bf16 v[96:99], v[240:243], v[208:211], v[96:99]
    ds_read_b64_tr_b16 v[164:165], v3 offset:32768
    v_mfma_f32_16x16x32_bf16 v[100:103], v[240:243], v[212:215], v[100:103]
    ds_read_b64_tr_b16 v[166:167], v3 offset:36864
    v_mfma_f32_16x16x32_bf16 v[104:107], v[240:243], v[216:219], v[104:107]
    ds_read_b64_tr_b16 v[168:169], v4 offset:32768
    v_mfma_f32_16x16x32_bf16 v[108:111], v[240:243], v[220:223], v[108:111]
    ds_read_b64_tr_b16 v[170:171], v4 offset:36864
    v_mfma_f32_16x16x32_bf16 v[48:51], v[228:231], v[208:211], v[48:51]
    ds_read_b64_tr_b16 v[172:173], v5 offset:32768
    v_mfma_f32_16x16x32_bf16 v[52:55], v[228:231], v[212:215], v[52:55]
    ds_read_b64_tr_b16 v[174:175], v5 offset:36864
    v_mfma_f32_16x16x32_bf16 v[56:59], v[228:231], v[216:219], v[56:59]
    ds_read_b64_tr_b16 v[192:193], v10 offset:32768
    v_mfma_f32_16x16x32_bf16 v[60:63], v[228:231], v[220:223], v[60:63]
    ds_read_b64_tr_b16 v[194:195], v10 offset:36864
    v_mfma_f32_16x16x32_bf16 v[112:115], v[244:247], v[208:211], v[112:115]
    ds_read_b64_tr_b16 v[180:181], v7 offset:32768
    v_mfma_f32_16x16x32_bf16 v[116:119], v[244:247], v[212:215], v[116:119]
    ds_read_b64_tr_b16 v[182:183], v7 offset:36864
    v_mfma_f32_16x16x32_bf16 v[120:123], v[244:247], v[216:219], v[120:123]
    ds_read_b64_tr_b16 v[196:197], v11 offset:32768
    v_mfma_f32_16x16x32_bf16 v[124:127], v[244:247], v[220:223], v[124:127]
    ds_read_b64_tr_b16 v[198:199], v11 offset:36864
    v_mfma_f32_16x16x32_bf16 v[64:67], v[232:235], v[208:211], v[64:67]
    ds_read_b64_tr_b16 v[184:185], v8 offset:32768
    v_mfma_f32_16x16x32_bf16 v[68:71], v[232:235], v[212:215], v[68:71]
    ds_read_b64_tr_b16 v[186:187], v8 offset:36864
    v_mfma_f32_16x16x32_bf16 v[72:75], v[232:235], v[216:219], v[72:75]
    ds_read_b64_tr_b16 v[200:201], v12 offset:32768
    v_mfma_f32_16x16x32_bf16 v[76:79], v[232:235], v[220:223], v[76:79]
    ds_read_b64_tr_b16 v[202:203], v12 offset:36864
    v_mfma_f32_16x16x32_bf16 v[128:131], v[248:251], v[208:211], v[128:131]
    ds_read_b64_tr_b16 v[188:189], v9 offset:32768
    v_mfma_f32_16x16x32_bf16 v[132:135], v[248:251], v[212:215], v[132:135]
    ds_read_b64_tr_b16 v[190:191], v9 offset:36864
    v_mfma_f32_16x16x32_bf16 v[136:139], v[248:251], v[216:219], v[136:139]
    ds_read_b64_tr_b16 v[204:205], v13 offset:32768
    v_mfma_f32_16x16x32_bf16 v[140:143], v[248:251], v[220:223], v[140:143]
    ds_read_b64_tr_b16 v[206:207], v13 offset:36864
    v_mfma_f32_16x16x32_bf16 v[80:83], v[236:239], v[208:211], v[80:83]
    v_mfma_f32_16x16x32_bf16 v[84:87], v[236:239], v[212:215], v[84:87]
    v_mfma_f32_16x16x32_bf16 v[88:91], v[236:239], v[216:219], v[88:91]
    v_mfma_f32_16x16x32_bf16 v[92:95], v[236:239], v[220:223], v[92:95]
    v_mfma_f32_16x16x32_bf16 v[144:147], v[252:255], v[208:211], v[144:147]
    v_mfma_f32_16x16x32_bf16 v[148:151], v[252:255], v[212:215], v[148:151]
    v_mfma_f32_16x16x32_bf16 v[152:155], v[252:255], v[216:219], v[152:155]
    v_mfma_f32_16x16x32_bf16 v[156:159], v[252:255], v[220:223], v[156:159]
    s_waitcnt lgkmcnt(0)
    v_mfma_f32_16x16x32_bf16 v[32:35], v[176:179], v[160:163], v[32:35]
    ds_read_b64_tr_b16 v[208:209], v2 offset:40960
    v_mfma_f32_16x16x32_bf16 v[36:39], v[176:179], v[164:167], v[36:39]
    ds_read_b64_tr_b16 v[210:211], v2 offset:45056
    v_mfma_f32_16x16x32_bf16 v[40:43], v[176:179], v[168:171], v[40:43]
    ds_read_b64_tr_b16 v[224:225], v6 offset:40960
    v_mfma_f32_16x16x32_bf16 v[44:47], v[176:179], v[172:175], v[44:47]
    ds_read_b64_tr_b16 v[226:227], v6 offset:45056
    v_mfma_f32_16x16x32_bf16 v[96:99], v[192:195], v[160:163], v[96:99]
    ds_read_b64_tr_b16 v[212:213], v3 offset:40960
    v_mfma_f32_16x16x32_bf16 v[100:103], v[192:195], v[164:167], v[100:103]
    ds_read_b64_tr_b16 v[214:215], v3 offset:45056
    v_mfma_f32_16x16x32_bf16 v[104:107], v[192:195], v[168:171], v[104:107]
    ds_read_b64_tr_b16 v[216:217], v4 offset:40960
    v_mfma_f32_16x16x32_bf16 v[108:111], v[192:195], v[172:175], v[108:111]
    ds_read_b64_tr_b16 v[218:219], v4 offset:45056
    v_mfma_f32_16x16x32_bf16 v[48:51], v[180:183], v[160:163], v[48:51]
    ds_read_b64_tr_b16 v[220:221], v5 offset:40960
    v_mfma_f32_16x16x32_bf16 v[52:55], v[180:183], v[164:167], v[52:55]
    ds_read_b64_tr_b16 v[222:223], v5 offset:45056
    v_mfma_f32_16x16x32_bf16 v[56:59], v[180:183], v[168:171], v[56:59]
    ds_read_b64_tr_b16 v[240:241], v10 offset:40960
    v_mfma_f32_16x16x32_bf16 v[60:63], v[180:183], v[172:175], v[60:63]
    ds_read_b64_tr_b16 v[242:243], v10 offset:45056
    v_mfma_f32_16x16x32_bf16 v[112:115], v[196:199], v[160:163], v[112:115]
    ds_read_b64_tr_b16 v[228:229], v7 offset:40960
    v_mfma_f32_16x16x32_bf16 v[116:119], v[196:199], v[164:167], v[116:119]
    ds_read_b64_tr_b16 v[230:231], v7 offset:45056
    v_mfma_f32_16x16x32_bf16 v[120:123], v[196:199], v[168:171], v[120:123]
    ds_read_b64_tr_b16 v[244:245], v11 offset:40960
    v_mfma_f32_16x16x32_bf16 v[124:127], v[196:199], v[172:175], v[124:127]
    ds_read_b64_tr_b16 v[246:247], v11 offset:45056
    v_mfma_f32_16x16x32_bf16 v[64:67], v[184:187], v[160:163], v[64:67]
    ds_read_b64_tr_b16 v[232:233], v8 offset:40960
    v_mfma_f32_16x16x32_bf16 v[68:71], v[184:187], v[164:167], v[68:71]
    ds_read_b64_tr_b16 v[234:235], v8 offset:45056
    v_mfma_f32_16x16x32_bf16 v[72:75], v[184:187], v[168:171], v[72:75]
    ds_read_b64_tr_b16 v[248:249], v12 offset:40960
    v_mfma_f32_16x16x32_bf16 v[76:79], v[184:187], v[172:175], v[76:79]
    ds_read_b64_tr_b16 v[250:251], v12 offset:45056
    v_mfma_f32_16x16x32_bf16 v[128:131], v[200:203], v[160:163], v[128:131]
    ds_read_b64_tr_b16 v[236:237], v9 offset:40960
    v_mfma_f32_16x16x32_bf16 v[132:135], v[200:203], v[164:167], v[132:135]
    ds_read_b64_tr_b16 v[238:239], v9 offset:45056
    v_mfma_f32_16x16x32_bf16 v[136:139], v[200:203], v[168:171], v[136:139]
    ds_read_b64_tr_b16 v[252:253], v13 offset:40960
    v_mfma_f32_16x16x32_bf16 v[140:143], v[200:203], v[172:175], v[140:143]
    ds_read_b64_tr_b16 v[254:255], v13 offset:45056
    v_mfma_f32_16x16x32_bf16 v[80:83], v[188:191], v[160:163], v[80:83]
    v_mfma_f32_16x16x32_bf16 v[84:87], v[188:191], v[164:167], v[84:87]
    v_mfma_f32_16x16x32_bf16 v[88:91], v[188:191], v[168:171], v[88:91]
    v_mfma_f32_16x16x32_bf16 v[92:95], v[188:191], v[172:175], v[92:95]
    v_mfma_f32_16x16x32_bf16 v[144:147], v[204:207], v[160:163], v[144:147]
    v_mfma_f32_16x16x32_bf16 v[148:151], v[204:207], v[164:167], v[148:151]
    v_mfma_f32_16x16x32_bf16 v[152:155], v[204:207], v[168:171], v[152:155]
    v_mfma_f32_16x16x32_bf16 v[156:159], v[204:207], v[172:175], v[156:159]
    s_waitcnt lgkmcnt(0)
    s_barrier
    v_mfma_f32_16x16x32_bf16 v[32:35], v[224:227], v[208:211], v[32:35]
    ds_read_b64_tr_b16 v[160:161], v2 offset:0
    v_mfma_f32_16x16x32_bf16 v[36:39], v[224:227], v[212:215], v[36:39]
    ds_read_b64_tr_b16 v[162:163], v2 offset:4096
    v_mfma_f32_16x16x32_bf16 v[40:43], v[224:227], v[216:219], v[40:43]
    ds_read_b64_tr_b16 v[176:177], v6 offset:0
    v_mfma_f32_16x16x32_bf16 v[44:47], v[224:227], v[220:223], v[44:47]
    ds_read_b64_tr_b16 v[178:179], v6 offset:4096
    v_mfma_f32_16x16x32_bf16 v[96:99], v[240:243], v[208:211], v[96:99]
    ds_read_b64_tr_b16 v[164:165], v3 offset:0
    v_mfma_f32_16x16x32_bf16 v[100:103], v[240:243], v[212:215], v[100:103]
    ds_read_b64_tr_b16 v[166:167], v3 offset:4096
    v_mfma_f32_16x16x32_bf16 v[104:107], v[240:243], v[216:219], v[104:107]
    ds_read_b64_tr_b16 v[168:169], v4 offset:0
    v_mfma_f32_16x16x32_bf16 v[108:111], v[240:243], v[220:223], v[108:111]
    ds_read_b64_tr_b16 v[170:171], v4 offset:4096
    v_mfma_f32_16x16x32_bf16 v[48:51], v[228:231], v[208:211], v[48:51]
    ds_read_b64_tr_b16 v[172:173], v5 offset:0
    v_mfma_f32_16x16x32_bf16 v[52:55], v[228:231], v[212:215], v[52:55]
    ds_read_b64_tr_b16 v[174:175], v5 offset:4096
    v_mfma_f32_16x16x32_bf16 v[56:59], v[228:231], v[216:219], v[56:59]
    ds_read_b64_tr_b16 v[192:193], v10 offset:0
    v_mfma_f32_16x16x32_bf16 v[60:63], v[228:231], v[220:223], v[60:63]
    ds_read_b64_tr_b16 v[194:195], v10 offset:4096
    v_mfma_f32_16x16x32_bf16 v[112:115], v[244:247], v[208:211], v[112:115]
    ds_read_b64_tr_b16 v[180:181], v7 offset:0
    v_mfma_f32_16x16x32_bf16 v[116:119], v[244:247], v[212:215], v[116:119]
    ds_read_b64_tr_b16 v[182:183], v7 offset:4096
    v_mfma_f32_16x16x32_bf16 v[120:123], v[244:247], v[216:219], v[120:123]
    ds_read_b64_tr_b16 v[196:197], v11 offset:0
    v_mfma_f32_16x16x32_bf16 v[124:127], v[244:247], v[220:223], v[124:127]
    ds_read_b64_tr_b16 v[198:199], v11 offset:4096
    v_mfma_f32_16x16x32_bf16 v[64:67], v[232:235], v[208:211], v[64:67]
    ds_read_b64_tr_b16 v[184:185], v8 offset:0
    v_mfma_f32_16x16x32_bf16 v[68:71], v[232:235], v[212:215], v[68:71]
    ds_read_b64_tr_b16 v[186:187], v8 offset:4096
    v_mfma_f32_16x16x32_bf16 v[72:75], v[232:235], v[216:219], v[72:75]
    ds_read_b64_tr_b16 v[200:201], v12 offset:0
    v_mfma_f32_16x16x32_bf16 v[76:79], v[232:235], v[220:223], v[76:79]
    ds_read_b64_tr_b16 v[202:203], v12 offset:4096
    v_mfma_f32_16x16x32_bf16 v[128:131], v[248:251], v[208:211], v[128:131]
    ds_read_b64_tr_b16 v[188:189], v9 offset:0
    v_mfma_f32_16x16x32_bf16 v[132:135], v[248:251], v[212:215], v[132:135]
    ds_read_b64_tr_b16 v[190:191], v9 offset:4096
    v_mfma_f32_16x16x32_bf16 v[136:139], v[248:251], v[216:219], v[136:139]
    ds_read_b64_tr_b16 v[204:205], v13 offset:0
    v_mfma_f32_16x16x32_bf16 v[140:143], v[248:251], v[220:223], v[140:143]
    ds_read_b64_tr_b16 v[206:207], v13 offset:4096
    v_mfma_f32_16x16x32_bf16 v[80:83], v[236:239], v[208:211], v[80:83]
    v_mfma_f32_16x16x32_bf16 v[84:87], v[236:239], v[212:215], v[84:87]
    v_mfma_f32_16x16x32_bf16 v[88:91], v[236:239], v[216:219], v[88:91]
    v_mfma_f32_16x16x32_bf16 v[92:95], v[236:239], v[220:223], v[92:95]
    v_mfma_f32_16x16x32_bf16 v[144:147], v[252:255], v[208:211], v[144:147]
    v_mfma_f32_16x16x32_bf16 v[148:151], v[252:255], v[212:215], v[148:151]
    v_mfma_f32_16x16x32_bf16 v[152:155], v[252:255], v[216:219], v[152:155]
    v_mfma_f32_16x16x32_bf16 v[156:159], v[252:255], v[220:223], v[156:159]
    s_waitcnt lgkmcnt(0)
    v_mfma_f32_16x16x32_bf16 v[32:35], v[176:179], v[160:163], v[32:35]
    ds_read_b64_tr_b16 v[208:209], v2 offset:8192
    v_mfma_f32_16x16x32_bf16 v[36:39], v[176:179], v[164:167], v[36:39]
    ds_read_b64_tr_b16 v[210:211], v2 offset:12288
    v_mfma_f32_16x16x32_bf16 v[40:43], v[176:179], v[168:171], v[40:43]
    ds_read_b64_tr_b16 v[224:225], v6 offset:8192
    v_mfma_f32_16x16x32_bf16 v[44:47], v[176:179], v[172:175], v[44:47]
    ds_read_b64_tr_b16 v[226:227], v6 offset:12288
    v_mfma_f32_16x16x32_bf16 v[96:99], v[192:195], v[160:163], v[96:99]
    ds_read_b64_tr_b16 v[212:213], v3 offset:8192
    v_mfma_f32_16x16x32_bf16 v[100:103], v[192:195], v[164:167], v[100:103]
    ds_read_b64_tr_b16 v[214:215], v3 offset:12288
    v_mfma_f32_16x16x32_bf16 v[104:107], v[192:195], v[168:171], v[104:107]
    ds_read_b64_tr_b16 v[216:217], v4 offset:8192
    v_mfma_f32_16x16x32_bf16 v[108:111], v[192:195], v[172:175], v[108:111]
    ds_read_b64_tr_b16 v[218:219], v4 offset:12288
    v_mfma_f32_16x16x32_bf16 v[48:51], v[180:183], v[160:163], v[48:51]
    ds_read_b64_tr_b16 v[220:221], v5 offset:8192
    v_mfma_f32_16x16x32_bf16 v[52:55], v[180:183], v[164:167], v[52:55]
    ds_read_b64_tr_b16 v[222:223], v5 offset:12288
    v_mfma_f32_16x16x32_bf16 v[56:59], v[180:183], v[168:171], v[56:59]
    ds_read_b64_tr_b16 v[240:241], v10 offset:8192
    v_mfma_f32_16x16x32_bf16 v[60:63], v[180:183], v[172:175], v[60:63]
    ds_read_b64_tr_b16 v[242:243], v10 offset:12288
    v_mfma_f32_16x16x32_bf16 v[112:115], v[196:199], v[160:163], v[112:115]
    ds_read_b64_tr_b16 v[228:229], v7 offset:8192
    v_mfma_f32_16x16x32_bf16 v[116:119], v[196:199], v[164:167], v[116:119]
    ds_read_b64_tr_b16 v[230:231], v7 offset:12288
    v_mfma_f32_16x16x32_bf16 v[120:123], v[196:199], v[168:171], v[120:123]
    ds_read_b64_tr_b16 v[244:245], v11 offset:8192
    v_mfma_f32_16x16x32_bf16 v[124:127], v[196:199], v[172:175], v[124:127]
    ds_read_b64_tr_b16 v[246:247], v11 offset:12288
    v_mfma_f32_16x16x32_bf16 v[64:67], v[184:187], v[160:163], v[64:67]
    ds_read_b64_tr_b16 v[232:233], v8 offset:8192
    v_mfma_f32_16x16x32_bf16 v[68:71], v[184:187], v[164:167], v[68:71]
    ds_read_b64_tr_b16 v[234:235], v8 offset:12288
    v_mfma_f32_16x16x32_bf16 v[72:75], v[184:187], v[168:171], v[72:75]
    ds_read_b64_tr_b16 v[248:249], v12 offset:8192
    v_mfma_f32_16x16x32_bf16 v[76:79], v[184:187], v[172:175], v[76:79]
    ds_read_b64_tr_b16 v[250:251], v12 offset:12288
    v_mfma_f32_16x16x32_bf16 v[128:131], v[200:203], v[160:163], v[128:131]
    ds_read_b64_tr_b16 v[236:237], v9 offset:8192
    v_mfma_f32_16x16x32_bf16 v[132:135], v[200:203], v[164:167], v[132:135]
    ds_read_b64_tr_b16 v[238:239], v9 offset:12288
    v_mfma_f32_16x16x32_bf16 v[136:139], v[200:203], v[168:171], v[136:139]
    ds_read_b64_tr_b16 v[252:253], v13 offset:8192
    v_mfma_f32_16x16x32_bf16 v[140:143], v[200:203], v[172:175], v[140:143]
    ds_read_b64_tr_b16 v[254:255], v13 offset:12288
    v_mfma_f32_16x16x32_bf16 v[80:83], v[188:191], v[160:163], v[80:83]
    v_mfma_f32_16x16x32_bf16 v[84:87], v[188:191], v[164:167], v[84:87]
    v_mfma_f32_16x16x32_bf16 v[88:91], v[188:191], v[168:171], v[88:91]
    v_mfma_f32_16x16x32_bf16 v[92:95], v[188:191], v[172:175], v[92:95]
    v_mfma_f32_16x16x32_bf16 v[144:147], v[204:207], v[160:163], v[144:147]
    v_mfma_f32_16x16x32_bf16 v[148:151], v[204:207], v[164:167], v[148:151]
    v_mfma_f32_16x16x32_bf16 v[152:155], v[204:207], v[168:171], v[152:155]
    v_mfma_f32_16x16x32_bf16 v[156:159], v[204:207], v[172:175], v[156:159]
    s_waitcnt lgkmcnt(0)
    s_barrier
    v_mfma_f32_16x16x32_bf16 v[32:35], v[224:227], v[208:211], v[32:35]
    ds_read_b64_tr_b16 v[160:161], v2 offset:16384
    v_mfma_f32_16x16x32_bf16 v[36:39], v[224:227], v[212:215], v[36:39]
    ds_read_b64_tr_b16 v[162:163], v2 offset:20480
    v_mfma_f32_16x16x32_bf16 v[40:43], v[224:227], v[216:219], v[40:43]
    ds_read_b64_tr_b16 v[176:177], v6 offset:16384
    v_mfma_f32_16x16x32_bf16 v[44:47], v[224:227], v[220:223], v[44:47]
    ds_read_b64_tr_b16 v[178:179], v6 offset:20480
    v_mfma_f32_16x16x32_bf16 v[96:99], v[240:243], v[208:211], v[96:99]
    ds_read_b64_tr_b16 v[164:165], v3 offset:16384
    v_mfma_f32_16x16x32_bf16 v[100:103], v[240:243], v[212:215], v[100:103]
    ds_read_b64_tr_b16 v[166:167], v3 offset:20480
    v_mfma_f32_16x16x32_bf16 v[104:107], v[240:243], v[216:219], v[104:107]
    ds_read_b64_tr_b16 v[168:169], v4 offset:16384
    v_mfma_f32_16x16x32_bf16 v[108:111], v[240:243], v[220:223], v[108:111]
    ds_read_b64_tr_b16 v[170:171], v4 offset:20480
    v_mfma_f32_16x16x32_bf16 v[48:51], v[228:231], v[208:211], v[48:51]
    ds_read_b64_tr_b16 v[172:173], v5 offset:16384
    v_mfma_f32_16x16x32_bf16 v[52:55], v[228:231], v[212:215], v[52:55]
    ds_read_b64_tr_b16 v[174:175], v5 offset:20480
    v_mfma_f32_16x16x32_bf16 v[56:59], v[228:231], v[216:219], v[56:59]
    ds_read_b64_tr_b16 v[192:193], v10 offset:16384
    v_mfma_f32_16x16x32_bf16 v[60:63], v[228:231], v[220:223], v[60:63]
    ds_read_b64_tr_b16 v[194:195], v10 offset:20480
    v_mfma_f32_16x16x32_bf16 v[112:115], v[244:247], v[208:211], v[112:115]
    ds_read_b64_tr_b16 v[180:181], v7 offset:16384
    v_mfma_f32_16x16x32_bf16 v[116:119], v[244:247], v[212:215], v[116:119]
    ds_read_b64_tr_b16 v[182:183], v7 offset:20480
    v_mfma_f32_16x16x32_bf16 v[120:123], v[244:247], v[216:219], v[120:123]
    ds_read_b64_tr_b16 v[196:197], v11 offset:16384
    v_mfma_f32_16x16x32_bf16 v[124:127], v[244:247], v[220:223], v[124:127]
    ds_read_b64_tr_b16 v[198:199], v11 offset:20480
    v_mfma_f32_16x16x32_bf16 v[64:67], v[232:235], v[208:211], v[64:67]
    ds_read_b64_tr_b16 v[184:185], v8 offset:16384
    v_mfma_f32_16x16x32_bf16 v[68:71], v[232:235], v[212:215], v[68:71]
    ds_read_b64_tr_b16 v[186:187], v8 offset:20480
    v_mfma_f32_16x16x32_bf16 v[72:75], v[232:235], v[216:219], v[72:75]
    ds_read_b64_tr_b16 v[200:201], v12 offset:16384
    v_mfma_f32_16x16x32_bf16 v[76:79], v[232:235], v[220:223], v[76:79]
    ds_read_b64_tr_b16 v[202:203], v12 offset:20480
    v_mfma_f32_16x16x32_bf16 v[128:131], v[248:251], v[208:211], v[128:131]
    ds_read_b64_tr_b16 v[188:189], v9 offset:16384
    v_mfma_f32_16x16x32_bf16 v[132:135], v[248:251], v[212:215], v[132:135]
    ds_read_b64_tr_b16 v[190:191], v9 offset:20480
    v_mfma_f32_16x16x32_bf16 v[136:139], v[248:251], v[216:219], v[136:139]
    ds_read_b64_tr_b16 v[204:205], v13 offset:16384
    v_mfma_f32_16x16x32_bf16 v[140:143], v[248:251], v[220:223], v[140:143]
    ds_read_b64_tr_b16 v[206:207], v13 offset:20480
    v_mfma_f32_16x16x32_bf16 v[80:83], v[236:239], v[208:211], v[80:83]
    v_mfma_f32_16x16x32_bf16 v[84:87], v[236:239], v[212:215], v[84:87]
    v_mfma_f32_16x16x32_bf16 v[88:91], v[236:239], v[216:219], v[88:91]
    v_mfma_f32_16x16x32_bf16 v[92:95], v[236:239], v[220:223], v[92:95]
    v_mfma_f32_16x16x32_bf16 v[144:147], v[252:255], v[208:211], v[144:147]
    v_mfma_f32_16x16x32_bf16 v[148:151], v[252:255], v[212:215], v[148:151]
    v_mfma_f32_16x16x32_bf16 v[152:155], v[252:255], v[216:219], v[152:155]
    v_mfma_f32_16x16x32_bf16 v[156:159], v[252:255], v[220:223], v[156:159]
    s_waitcnt lgkmcnt(0)
    v_mfma_f32_16x16x32_bf16 v[32:35], v[176:179], v[160:163], v[32:35]
    ds_read_b64_tr_b16 v[208:209], v2 offset:24576
    v_mfma_f32_16x16x32_bf16 v[36:39], v[176:179], v[164:167], v[36:39]
    ds_read_b64_tr_b16 v[210:211], v2 offset:28672
    v_mfma_f32_16x16x32_bf16 v[40:43], v[176:179], v[168:171], v[40:43]
    ds_read_b64_tr_b16 v[224:225], v6 offset:24576
    v_mfma_f32_16x16x32_bf16 v[44:47], v[176:179], v[172:175], v[44:47]
    ds_read_b64_tr_b16 v[226:227], v6 offset:28672
    v_mfma_f32_16x16x32_bf16 v[96:99], v[192:195], v[160:163], v[96:99]
    ds_read_b64_tr_b16 v[212:213], v3 offset:24576
    v_mfma_f32_16x16x32_bf16 v[100:103], v[192:195], v[164:167], v[100:103]
    ds_read_b64_tr_b16 v[214:215], v3 offset:28672
    v_mfma_f32_16x16x32_bf16 v[104:107], v[192:195], v[168:171], v[104:107]
    ds_read_b64_tr_b16 v[216:217], v4 offset:24576
    v_mfma_f32_16x16x32_bf16 v[108:111], v[192:195], v[172:175], v[108:111]
    ds_read_b64_tr_b16 v[218:219], v4 offset:28672
    v_mfma_f32_16x16x32_bf16 v[48:51], v[180:183], v[160:163], v[48:51]
    ds_read_b64_tr_b16 v[220:221], v5 offset:24576
    v_mfma_f32_16x16x32_bf16 v[52:55], v[180:183], v[164:167], v[52:55]
    ds_read_b64_tr_b16 v[222:223], v5 offset:28672
    v_mfma_f32_16x16x32_bf16 v[56:59], v[180:183], v[168:171], v[56:59]
    ds_read_b64_tr_b16 v[240:241], v10 offset:24576
    v_mfma_f32_16x16x32_bf16 v[60:63], v[180:183], v[172:175], v[60:63]
    ds_read_b64_tr_b16 v[242:243], v10 offset:28672
    v_mfma_f32_16x16x32_bf16 v[112:115], v[196:199], v[160:163], v[112:115]
    ds_read_b64_tr_b16 v[228:229], v7 offset:24576
    v_mfma_f32_16x16x32_bf16 v[116:119], v[196:199], v[164:167], v[116:119]
    ds_read_b64_tr_b16 v[230:231], v7 offset:28672
    v_mfma_f32_16x16x32_bf16 v[120:123], v[196:199], v[168:171], v[120:123]
    ds_read_b64_tr_b16 v[244:245], v11 offset:24576
    v_mfma_f32_16x16x32_bf16 v[124:127], v[196:199], v[172:175], v[124:127]
    ds_read_b64_tr_b16 v[246:247], v11 offset:28672
    v_mfma_f32_16x16x32_bf16 v[64:67], v[184:187], v[160:163], v[64:67]
    ds_read_b64_tr_b16 v[232:233], v8 offset:24576
    v_mfma_f32_16x16x32_bf16 v[68:71], v[184:187], v[164:167], v[68:71]
    ds_read_b64_tr_b16 v[234:235], v8 offset:28672
    v_mfma_f32_16x16x32_bf16 v[72:75], v[184:187], v[168:171], v[72:75]
    ds_read_b64_tr_b16 v[248:249], v12 offset:24576
    v_mfma_f32_16x16x32_bf16 v[76:79], v[184:187], v[172:175], v[76:79]
    ds_read_b64_tr_b16 v[250:251], v12 offset:28672
    v_mfma_f32_16x16x32_bf16 v[128:131], v[200:203], v[160:163], v[128:131]
    ds_read_b64_tr_b16 v[236:237], v9 offset:24576
    v_mfma_f32_16x16x32_bf16 v[132:135], v[200:203], v[164:167], v[132:135]
    ds_read_b64_tr_b16 v[238:239], v9 offset:28672
    v_mfma_f32_16x16x32_bf16 v[136:139], v[200:203], v[168:171], v[136:139]
    ds_read_b64_tr_b16 v[252:253], v13 offset:24576
    v_mfma_f32_16x16x32_bf16 v[140:143], v[200:203], v[172:175], v[140:143]
    ds_read_b64_tr_b16 v[254:255], v13 offset:28672
    v_mfma_f32_16x16x32_bf16 v[80:83], v[188:191], v[160:163], v[80:83]
    v_mfma_f32_16x16x32_bf16 v[84:87], v[188:191], v[164:167], v[84:87]
    v_mfma_f32_16x16x32_bf16 v[88:91], v[188:191], v[168:171], v[88:91]
    v_mfma_f32_16x16x32_bf16 v[92:95], v[188:191], v[172:175], v[92:95]
    v_mfma_f32_16x16x32_bf16 v[144:147], v[204:207], v[160:163], v[144:147]
    v_mfma_f32_16x16x32_bf16 v[148:151], v[204:207], v[164:167], v[148:151]
    v_mfma_f32_16x16x32_bf16 v[152:155], v[204:207], v[168:171], v[152:155]
    v_mfma_f32_16x16x32_bf16 v[156:159], v[204:207], v[172:175], v[156:159]
    s_waitcnt lgkmcnt(0)
    s_barrier
    v_mfma_f32_16x16x32_bf16 v[32:35], v[224:227], v[208:211], v[32:35]
    ds_read_b64_tr_b16 v[160:161], v2 offset:32768
    v_mfma_f32_16x16x32_bf16 v[36:39], v[224:227], v[212:215], v[36:39]
    ds_read_b64_tr_b16 v[162:163], v2 offset:36864
    v_mfma_f32_16x16x32_bf16 v[40:43], v[224:227], v[216:219], v[40:43]
    ds_read_b64_tr_b16 v[176:177], v6 offset:32768
    v_mfma_f32_16x16x32_bf16 v[44:47], v[224:227], v[220:223], v[44:47]
    ds_read_b64_tr_b16 v[178:179], v6 offset:36864
    v_mfma_f32_16x16x32_bf16 v[96:99], v[240:243], v[208:211], v[96:99]
    ds_read_b64_tr_b16 v[164:165], v3 offset:32768
    v_mfma_f32_16x16x32_bf16 v[100:103], v[240:243], v[212:215], v[100:103]
    ds_read_b64_tr_b16 v[166:167], v3 offset:36864
    v_mfma_f32_16x16x32_bf16 v[104:107], v[240:243], v[216:219], v[104:107]
    ds_read_b64_tr_b16 v[168:169], v4 offset:32768
    v_mfma_f32_16x16x32_bf16 v[108:111], v[240:243], v[220:223], v[108:111]
    ds_read_b64_tr_b16 v[170:171], v4 offset:36864
    v_mfma_f32_16x16x32_bf16 v[48:51], v[228:231], v[208:211], v[48:51]
    ds_read_b64_tr_b16 v[172:173], v5 offset:32768
    v_mfma_f32_16x16x32_bf16 v[52:55], v[228:231], v[212:215], v[52:55]
    ds_read_b64_tr_b16 v[174:175], v5 offset:36864
    v_mfma_f32_16x16x32_bf16 v[56:59], v[228:231], v[216:219], v[56:59]
    ds_read_b64_tr_b16 v[192:193], v10 offset:32768
    v_mfma_f32_16x16x32_bf16 v[60:63], v[228:231], v[220:223], v[60:63]
    ds_read_b64_tr_b16 v[194:195], v10 offset:36864
    v_mfma_f32_16x16x32_bf16 v[112:115], v[244:247], v[208:211], v[112:115]
    ds_read_b64_tr_b16 v[180:181], v7 offset:32768
    v_mfma_f32_16x16x32_bf16 v[116:119], v[244:247], v[212:215], v[116:119]
    ds_read_b64_tr_b16 v[182:183], v7 offset:36864
    v_mfma_f32_16x16x32_bf16 v[120:123], v[244:247], v[216:219], v[120:123]
    ds_read_b64_tr_b16 v[196:197], v11 offset:32768
    v_mfma_f32_16x16x32_bf16 v[124:127], v[244:247], v[220:223], v[124:127]
    ds_read_b64_tr_b16 v[198:199], v11 offset:36864
    v_mfma_f32_16x16x32_bf16 v[64:67], v[232:235], v[208:211], v[64:67]
    ds_read_b64_tr_b16 v[184:185], v8 offset:32768
    v_mfma_f32_16x16x32_bf16 v[68:71], v[232:235], v[212:215], v[68:71]
    ds_read_b64_tr_b16 v[186:187], v8 offset:36864
    v_mfma_f32_16x16x32_bf16 v[72:75], v[232:235], v[216:219], v[72:75]
    ds_read_b64_tr_b16 v[200:201], v12 offset:32768
    v_mfma_f32_16x16x32_bf16 v[76:79], v[232:235], v[220:223], v[76:79]
    ds_read_b64_tr_b16 v[202:203], v12 offset:36864
    v_mfma_f32_16x16x32_bf16 v[128:131], v[248:251], v[208:211], v[128:131]
    ds_read_b64_tr_b16 v[188:189], v9 offset:32768
    v_mfma_f32_16x16x32_bf16 v[132:135], v[248:251], v[212:215], v[132:135]
    ds_read_b64_tr_b16 v[190:191], v9 offset:36864
    v_mfma_f32_16x16x32_bf16 v[136:139], v[248:251], v[216:219], v[136:139]
    ds_read_b64_tr_b16 v[204:205], v13 offset:32768
    v_mfma_f32_16x16x32_bf16 v[140:143], v[248:251], v[220:223], v[140:143]
    ds_read_b64_tr_b16 v[206:207], v13 offset:36864
    v_mfma_f32_16x16x32_bf16 v[80:83], v[236:239], v[208:211], v[80:83]
    v_mfma_f32_16x16x32_bf16 v[84:87], v[236:239], v[212:215], v[84:87]
    v_mfma_f32_16x16x32_bf16 v[88:91], v[236:239], v[216:219], v[88:91]
    v_mfma_f32_16x16x32_bf16 v[92:95], v[236:239], v[220:223], v[92:95]
    v_mfma_f32_16x16x32_bf16 v[144:147], v[252:255], v[208:211], v[144:147]
    v_mfma_f32_16x16x32_bf16 v[148:151], v[252:255], v[212:215], v[148:151]
    v_mfma_f32_16x16x32_bf16 v[152:155], v[252:255], v[216:219], v[152:155]
    v_mfma_f32_16x16x32_bf16 v[156:159], v[252:255], v[220:223], v[156:159]
    s_waitcnt lgkmcnt(0)
    v_mfma_f32_16x16x32_bf16 v[32:35], v[176:179], v[160:163], v[32:35]
    ds_read_b64_tr_b16 v[208:209], v2 offset:40960
    v_mfma_f32_16x16x32_bf16 v[36:39], v[176:179], v[164:167], v[36:39]
    ds_read_b64_tr_b16 v[210:211], v2 offset:45056
    v_mfma_f32_16x16x32_bf16 v[40:43], v[176:179], v[168:171], v[40:43]
    ds_read_b64_tr_b16 v[224:225], v6 offset:40960
    v_mfma_f32_16x16x32_bf16 v[44:47], v[176:179], v[172:175], v[44:47]
    ds_read_b64_tr_b16 v[226:227], v6 offset:45056
    v_mfma_f32_16x16x32_bf16 v[96:99], v[192:195], v[160:163], v[96:99]
    ds_read_b64_tr_b16 v[212:213], v3 offset:40960
    v_mfma_f32_16x16x32_bf16 v[100:103], v[192:195], v[164:167], v[100:103]
    ds_read_b64_tr_b16 v[214:215], v3 offset:45056
    v_mfma_f32_16x16x32_bf16 v[104:107], v[192:195], v[168:171], v[104:107]
    ds_read_b64_tr_b16 v[216:217], v4 offset:40960
    v_mfma_f32_16x16x32_bf16 v[108:111], v[192:195], v[172:175], v[108:111]
    ds_read_b64_tr_b16 v[218:219], v4 offset:45056
    v_mfma_f32_16x16x32_bf16 v[48:51], v[180:183], v[160:163], v[48:51]
    ds_read_b64_tr_b16 v[220:221], v5 offset:40960
    v_mfma_f32_16x16x32_bf16 v[52:55], v[180:183], v[164:167], v[52:55]
    ds_read_b64_tr_b16 v[222:223], v5 offset:45056
    v_mfma_f32_16x16x32_bf16 v[56:59], v[180:183], v[168:171], v[56:59]
    ds_read_b64_tr_b16 v[240:241], v10 offset:40960
    v_mfma_f32_16x16x32_bf16 v[60:63], v[180:183], v[172:175], v[60:63]
    ds_read_b64_tr_b16 v[242:243], v10 offset:45056
    v_mfma_f32_16x16x32_bf16 v[112:115], v[196:199], v[160:163], v[112:115]
    ds_read_b64_tr_b16 v[228:229], v7 offset:40960
    v_mfma_f32_16x16x32_bf16 v[116:119], v[196:199], v[164:167], v[116:119]
    ds_read_b64_tr_b16 v[230:231], v7 offset:45056
    v_mfma_f32_16x16x32_bf16 v[120:123], v[196:199], v[168:171], v[120:123]
    ds_read_b64_tr_b16 v[244:245], v11 offset:40960
    v_mfma_f32_16x16x32_bf16 v[124:127], v[196:199], v[172:175], v[124:127]
    ds_read_b64_tr_b16 v[246:247], v11 offset:45056
    v_mfma_f32_16x16x32_bf16 v[64:67], v[184:187], v[160:163], v[64:67]
    ds_read_b64_tr_b16 v[232:233], v8 offset:40960
    v_mfma_f32_16x16x32_bf16 v[68:71], v[184:187], v[164:167], v[68:71]
    ds_read_b64_tr_b16 v[234:235], v8 offset:45056
    v_mfma_f32_16x16x32_bf16 v[72:75], v[184:187], v[168:171], v[72:75]
    ds_read_b64_tr_b16 v[248:249], v12 offset:40960
    v_mfma_f32_16x16x32_bf16 v[76:79], v[184:187], v[172:175], v[76:79]
    ds_read_b64_tr_b16 v[250:251], v12 offset:45056
    v_mfma_f32_16x16x32_bf16 v[128:131], v[200:203], v[160:163], v[128:131]
    ds_read_b64_tr_b16 v[236:237], v9 offset:40960
    v_mfma_f32_16x16x32_bf16 v[132:135], v[200:203], v[164:167], v[132:135]
    ds_read_b64_tr_b16 v[238:239], v9 offset:45056
    v_mfma_f32_16x16x32_bf16 v[136:139], v[200:203], v[168:171], v[136:139]
    ds_read_b64_tr_b16 v[252:253], v13 offset:40960
    v_mfma_f32_16x16x32_bf16 v[140:143], v[200:203], v[172:175], v[140:143]
    ds_read_b64_tr_b16 v[254:255], v13 offset:45056
    v_mfma_f32_16x16x32_bf16 v[80:83], v[188:191], v[160:163], v[80:83]
    v_mfma_f32_16x16x32_bf16 v[84:87], v[188:191], v[164:167], v[84:87]
    v_mfma_f32_16x16x32_bf16 v[88:91], v[188:191], v[168:171], v[88:91]
    v_mfma_f32_16x16x32_bf16 v[92:95], v[188:191], v[172:175], v[92:95]
    v_mfma_f32_16x16x32_bf16 v[144:147], v[204:207], v[160:163], v[144:147]
    v_mfma_f32_16x16x32_bf16 v[148:151], v[204:207], v[164:167], v[148:151]
    v_mfma_f32_16x16x32_bf16 v[152:155], v[204:207], v[168:171], v[152:155]
    v_mfma_f32_16x16x32_bf16 v[156:159], v[204:207], v[172:175], v[156:159]
    s_waitcnt lgkmcnt(0)
    s_barrier
    v_mfma_f32_16x16x32_bf16 v[32:35], v[224:227], v[208:211], v[32:35]
    ds_read_b64_tr_b16 v[160:161], v2 offset:0
    v_mfma_f32_16x16x32_bf16 v[36:39], v[224:227], v[212:215], v[36:39]
    ds_read_b64_tr_b16 v[162:163], v2 offset:4096
    v_mfma_f32_16x16x32_bf16 v[40:43], v[224:227], v[216:219], v[40:43]
    ds_read_b64_tr_b16 v[176:177], v6 offset:0
    v_mfma_f32_16x16x32_bf16 v[44:47], v[224:227], v[220:223], v[44:47]
    ds_read_b64_tr_b16 v[178:179], v6 offset:4096
    v_mfma_f32_16x16x32_bf16 v[96:99], v[240:243], v[208:211], v[96:99]
    ds_read_b64_tr_b16 v[164:165], v3 offset:0
    v_mfma_f32_16x16x32_bf16 v[100:103], v[240:243], v[212:215], v[100:103]
    ds_read_b64_tr_b16 v[166:167], v3 offset:4096
    v_mfma_f32_16x16x32_bf16 v[104:107], v[240:243], v[216:219], v[104:107]
    ds_read_b64_tr_b16 v[168:169], v4 offset:0
    v_mfma_f32_16x16x32_bf16 v[108:111], v[240:243], v[220:223], v[108:111]
    ds_read_b64_tr_b16 v[170:171], v4 offset:4096
    v_mfma_f32_16x16x32_bf16 v[48:51], v[228:231], v[208:211], v[48:51]
    ds_read_b64_tr_b16 v[172:173], v5 offset:0
    v_mfma_f32_16x16x32_bf16 v[52:55], v[228:231], v[212:215], v[52:55]
    ds_read_b64_tr_b16 v[174:175], v5 offset:4096
    v_mfma_f32_16x16x32_bf16 v[56:59], v[228:231], v[216:219], v[56:59]
    ds_read_b64_tr_b16 v[192:193], v10 offset:0
    v_mfma_f32_16x16x32_bf16 v[60:63], v[228:231], v[220:223], v[60:63]
    ds_read_b64_tr_b16 v[194:195], v10 offset:4096
    v_mfma_f32_16x16x32_bf16 v[112:115], v[244:247], v[208:211], v[112:115]
    ds_read_b64_tr_b16 v[180:181], v7 offset:0
    v_mfma_f32_16x16x32_bf16 v[116:119], v[244:247], v[212:215], v[116:119]
    ds_read_b64_tr_b16 v[182:183], v7 offset:4096
    v_mfma_f32_16x16x32_bf16 v[120:123], v[244:247], v[216:219], v[120:123]
    ds_read_b64_tr_b16 v[196:197], v11 offset:0
    v_mfma_f32_16x16x32_bf16 v[124:127], v[244:247], v[220:223], v[124:127]
    ds_read_b64_tr_b16 v[198:199], v11 offset:4096
    v_mfma_f32_16x16x32_bf16 v[64:67], v[232:235], v[208:211], v[64:67]
    ds_read_b64_tr_b16 v[184:185], v8 offset:0
    v_mfma_f32_16x16x32_bf16 v[68:71], v[232:235], v[212:215], v[68:71]
    ds_read_b64_tr_b16 v[186:187], v8 offset:4096
    v_mfma_f32_16x16x32_bf16 v[72:75], v[232:235], v[216:219], v[72:75]
    ds_read_b64_tr_b16 v[200:201], v12 offset:0
    v_mfma_f32_16x16x32_bf16 v[76:79], v[232:235], v[220:223], v[76:79]
    ds_read_b64_tr_b16 v[202:203], v12 offset:4096
    v_mfma_f32_16x16x32_bf16 v[128:131], v[248:251], v[208:211], v[128:131]
    ds_read_b64_tr_b16 v[188:189], v9 offset:0
    v_mfma_f32_16x16x32_bf16 v[132:135], v[248:251], v[212:215], v[132:135]
    ds_read_b64_tr_b16 v[190:191], v9 offset:4096
    v_mfma_f32_16x16x32_bf16 v[136:139], v[248:251], v[216:219], v[136:139]
    ds_read_b64_tr_b16 v[204:205], v13 offset:0
    v_mfma_f32_16x16x32_bf16 v[140:143], v[248:251], v[220:223], v[140:143]
    ds_read_b64_tr_b16 v[206:207], v13 offset:4096
    v_mfma_f32_16x16x32_bf16 v[80:83], v[236:239], v[208:211], v[80:83]
    v_mfma_f32_16x16x32_bf16 v[84:87], v[236:239], v[212:215], v[84:87]
    v_mfma_f32_16x16x32_bf16 v[88:91], v[236:239], v[216:219], v[88:91]
    v_mfma_f32_16x16x32_bf16 v[92:95], v[236:239], v[220:223], v[92:95]
    v_mfma_f32_16x16x32_bf16 v[144:147], v[252:255], v[208:211], v[144:147]
    v_mfma_f32_16x16x32_bf16 v[148:151], v[252:255], v[212:215], v[148:151]
    v_mfma_f32_16x16x32_bf16 v[152:155], v[252:255], v[216:219], v[152:155]
    v_mfma_f32_16x16x32_bf16 v[156:159], v[252:255], v[220:223], v[156:159]
    s_waitcnt lgkmcnt(0)
    v_mfma_f32_16x16x32_bf16 v[32:35], v[176:179], v[160:163], v[32:35]
    ds_read_b64_tr_b16 v[208:209], v2 offset:8192
    v_mfma_f32_16x16x32_bf16 v[36:39], v[176:179], v[164:167], v[36:39]
    ds_read_b64_tr_b16 v[210:211], v2 offset:12288
    v_mfma_f32_16x16x32_bf16 v[40:43], v[176:179], v[168:171], v[40:43]
    ds_read_b64_tr_b16 v[224:225], v6 offset:8192
    v_mfma_f32_16x16x32_bf16 v[44:47], v[176:179], v[172:175], v[44:47]
    ds_read_b64_tr_b16 v[226:227], v6 offset:12288
    v_mfma_f32_16x16x32_bf16 v[96:99], v[192:195], v[160:163], v[96:99]
    ds_read_b64_tr_b16 v[212:213], v3 offset:8192
    v_mfma_f32_16x16x32_bf16 v[100:103], v[192:195], v[164:167], v[100:103]
    ds_read_b64_tr_b16 v[214:215], v3 offset:12288
    v_mfma_f32_16x16x32_bf16 v[104:107], v[192:195], v[168:171], v[104:107]
    ds_read_b64_tr_b16 v[216:217], v4 offset:8192
    v_mfma_f32_16x16x32_bf16 v[108:111], v[192:195], v[172:175], v[108:111]
    ds_read_b64_tr_b16 v[218:219], v4 offset:12288
    v_mfma_f32_16x16x32_bf16 v[48:51], v[180:183], v[160:163], v[48:51]
    ds_read_b64_tr_b16 v[220:221], v5 offset:8192
    v_mfma_f32_16x16x32_bf16 v[52:55], v[180:183], v[164:167], v[52:55]
    ds_read_b64_tr_b16 v[222:223], v5 offset:12288
    v_mfma_f32_16x16x32_bf16 v[56:59], v[180:183], v[168:171], v[56:59]
    ds_read_b64_tr_b16 v[240:241], v10 offset:8192
    v_mfma_f32_16x16x32_bf16 v[60:63], v[180:183], v[172:175], v[60:63]
    ds_read_b64_tr_b16 v[242:243], v10 offset:12288
    v_mfma_f32_16x16x32_bf16 v[112:115], v[196:199], v[160:163], v[112:115]
    ds_read_b64_tr_b16 v[228:229], v7 offset:8192
    v_mfma_f32_16x16x32_bf16 v[116:119], v[196:199], v[164:167], v[116:119]
    ds_read_b64_tr_b16 v[230:231], v7 offset:12288
    v_mfma_f32_16x16x32_bf16 v[120:123], v[196:199], v[168:171], v[120:123]
    ds_read_b64_tr_b16 v[244:245], v11 offset:8192
    v_mfma_f32_16x16x32_bf16 v[124:127], v[196:199], v[172:175], v[124:127]
    ds_read_b64_tr_b16 v[246:247], v11 offset:12288
    v_mfma_f32_16x16x32_bf16 v[64:67], v[184:187], v[160:163], v[64:67]
    ds_read_b64_tr_b16 v[232:233], v8 offset:8192
    v_mfma_f32_16x16x32_bf16 v[68:71], v[184:187], v[164:167], v[68:71]
    ds_read_b64_tr_b16 v[234:235], v8 offset:12288
    v_mfma_f32_16x16x32_bf16 v[72:75], v[184:187], v[168:171], v[72:75]
    ds_read_b64_tr_b16 v[248:249], v12 offset:8192
    v_mfma_f32_16x16x32_bf16 v[76:79], v[184:187], v[172:175], v[76:79]
    ds_read_b64_tr_b16 v[250:251], v12 offset:12288
    v_mfma_f32_16x16x32_bf16 v[128:131], v[200:203], v[160:163], v[128:131]
    ds_read_b64_tr_b16 v[236:237], v9 offset:8192
    v_mfma_f32_16x16x32_bf16 v[132:135], v[200:203], v[164:167], v[132:135]
    ds_read_b64_tr_b16 v[238:239], v9 offset:12288
    v_mfma_f32_16x16x32_bf16 v[136:139], v[200:203], v[168:171], v[136:139]
    ds_read_b64_tr_b16 v[252:253], v13 offset:8192
    v_mfma_f32_16x16x32_bf16 v[140:143], v[200:203], v[172:175], v[140:143]
    ds_read_b64_tr_b16 v[254:255], v13 offset:12288
    v_mfma_f32_16x16x32_bf16 v[80:83], v[188:191], v[160:163], v[80:83]
    v_mfma_f32_16x16x32_bf16 v[84:87], v[188:191], v[164:167], v[84:87]
    v_mfma_f32_16x16x32_bf16 v[88:91], v[188:191], v[168:171], v[88:91]
    v_mfma_f32_16x16x32_bf16 v[92:95], v[188:191], v[172:175], v[92:95]
    v_mfma_f32_16x16x32_bf16 v[144:147], v[204:207], v[160:163], v[144:147]
    v_mfma_f32_16x16x32_bf16 v[148:151], v[204:207], v[164:167], v[148:151]
    v_mfma_f32_16x16x32_bf16 v[152:155], v[204:207], v[168:171], v[152:155]
    v_mfma_f32_16x16x32_bf16 v[156:159], v[204:207], v[172:175], v[156:159]
    s_waitcnt lgkmcnt(0)
    v_mfma_f32_16x16x32_bf16 v[32:35], v[224:227], v[208:211], v[32:35]
    ds_read_b64_tr_b16 v[160:161], v2 offset:16384
    v_mfma_f32_16x16x32_bf16 v[36:39], v[224:227], v[212:215], v[36:39]
    ds_read_b64_tr_b16 v[162:163], v2 offset:20480
    v_mfma_f32_16x16x32_bf16 v[40:43], v[224:227], v[216:219], v[40:43]
    ds_read_b64_tr_b16 v[176:177], v6 offset:16384
    v_mfma_f32_16x16x32_bf16 v[44:47], v[224:227], v[220:223], v[44:47]
    ds_read_b64_tr_b16 v[178:179], v6 offset:20480
    v_mfma_f32_16x16x32_bf16 v[96:99], v[240:243], v[208:211], v[96:99]
    ds_read_b64_tr_b16 v[164:165], v3 offset:16384
    v_mfma_f32_16x16x32_bf16 v[100:103], v[240:243], v[212:215], v[100:103]
    ds_read_b64_tr_b16 v[166:167], v3 offset:20480
    v_mfma_f32_16x16x32_bf16 v[104:107], v[240:243], v[216:219], v[104:107]
    ds_read_b64_tr_b16 v[168:169], v4 offset:16384
    v_mfma_f32_16x16x32_bf16 v[108:111], v[240:243], v[220:223], v[108:111]
    ds_read_b64_tr_b16 v[170:171], v4 offset:20480
    v_mfma_f32_16x16x32_bf16 v[48:51], v[228:231], v[208:211], v[48:51]
    ds_read_b64_tr_b16 v[172:173], v5 offset:16384
    v_mfma_f32_16x16x32_bf16 v[52:55], v[228:231], v[212:215], v[52:55]
    ds_read_b64_tr_b16 v[174:175], v5 offset:20480
    v_mfma_f32_16x16x32_bf16 v[56:59], v[228:231], v[216:219], v[56:59]
    ds_read_b64_tr_b16 v[192:193], v10 offset:16384
    v_mfma_f32_16x16x32_bf16 v[60:63], v[228:231], v[220:223], v[60:63]
    ds_read_b64_tr_b16 v[194:195], v10 offset:20480
    v_mfma_f32_16x16x32_bf16 v[112:115], v[244:247], v[208:211], v[112:115]
    ds_read_b64_tr_b16 v[180:181], v7 offset:16384
    v_mfma_f32_16x16x32_bf16 v[116:119], v[244:247], v[212:215], v[116:119]
    ds_read_b64_tr_b16 v[182:183], v7 offset:20480
    v_mfma_f32_16x16x32_bf16 v[120:123], v[244:247], v[216:219], v[120:123]
    ds_read_b64_tr_b16 v[196:197], v11 offset:16384
    v_mfma_f32_16x16x32_bf16 v[124:127], v[244:247], v[220:223], v[124:127]
    ds_read_b64_tr_b16 v[198:199], v11 offset:20480
    v_mfma_f32_16x16x32_bf16 v[64:67], v[232:235], v[208:211], v[64:67]
    ds_read_b64_tr_b16 v[184:185], v8 offset:16384
    v_mfma_f32_16x16x32_bf16 v[68:71], v[232:235], v[212:215], v[68:71]
    ds_read_b64_tr_b16 v[186:187], v8 offset:20480
    v_mfma_f32_16x16x32_bf16 v[72:75], v[232:235], v[216:219], v[72:75]
    ds_read_b64_tr_b16 v[200:201], v12 offset:16384
    v_mfma_f32_16x16x32_bf16 v[76:79], v[232:235], v[220:223], v[76:79]
    ds_read_b64_tr_b16 v[202:203], v12 offset:20480
    v_mfma_f32_16x16x32_bf16 v[128:131], v[248:251], v[208:211], v[128:131]
    ds_read_b64_tr_b16 v[188:189], v9 offset:16384
    v_mfma_f32_16x16x32_bf16 v[132:135], v[248:251], v[212:215], v[132:135]
    ds_read_b64_tr_b16 v[190:191], v9 offset:20480
    v_mfma_f32_16x16x32_bf16 v[136:139], v[248:251], v[216:219], v[136:139]
    ds_read_b64_tr_b16 v[204:205], v13 offset:16384
    v_mfma_f32_16x16x32_bf16 v[140:143], v[248:251], v[220:223], v[140:143]
    ds_read_b64_tr_b16 v[206:207], v13 offset:20480
    v_mfma_f32_16x16x32_bf16 v[80:83], v[236:239], v[208:211], v[80:83]
    v_mfma_f32_16x16x32_bf16 v[84:87], v[236:239], v[212:215], v[84:87]
    v_mfma_f32_16x16x32_bf16 v[88:91], v[236:239], v[216:219], v[88:91]
    v_mfma_f32_16x16x32_bf16 v[92:95], v[236:239], v[220:223], v[92:95]
    v_mfma_f32_16x16x32_bf16 v[144:147], v[252:255], v[208:211], v[144:147]
    v_mfma_f32_16x16x32_bf16 v[148:151], v[252:255], v[212:215], v[148:151]
    v_mfma_f32_16x16x32_bf16 v[152:155], v[252:255], v[216:219], v[152:155]
    v_mfma_f32_16x16x32_bf16 v[156:159], v[252:255], v[220:223], v[156:159]
    s_waitcnt lgkmcnt(0)
    v_mfma_f32_16x16x32_bf16 v[32:35], v[176:179], v[160:163], v[32:35]
    ds_read_b64_tr_b16 v[208:209], v2 offset:24576
    v_mfma_f32_16x16x32_bf16 v[36:39], v[176:179], v[164:167], v[36:39]
    ds_read_b64_tr_b16 v[210:211], v2 offset:28672
    v_mfma_f32_16x16x32_bf16 v[40:43], v[176:179], v[168:171], v[40:43]
    ds_read_b64_tr_b16 v[224:225], v6 offset:24576
    v_mfma_f32_16x16x32_bf16 v[44:47], v[176:179], v[172:175], v[44:47]
    ds_read_b64_tr_b16 v[226:227], v6 offset:28672
    v_mfma_f32_16x16x32_bf16 v[96:99], v[192:195], v[160:163], v[96:99]
    ds_read_b64_tr_b16 v[212:213], v3 offset:24576
    v_mfma_f32_16x16x32_bf16 v[100:103], v[192:195], v[164:167], v[100:103]
    ds_read_b64_tr_b16 v[214:215], v3 offset:28672
    v_mfma_f32_16x16x32_bf16 v[104:107], v[192:195], v[168:171], v[104:107]
    ds_read_b64_tr_b16 v[216:217], v4 offset:24576
    v_mfma_f32_16x16x32_bf16 v[108:111], v[192:195], v[172:175], v[108:111]
    ds_read_b64_tr_b16 v[218:219], v4 offset:28672
    v_mfma_f32_16x16x32_bf16 v[48:51], v[180:183], v[160:163], v[48:51]
    ds_read_b64_tr_b16 v[220:221], v5 offset:24576
    v_mfma_f32_16x16x32_bf16 v[52:55], v[180:183], v[164:167], v[52:55]
    ds_read_b64_tr_b16 v[222:223], v5 offset:28672
    v_mfma_f32_16x16x32_bf16 v[56:59], v[180:183], v[168:171], v[56:59]
    ds_read_b64_tr_b16 v[240:241], v10 offset:24576
    v_mfma_f32_16x16x32_bf16 v[60:63], v[180:183], v[172:175], v[60:63]
    ds_read_b64_tr_b16 v[242:243], v10 offset:28672
    v_mfma_f32_16x16x32_bf16 v[112:115], v[196:199], v[160:163], v[112:115]
    ds_read_b64_tr_b16 v[228:229], v7 offset:24576
    v_mfma_f32_16x16x32_bf16 v[116:119], v[196:199], v[164:167], v[116:119]
    ds_read_b64_tr_b16 v[230:231], v7 offset:28672
    v_mfma_f32_16x16x32_bf16 v[120:123], v[196:199], v[168:171], v[120:123]
    ds_read_b64_tr_b16 v[244:245], v11 offset:24576
    v_mfma_f32_16x16x32_bf16 v[124:127], v[196:199], v[172:175], v[124:127]
    ds_read_b64_tr_b16 v[246:247], v11 offset:28672
    v_mfma_f32_16x16x32_bf16 v[64:67], v[184:187], v[160:163], v[64:67]
    ds_read_b64_tr_b16 v[232:233], v8 offset:24576
    v_mfma_f32_16x16x32_bf16 v[68:71], v[184:187], v[164:167], v[68:71]
    ds_read_b64_tr_b16 v[234:235], v8 offset:28672
    v_mfma_f32_16x16x32_bf16 v[72:75], v[184:187], v[168:171], v[72:75]
    ds_read_b64_tr_b16 v[248:249], v12 offset:24576
    v_mfma_f32_16x16x32_bf16 v[76:79], v[184:187], v[172:175], v[76:79]
    ds_read_b64_tr_b16 v[250:251], v12 offset:28672
    v_mfma_f32_16x16x32_bf16 v[128:131], v[200:203], v[160:163], v[128:131]
    ds_read_b64_tr_b16 v[236:237], v9 offset:24576
    v_mfma_f32_16x16x32_bf16 v[132:135], v[200:203], v[164:167], v[132:135]
    ds_read_b64_tr_b16 v[238:239], v9 offset:28672
    v_mfma_f32_16x16x32_bf16 v[136:139], v[200:203], v[168:171], v[136:139]
    ds_read_b64_tr_b16 v[252:253], v13 offset:24576
    v_mfma_f32_16x16x32_bf16 v[140:143], v[200:203], v[172:175], v[140:143]
    ds_read_b64_tr_b16 v[254:255], v13 offset:28672
    v_mfma_f32_16x16x32_bf16 v[80:83], v[188:191], v[160:163], v[80:83]
    v_mfma_f32_16x16x32_bf16 v[84:87], v[188:191], v[164:167], v[84:87]
    v_mfma_f32_16x16x32_bf16 v[88:91], v[188:191], v[168:171], v[88:91]
    v_mfma_f32_16x16x32_bf16 v[92:95], v[188:191], v[172:175], v[92:95]
    v_mfma_f32_16x16x32_bf16 v[144:147], v[204:207], v[160:163], v[144:147]
    v_mfma_f32_16x16x32_bf16 v[148:151], v[204:207], v[164:167], v[148:151]
    v_mfma_f32_16x16x32_bf16 v[152:155], v[204:207], v[168:171], v[152:155]
    v_mfma_f32_16x16x32_bf16 v[156:159], v[204:207], v[172:175], v[156:159]
    s_waitcnt lgkmcnt(0)
    v_mfma_f32_16x16x32_bf16 v[32:35], v[224:227], v[208:211], v[32:35]
    v_mfma_f32_16x16x32_bf16 v[36:39], v[224:227], v[212:215], v[36:39]
    v_mfma_f32_16x16x32_bf16 v[40:43], v[224:227], v[216:219], v[40:43]
    v_mfma_f32_16x16x32_bf16 v[44:47], v[224:227], v[220:223], v[44:47]
    v_mfma_f32_16x16x32_bf16 v[96:99], v[240:243], v[208:211], v[96:99]
    v_mfma_f32_16x16x32_bf16 v[100:103], v[240:243], v[212:215], v[100:103]
    v_mfma_f32_16x16x32_bf16 v[104:107], v[240:243], v[216:219], v[104:107]
    v_mfma_f32_16x16x32_bf16 v[108:111], v[240:243], v[220:223], v[108:111]
    v_mfma_f32_16x16x32_bf16 v[48:51], v[228:231], v[208:211], v[48:51]
    v_mfma_f32_16x16x32_bf16 v[52:55], v[228:231], v[212:215], v[52:55]
    v_mfma_f32_16x16x32_bf16 v[56:59], v[228:231], v[216:219], v[56:59]
    v_mfma_f32_16x16x32_bf16 v[60:63], v[228:231], v[220:223], v[60:63]
    v_mfma_f32_16x16x32_bf16 v[112:115], v[244:247], v[208:211], v[112:115]
    v_mfma_f32_16x16x32_bf16 v[116:119], v[244:247], v[212:215], v[116:119]
    v_mfma_f32_16x16x32_bf16 v[120:123], v[244:247], v[216:219], v[120:123]
    v_mfma_f32_16x16x32_bf16 v[124:127], v[244:247], v[220:223], v[124:127]
    v_mfma_f32_16x16x32_bf16 v[64:67], v[232:235], v[208:211], v[64:67]
    v_mfma_f32_16x16x32_bf16 v[68:71], v[232:235], v[212:215], v[68:71]
    v_mfma_f32_16x16x32_bf16 v[72:75], v[232:235], v[216:219], v[72:75]
    v_mfma_f32_16x16x32_bf16 v[76:79], v[232:235], v[220:223], v[76:79]
    s_barrier
    v_mfma_f32_16x16x32_bf16 v[128:131], v[248:251], v[208:211], v[128:131]
    ds_read_b128 v[160:163], v14 offset:0
    v_mfma_f32_16x16x32_bf16 v[132:135], v[248:251], v[212:215], v[132:135]
    ds_read_b128 v[164:167], v14 offset:64
    v_mfma_f32_16x16x32_bf16 v[136:139], v[248:251], v[216:219], v[136:139]
    ds_read_b128 v[168:171], v14 offset:128
    v_mfma_f32_16x16x32_bf16 v[140:143], v[248:251], v[220:223], v[140:143]
    ds_read_b128 v[172:175], v14 offset:192
    v_mfma_f32_16x16x32_bf16 v[80:83], v[236:239], v[208:211], v[80:83]
    ds_read_b128 v[176:179], v14 offset:512
    v_mfma_f32_16x16x32_bf16 v[84:87], v[236:239], v[212:215], v[84:87]
    ds_read_b128 v[180:183], v14 offset:576
    v_mfma_f32_16x16x32_bf16 v[88:91], v[236:239], v[216:219], v[88:91]
    ds_read_b128 v[184:187], v14 offset:640
    v_mfma_f32_16x16x32_bf16 v[92:95], v[236:239], v[220:223], v[92:95]
    ds_read_b128 v[188:191], v14 offset:704
    v_mfma_f32_16x16x32_bf16 v[144:147], v[252:255], v[208:211], v[144:147]
    ds_read_b128 v[192:195], v15 offset:0
    v_mfma_f32_16x16x32_bf16 v[148:151], v[252:255], v[212:215], v[148:151]
    ds_read_b128 v[196:199], v15 offset:256
    v_mfma_f32_16x16x32_bf16 v[152:155], v[252:255], v[216:219], v[152:155]
    ds_read_b128 v[200:203], v15 offset:512
    v_mfma_f32_16x16x32_bf16 v[156:159], v[252:255], v[220:223], v[156:159]
    ds_read_b128 v[204:207], v15 offset:768
    s_waitcnt lgkmcnt(0)
    v_pk_fma_f32 v[32:33], v[160:161], v[192:193], v[32:33] op_sel_hi:[1,0,1]
    v_pk_fma_f32 v[34:35], v[162:163], v[192:193], v[34:35] op_sel_hi:[1,0,1]
    v_pk_fma_f32 v[48:49], v[164:165], v[192:193], v[48:49] op_sel_hi:[1,0,1]
    v_pk_fma_f32 v[50:51], v[166:167], v[192:193], v[50:51] op_sel_hi:[1,0,1]
    v_pk_mul_f32 v[208:209], v[32:33], v[194:195] op_sel_hi:[1,0]
    v_pk_mul_f32 v[210:211], v[34:35], v[194:195] op_sel_hi:[1,0]
    v_pk_mul_f32 v[212:213], v[48:49], v[194:195] op_sel_hi:[1,0]
    v_pk_mul_f32 v[214:215], v[50:51], v[194:195] op_sel_hi:[1,0]
    v_exp_f32 v208, v208
    v_exp_f32 v209, v209
    v_exp_f32 v210, v210
    v_exp_f32 v211, v211
    v_exp_f32 v212, v212
    v_exp_f32 v213, v213
    v_exp_f32 v214, v214
    v_exp_f32 v215, v215
    v_pk_fma_f32 v[96:97], v[176:177], v[192:193], v[96:97] op_sel_hi:[1,0,1]
    v_pk_fma_f32 v[98:99], v[178:179], v[192:193], v[98:99] op_sel_hi:[1,0,1]
    v_pk_fma_f32 v[112:113], v[180:181], v[192:193], v[112:113] op_sel_hi:[1,0,1]
    v_pk_fma_f32 v[114:115], v[182:183], v[192:193], v[114:115] op_sel_hi:[1,0,1]
    v_pk_fma_f32 v[208:209], v[208:209], v[194:195], v[194:195] op_sel:[0,1,1] op_sel_hi:[1,1,1]
    v_pk_fma_f32 v[210:211], v[210:211], v[194:195], v[194:195] op_sel:[0,1,1] op_sel_hi:[1,1,1]
    v_pk_fma_f32 v[212:213], v[212:213], v[194:195], v[194:195] op_sel:[0,1,1] op_sel_hi:[1,1,1]
    v_pk_fma_f32 v[214:215], v[214:215], v[194:195], v[194:195] op_sel:[0,1,1] op_sel_hi:[1,1,1]
    v_rcp_f32 v208, v208
    v_rcp_f32 v209, v209
    v_rcp_f32 v210, v210
    v_rcp_f32 v211, v211
    v_rcp_f32 v212, v212
    v_rcp_f32 v213, v213
    v_rcp_f32 v214, v214
    v_rcp_f32 v215, v215
    v_pk_mul_f32 v[32:33], v[32:33], v[96:97]
    v_pk_mul_f32 v[34:35], v[34:35], v[98:99]
    v_pk_mul_f32 v[48:49], v[48:49], v[112:113]
    v_pk_mul_f32 v[50:51], v[50:51], v[114:115]
    v_pk_mul_f32 v[32:33], v[32:33], v[208:209]
    v_pk_mul_f32 v[34:35], v[34:35], v[210:211]
    v_pk_mul_f32 v[48:49], v[48:49], v[212:213]
    v_pk_mul_f32 v[50:51], v[50:51], v[214:215]
    v_cvt_pk_bf16_f32 v224, v32, v33
    v_cvt_pk_bf16_f32 v225, v34, v35
    v_cvt_pk_bf16_f32 v226, v48, v49
    v_cvt_pk_bf16_f32 v227, v50, v51
    global_store_dwordx4 v16, v[224:227], s[42:43] offset:0 sc1
    v_pk_fma_f32 v[36:37], v[160:161], v[196:197], v[36:37] op_sel_hi:[1,0,1]
    v_pk_fma_f32 v[38:39], v[162:163], v[196:197], v[38:39] op_sel_hi:[1,0,1]
    v_pk_fma_f32 v[52:53], v[164:165], v[196:197], v[52:53] op_sel_hi:[1,0,1]
    v_pk_fma_f32 v[54:55], v[166:167], v[196:197], v[54:55] op_sel_hi:[1,0,1]
    v_pk_mul_f32 v[216:217], v[36:37], v[198:199] op_sel_hi:[1,0]
    v_pk_mul_f32 v[218:219], v[38:39], v[198:199] op_sel_hi:[1,0]
    v_pk_mul_f32 v[220:221], v[52:53], v[198:199] op_sel_hi:[1,0]
    v_pk_mul_f32 v[222:223], v[54:55], v[198:199] op_sel_hi:[1,0]
    v_exp_f32 v216, v216
    v_exp_f32 v217, v217
    v_exp_f32 v218, v218
    v_exp_f32 v219, v219
    v_exp_f32 v220, v220
    v_exp_f32 v221, v221
    v_exp_f32 v222, v222
    v_exp_f32 v223, v223
    v_pk_fma_f32 v[100:101], v[176:177], v[196:197], v[100:101] op_sel_hi:[1,0,1]
    v_pk_fma_f32 v[102:103], v[178:179], v[196:197], v[102:103] op_sel_hi:[1,0,1]
    v_pk_fma_f32 v[116:117], v[180:181], v[196:197], v[116:117] op_sel_hi:[1,0,1]
    v_pk_fma_f32 v[118:119], v[182:183], v[196:197], v[118:119] op_sel_hi:[1,0,1]
    v_pk_fma_f32 v[216:217], v[216:217], v[198:199], v[198:199] op_sel:[0,1,1] op_sel_hi:[1,1,1]
    v_pk_fma_f32 v[218:219], v[218:219], v[198:199], v[198:199] op_sel:[0,1,1] op_sel_hi:[1,1,1]
    v_pk_fma_f32 v[220:221], v[220:221], v[198:199], v[198:199] op_sel:[0,1,1] op_sel_hi:[1,1,1]
    v_pk_fma_f32 v[222:223], v[222:223], v[198:199], v[198:199] op_sel:[0,1,1] op_sel_hi:[1,1,1]
    v_rcp_f32 v216, v216
    v_rcp_f32 v217, v217
    v_rcp_f32 v218, v218
    v_rcp_f32 v219, v219
    v_rcp_f32 v220, v220
    v_rcp_f32 v221, v221
    v_rcp_f32 v222, v222
    v_rcp_f32 v223, v223
    v_pk_mul_f32 v[36:37], v[36:37], v[100:101]
    v_pk_mul_f32 v[38:39], v[38:39], v[102:103]
    v_pk_mul_f32 v[52:53], v[52:53], v[116:117]
    v_pk_mul_f32 v[54:55], v[54:55], v[118:119]
    v_pk_mul_f32 v[36:37], v[36:37], v[216:217]
    v_pk_mul_f32 v[38:39], v[38:39], v[218:219]
    v_pk_mul_f32 v[52:53], v[52:53], v[220:221]
    v_pk_mul_f32 v[54:55], v[54:55], v[222:223]
    v_cvt_pk_bf16_f32 v228, v36, v37
    v_cvt_pk_bf16_f32 v229, v38, v39
    v_cvt_pk_bf16_f32 v230, v52, v53
    v_cvt_pk_bf16_f32 v231, v54, v55
    global_store_dwordx4 v16, v[228:231], s[44:45] offset:0 sc1
    v_pk_fma_f32 v[40:41], v[160:161], v[200:201], v[40:41] op_sel_hi:[1,0,1]
    v_pk_fma_f32 v[42:43], v[162:163], v[200:201], v[42:43] op_sel_hi:[1,0,1]
    v_pk_fma_f32 v[56:57], v[164:165], v[200:201], v[56:57] op_sel_hi:[1,0,1]
    v_pk_fma_f32 v[58:59], v[166:167], v[200:201], v[58:59] op_sel_hi:[1,0,1]
    v_pk_mul_f32 v[208:209], v[40:41], v[202:203] op_sel_hi:[1,0]
    v_pk_mul_f32 v[210:211], v[42:43], v[202:203] op_sel_hi:[1,0]
    v_pk_mul_f32 v[212:213], v[56:57], v[202:203] op_sel_hi:[1,0]
    v_pk_mul_f32 v[214:215], v[58:59], v[202:203] op_sel_hi:[1,0]
    v_exp_f32 v208, v208
    v_exp_f32 v209, v209
    v_exp_f32 v210, v210
    v_exp_f32 v211, v211
    v_exp_f32 v212, v212
    v_exp_f32 v213, v213
    v_exp_f32 v214, v214
    v_exp_f32 v215, v215
    v_pk_fma_f32 v[104:105], v[176:177], v[200:201], v[104:105] op_sel_hi:[1,0,1]
    v_pk_fma_f32 v[106:107], v[178:179], v[200:201], v[106:107] op_sel_hi:[1,0,1]
    v_pk_fma_f32 v[120:121], v[180:181], v[200:201], v[120:121] op_sel_hi:[1,0,1]
    v_pk_fma_f32 v[122:123], v[182:183], v[200:201], v[122:123] op_sel_hi:[1,0,1]
    v_pk_fma_f32 v[208:209], v[208:209], v[202:203], v[202:203] op_sel:[0,1,1] op_sel_hi:[1,1,1]
    v_pk_fma_f32 v[210:211], v[210:211], v[202:203], v[202:203] op_sel:[0,1,1] op_sel_hi:[1,1,1]
    v_pk_fma_f32 v[212:213], v[212:213], v[202:203], v[202:203] op_sel:[0,1,1] op_sel_hi:[1,1,1]
    v_pk_fma_f32 v[214:215], v[214:215], v[202:203], v[202:203] op_sel:[0,1,1] op_sel_hi:[1,1,1]
    v_rcp_f32 v208, v208
    v_rcp_f32 v209, v209
    v_rcp_f32 v210, v210
    v_rcp_f32 v211, v211
    v_rcp_f32 v212, v212
    v_rcp_f32 v213, v213
    v_rcp_f32 v214, v214
    v_rcp_f32 v215, v215
    v_pk_mul_f32 v[40:41], v[40:41], v[104:105]
    v_pk_mul_f32 v[42:43], v[42:43], v[106:107]
    v_pk_mul_f32 v[56:57], v[56:57], v[120:121]
    v_pk_mul_f32 v[58:59], v[58:59], v[122:123]
    v_pk_mul_f32 v[40:41], v[40:41], v[208:209]
    v_pk_mul_f32 v[42:43], v[42:43], v[210:211]
    v_pk_mul_f32 v[56:57], v[56:57], v[212:213]
    v_pk_mul_f32 v[58:59], v[58:59], v[214:215]
    v_cvt_pk_bf16_f32 v232, v40, v41
    v_cvt_pk_bf16_f32 v233, v42, v43
    v_cvt_pk_bf16_f32 v234, v56, v57
    v_cvt_pk_bf16_f32 v235, v58, v59
    global_store_dwordx4 v16, v[232:235], s[46:47] offset:0 sc1
    v_pk_fma_f32 v[44:45], v[160:161], v[204:205], v[44:45] op_sel_hi:[1,0,1]
    v_pk_fma_f32 v[46:47], v[162:163], v[204:205], v[46:47] op_sel_hi:[1,0,1]
    v_pk_fma_f32 v[60:61], v[164:165], v[204:205], v[60:61] op_sel_hi:[1,0,1]
    v_pk_fma_f32 v[62:63], v[166:167], v[204:205], v[62:63] op_sel_hi:[1,0,1]
    v_pk_mul_f32 v[216:217], v[44:45], v[206:207] op_sel_hi:[1,0]
    v_pk_mul_f32 v[218:219], v[46:47], v[206:207] op_sel_hi:[1,0]
    v_pk_mul_f32 v[220:221], v[60:61], v[206:207] op_sel_hi:[1,0]
    v_pk_mul_f32 v[222:223], v[62:63], v[206:207] op_sel_hi:[1,0]
    v_exp_f32 v216, v216
    v_exp_f32 v217, v217
    v_exp_f32 v218, v218
    v_exp_f32 v219, v219
    v_exp_f32 v220, v220
    v_exp_f32 v221, v221
    v_exp_f32 v222, v222
    v_exp_f32 v223, v223
    v_pk_fma_f32 v[108:109], v[176:177], v[204:205], v[108:109] op_sel_hi:[1,0,1]
    v_pk_fma_f32 v[110:111], v[178:179], v[204:205], v[110:111] op_sel_hi:[1,0,1]
    v_pk_fma_f32 v[124:125], v[180:181], v[204:205], v[124:125] op_sel_hi:[1,0,1]
    v_pk_fma_f32 v[126:127], v[182:183], v[204:205], v[126:127] op_sel_hi:[1,0,1]
    v_pk_fma_f32 v[216:217], v[216:217], v[206:207], v[206:207] op_sel:[0,1,1] op_sel_hi:[1,1,1]
    v_pk_fma_f32 v[218:219], v[218:219], v[206:207], v[206:207] op_sel:[0,1,1] op_sel_hi:[1,1,1]
    v_pk_fma_f32 v[220:221], v[220:221], v[206:207], v[206:207] op_sel:[0,1,1] op_sel_hi:[1,1,1]
    v_pk_fma_f32 v[222:223], v[222:223], v[206:207], v[206:207] op_sel:[0,1,1] op_sel_hi:[1,1,1]
    v_rcp_f32 v216, v216
    v_rcp_f32 v217, v217
    v_rcp_f32 v218, v218
    v_rcp_f32 v219, v219
    v_rcp_f32 v220, v220
    v_rcp_f32 v221, v221
    v_rcp_f32 v222, v222
    v_rcp_f32 v223, v223
    v_pk_mul_f32 v[44:45], v[44:45], v[108:109]
    v_pk_mul_f32 v[46:47], v[46:47], v[110:111]
    v_pk_mul_f32 v[60:61], v[60:61], v[124:125]
    v_pk_mul_f32 v[62:63], v[62:63], v[126:127]
    v_pk_mul_f32 v[44:45], v[44:45], v[216:217]
    v_pk_mul_f32 v[46:47], v[46:47], v[218:219]
    v_pk_mul_f32 v[60:61], v[60:61], v[220:221]
    v_pk_mul_f32 v[62:63], v[62:63], v[222:223]
    v_cvt_pk_bf16_f32 v236, v44, v45
    v_cvt_pk_bf16_f32 v237, v46, v47
    v_cvt_pk_bf16_f32 v238, v60, v61
    v_cvt_pk_bf16_f32 v239, v62, v63
    global_store_dwordx4 v16, v[236:239], s[48:49] offset:0 sc1
    v_pk_fma_f32 v[64:65], v[168:169], v[192:193], v[64:65] op_sel_hi:[1,0,1]
    v_pk_fma_f32 v[66:67], v[170:171], v[192:193], v[66:67] op_sel_hi:[1,0,1]
    v_pk_fma_f32 v[80:81], v[172:173], v[192:193], v[80:81] op_sel_hi:[1,0,1]
    v_pk_fma_f32 v[82:83], v[174:175], v[192:193], v[82:83] op_sel_hi:[1,0,1]
    v_pk_mul_f32 v[208:209], v[64:65], v[194:195] op_sel_hi:[1,0]
    v_pk_mul_f32 v[210:211], v[66:67], v[194:195] op_sel_hi:[1,0]
    v_pk_mul_f32 v[212:213], v[80:81], v[194:195] op_sel_hi:[1,0]
    v_pk_mul_f32 v[214:215], v[82:83], v[194:195] op_sel_hi:[1,0]
    v_exp_f32 v208, v208
    v_exp_f32 v209, v209
    v_exp_f32 v210, v210
    v_exp_f32 v211, v211
    v_exp_f32 v212, v212
    v_exp_f32 v213, v213
    v_exp_f32 v214, v214
    v_exp_f32 v215, v215
    v_pk_fma_f32 v[128:129], v[184:185], v[192:193], v[128:129] op_sel_hi:[1,0,1]
    v_pk_fma_f32 v[130:131], v[186:187], v[192:193], v[130:131] op_sel_hi:[1,0,1]
    v_pk_fma_f32 v[144:145], v[188:189], v[192:193], v[144:145] op_sel_hi:[1,0,1]
    v_pk_fma_f32 v[146:147], v[190:191], v[192:193], v[146:147] op_sel_hi:[1,0,1]
    v_pk_fma_f32 v[208:209], v[208:209], v[194:195], v[194:195] op_sel:[0,1,1] op_sel_hi:[1,1,1]
    v_pk_fma_f32 v[210:211], v[210:211], v[194:195], v[194:195] op_sel:[0,1,1] op_sel_hi:[1,1,1]
    v_pk_fma_f32 v[212:213], v[212:213], v[194:195], v[194:195] op_sel:[0,1,1] op_sel_hi:[1,1,1]
    v_pk_fma_f32 v[214:215], v[214:215], v[194:195], v[194:195] op_sel:[0,1,1] op_sel_hi:[1,1,1]
    v_rcp_f32 v208, v208
    v_rcp_f32 v209, v209
    v_rcp_f32 v210, v210
    v_rcp_f32 v211, v211
    v_rcp_f32 v212, v212
    v_rcp_f32 v213, v213
    v_rcp_f32 v214, v214
    v_rcp_f32 v215, v215
    v_pk_mul_f32 v[64:65], v[64:65], v[128:129]
    v_pk_mul_f32 v[66:67], v[66:67], v[130:131]
    v_pk_mul_f32 v[80:81], v[80:81], v[144:145]
    v_pk_mul_f32 v[82:83], v[82:83], v[146:147]
    v_pk_mul_f32 v[64:65], v[64:65], v[208:209]
    v_pk_mul_f32 v[66:67], v[66:67], v[210:211]
    v_pk_mul_f32 v[80:81], v[80:81], v[212:213]
    v_pk_mul_f32 v[82:83], v[82:83], v[214:215]
    v_cvt_pk_bf16_f32 v224, v64, v65
    v_cvt_pk_bf16_f32 v225, v66, v67
    v_cvt_pk_bf16_f32 v226, v80, v81
    v_cvt_pk_bf16_f32 v227, v82, v83
    global_store_dwordx4 v16, v[224:227], s[42:43] offset:1024 sc1
    v_pk_fma_f32 v[68:69], v[168:169], v[196:197], v[68:69] op_sel_hi:[1,0,1]
    v_pk_fma_f32 v[70:71], v[170:171], v[196:197], v[70:71] op_sel_hi:[1,0,1]
    v_pk_fma_f32 v[84:85], v[172:173], v[196:197], v[84:85] op_sel_hi:[1,0,1]
    v_pk_fma_f32 v[86:87], v[174:175], v[196:197], v[86:87] op_sel_hi:[1,0,1]
    v_pk_mul_f32 v[216:217], v[68:69], v[198:199] op_sel_hi:[1,0]
    v_pk_mul_f32 v[218:219], v[70:71], v[198:199] op_sel_hi:[1,0]
    v_pk_mul_f32 v[220:221], v[84:85], v[198:199] op_sel_hi:[1,0]
    v_pk_mul_f32 v[222:223], v[86:87], v[198:199] op_sel_hi:[1,0]
    v_exp_f32 v216, v216
    v_exp_f32 v217, v217
    v_exp_f32 v218, v218
    v_exp_f32 v219, v219
    v_exp_f32 v220, v220
    v_exp_f32 v221, v221
    v_exp_f32 v222, v222
    v_exp_f32 v223, v223
    v_pk_fma_f32 v[132:133], v[184:185], v[196:197], v[132:133] op_sel_hi:[1,0,1]
    v_pk_fma_f32 v[134:135], v[186:187], v[196:197], v[134:135] op_sel_hi:[1,0,1]
    v_pk_fma_f32 v[148:149], v[188:189], v[196:197], v[148:149] op_sel_hi:[1,0,1]
    v_pk_fma_f32 v[150:151], v[190:191], v[196:197], v[150:151] op_sel_hi:[1,0,1]
    v_pk_fma_f32 v[216:217], v[216:217], v[198:199], v[198:199] op_sel:[0,1,1] op_sel_hi:[1,1,1]
    v_pk_fma_f32 v[218:219], v[218:219], v[198:199], v[198:199] op_sel:[0,1,1] op_sel_hi:[1,1,1]
    v_pk_fma_f32 v[220:221], v[220:221], v[198:199], v[198:199] op_sel:[0,1,1] op_sel_hi:[1,1,1]
    v_pk_fma_f32 v[222:223], v[222:223], v[198:199], v[198:199] op_sel:[0,1,1] op_sel_hi:[1,1,1]
    v_rcp_f32 v216, v216
    v_rcp_f32 v217, v217
    v_rcp_f32 v218, v218
    v_rcp_f32 v219, v219
    v_rcp_f32 v220, v220
    v_rcp_f32 v221, v221
    v_rcp_f32 v222, v222
    v_rcp_f32 v223, v223
    v_pk_mul_f32 v[68:69], v[68:69], v[132:133]
    v_pk_mul_f32 v[70:71], v[70:71], v[134:135]
    v_pk_mul_f32 v[84:85], v[84:85], v[148:149]
    v_pk_mul_f32 v[86:87], v[86:87], v[150:151]
    v_pk_mul_f32 v[68:69], v[68:69], v[216:217]
    v_pk_mul_f32 v[70:71], v[70:71], v[218:219]
    v_pk_mul_f32 v[84:85], v[84:85], v[220:221]
    v_pk_mul_f32 v[86:87], v[86:87], v[222:223]
    v_cvt_pk_bf16_f32 v228, v68, v69
    v_cvt_pk_bf16_f32 v229, v70, v71
    v_cvt_pk_bf16_f32 v230, v84, v85
    v_cvt_pk_bf16_f32 v231, v86, v87
    global_store_dwordx4 v16, v[228:231], s[44:45] offset:1024 sc1
    v_pk_fma_f32 v[72:73], v[168:169], v[200:201], v[72:73] op_sel_hi:[1,0,1]
    v_pk_fma_f32 v[74:75], v[170:171], v[200:201], v[74:75] op_sel_hi:[1,0,1]
    v_pk_fma_f32 v[88:89], v[172:173], v[200:201], v[88:89] op_sel_hi:[1,0,1]
    v_pk_fma_f32 v[90:91], v[174:175], v[200:201], v[90:91] op_sel_hi:[1,0,1]
    v_pk_mul_f32 v[208:209], v[72:73], v[202:203] op_sel_hi:[1,0]
    v_pk_mul_f32 v[210:211], v[74:75], v[202:203] op_sel_hi:[1,0]
    v_pk_mul_f32 v[212:213], v[88:89], v[202:203] op_sel_hi:[1,0]
    v_pk_mul_f32 v[214:215], v[90:91], v[202:203] op_sel_hi:[1,0]
    v_exp_f32 v208, v208
    v_exp_f32 v209, v209
    v_exp_f32 v210, v210
    v_exp_f32 v211, v211
    v_exp_f32 v212, v212
    v_exp_f32 v213, v213
    v_exp_f32 v214, v214
    v_exp_f32 v215, v215
    v_pk_fma_f32 v[136:137], v[184:185], v[200:201], v[136:137] op_sel_hi:[1,0,1]
    v_pk_fma_f32 v[138:139], v[186:187], v[200:201], v[138:139] op_sel_hi:[1,0,1]
    v_pk_fma_f32 v[152:153], v[188:189], v[200:201], v[152:153] op_sel_hi:[1,0,1]
    v_pk_fma_f32 v[154:155], v[190:191], v[200:201], v[154:155] op_sel_hi:[1,0,1]
    v_pk_fma_f32 v[208:209], v[208:209], v[202:203], v[202:203] op_sel:[0,1,1] op_sel_hi:[1,1,1]
    v_pk_fma_f32 v[210:211], v[210:211], v[202:203], v[202:203] op_sel:[0,1,1] op_sel_hi:[1,1,1]
    v_pk_fma_f32 v[212:213], v[212:213], v[202:203], v[202:203] op_sel:[0,1,1] op_sel_hi:[1,1,1]
    v_pk_fma_f32 v[214:215], v[214:215], v[202:203], v[202:203] op_sel:[0,1,1] op_sel_hi:[1,1,1]
    v_rcp_f32 v208, v208
    v_rcp_f32 v209, v209
    v_rcp_f32 v210, v210
    v_rcp_f32 v211, v211
    v_rcp_f32 v212, v212
    v_rcp_f32 v213, v213
    v_rcp_f32 v214, v214
    v_rcp_f32 v215, v215
    v_pk_mul_f32 v[72:73], v[72:73], v[136:137]
    v_pk_mul_f32 v[74:75], v[74:75], v[138:139]
    v_pk_mul_f32 v[88:89], v[88:89], v[152:153]
    v_pk_mul_f32 v[90:91], v[90:91], v[154:155]
    v_pk_mul_f32 v[72:73], v[72:73], v[208:209]
    v_pk_mul_f32 v[74:75], v[74:75], v[210:211]
    v_pk_mul_f32 v[88:89], v[88:89], v[212:213]
    v_pk_mul_f32 v[90:91], v[90:91], v[214:215]
    v_cvt_pk_bf16_f32 v232, v72, v73
    v_cvt_pk_bf16_f32 v233, v74, v75
    v_cvt_pk_bf16_f32 v234, v88, v89
    v_cvt_pk_bf16_f32 v235, v90, v91
    global_store_dwordx4 v16, v[232:235], s[46:47] offset:1024 sc1
    v_pk_fma_f32 v[76:77], v[168:169], v[204:205], v[76:77] op_sel_hi:[1,0,1]
    v_pk_fma_f32 v[78:79], v[170:171], v[204:205], v[78:79] op_sel_hi:[1,0,1]
    v_pk_fma_f32 v[92:93], v[172:173], v[204:205], v[92:93] op_sel_hi:[1,0,1]
    v_pk_fma_f32 v[94:95], v[174:175], v[204:205], v[94:95] op_sel_hi:[1,0,1]
    v_pk_mul_f32 v[216:217], v[76:77], v[206:207] op_sel_hi:[1,0]
    v_pk_mul_f32 v[218:219], v[78:79], v[206:207] op_sel_hi:[1,0]
    v_pk_mul_f32 v[220:221], v[92:93], v[206:207] op_sel_hi:[1,0]
    v_pk_mul_f32 v[222:223], v[94:95], v[206:207] op_sel_hi:[1,0]
    v_exp_f32 v216, v216
    v_exp_f32 v217, v217
    v_exp_f32 v218, v218
    v_exp_f32 v219, v219
    v_exp_f32 v220, v220
    v_exp_f32 v221, v221
    v_exp_f32 v222, v222
    v_exp_f32 v223, v223
    v_pk_fma_f32 v[140:141], v[184:185], v[204:205], v[140:141] op_sel_hi:[1,0,1]
    v_pk_fma_f32 v[142:143], v[186:187], v[204:205], v[142:143] op_sel_hi:[1,0,1]
    v_pk_fma_f32 v[156:157], v[188:189], v[204:205], v[156:157] op_sel_hi:[1,0,1]
    v_pk_fma_f32 v[158:159], v[190:191], v[204:205], v[158:159] op_sel_hi:[1,0,1]
    v_pk_fma_f32 v[216:217], v[216:217], v[206:207], v[206:207] op_sel:[0,1,1] op_sel_hi:[1,1,1]
    v_pk_fma_f32 v[218:219], v[218:219], v[206:207], v[206:207] op_sel:[0,1,1] op_sel_hi:[1,1,1]
    v_pk_fma_f32 v[220:221], v[220:221], v[206:207], v[206:207] op_sel:[0,1,1] op_sel_hi:[1,1,1]
    v_pk_fma_f32 v[222:223], v[222:223], v[206:207], v[206:207] op_sel:[0,1,1] op_sel_hi:[1,1,1]
    v_rcp_f32 v216, v216
    v_rcp_f32 v217, v217
    v_rcp_f32 v218, v218
    v_rcp_f32 v219, v219
    v_rcp_f32 v220, v220
    v_rcp_f32 v221, v221
    v_rcp_f32 v222, v222
    v_rcp_f32 v223, v223
    v_pk_mul_f32 v[76:77], v[76:77], v[140:141]
    v_pk_mul_f32 v[78:79], v[78:79], v[142:143]
    v_pk_mul_f32 v[92:93], v[92:93], v[156:157]
    v_pk_mul_f32 v[94:95], v[94:95], v[158:159]
    v_pk_mul_f32 v[76:77], v[76:77], v[216:217]
    v_pk_mul_f32 v[78:79], v[78:79], v[218:219]
    v_pk_mul_f32 v[92:93], v[92:93], v[220:221]
    v_pk_mul_f32 v[94:95], v[94:95], v[222:223]
    v_cvt_pk_bf16_f32 v236, v76, v77
    v_cvt_pk_bf16_f32 v237, v78, v79
    v_cvt_pk_bf16_f32 v238, v92, v93
    v_cvt_pk_bf16_f32 v239, v94, v95
    global_store_dwordx4 v16, v[236:239], s[48:49] offset:1024 sc1
    s_lshl_b32 s28, s23, 1
    s_add_u32 s28, s28, s26
    s_lshl_b32 s28, s28, 8
    s_lshl_b32 s29, s24, 4
    s_add_u32 s28, s28, s29
    s_lshl_b32 s29, s27, 3
    s_add_u32 s28, s28, s29
    s_lshl_b32 s28, s28, 0
    s_add_u32 s28, s28, 0x1150000
    v_mov_b32 v250, s28
    s_lshl_b32 s28, s2, 7
    s_add_u32 s28, s28, 0x1104000
    v_writelane_b32 v250, s28, 1
    s_lshr_b32 s28, s2, 5
    s_lshl_b32 s29, s20, 3
    s_add_u32 s28, s28, s29
    s_cmp_eq_u32 s28, 1
    s_cselect_b32 s62, 3, 1
    s_mov_b32 s63, 0
K3_P2:
    s_and_b32 s26, s20, 1
    s_lshr_b32 s27, s20, 1
    v_lshrrev_b32 v12, 5, v1
    v_bfe_u32 v11, v1, 4, 1
    v_bfe_u32 v8, v1, 2, 2
    v_and_b32 v9, 3, v1
    v_and_or_b32 v10, v8, 2, v12
    v_xor_b32 v10, v10, v11
    v_lshl_add_u32 v8, v12, 2, v8
    v_lshlrev_b32 v8, 7, v8
    v_lshl_add_u32 v8, v9, 3, v8
    s_lshl_b32 s28, s27, 12
    v_add_u32 v8, s28, v8
    s_lshl_b32 s29, s27, 1
    v_xor_b32 v9, s29, v10
    v_lshl_add_u32 v96, v9, 5, v8
    v_xor_b32 v97, 64, v96
    v_add_u32 v98, 0x10000, v96
    v_add_u32 v99, 0x10000, v97
    v_add_u32 v100, 0x20000, v96
    v_add_u32 v101, 0x20000, v97
    s_lshl_b32 s29, s26, 1
    v_xor_b32 v9, s29, v10
    v_lshl_add_u32 v9, v9, 5, v8
    v_add_u32 v108, 150528, v9
    v_and_b32 v13, 15, v1
    v_mul_u32_u24 v4, 57344, v11
    v_lshl_add_u32 v4, v12, 8, v4
    v_lshl_add_u32 v4, v13, 4, v4
    s_mul_i32 s28, s26, 114688
    s_lshl_b32 s29, s27, 10
    s_add_u32 s28, s28, s29
    v_add_u32 v4, s28, v4
    s_mul_i32 s29, s60, 229376
    s_add_u32 s29, s29, 0xa00000
    s_add_u32 s40, s14, s29
    s_addc_u32 s41, s15, 0
    s_mov_b32 s42, 229376
    s_mov_b32 s43, 0x20000
    v_lshlrev_b32 v13, 4, v1
    s_mul_i32 s28, s26, 49152
    s_add_u32 s28, s28, 57344
    s_lshl_b32 s29, s27, 12
    s_add_u32 s32, s28, s29
    v_add_u32 v14, s32, v13
    s_xor_b32 s29, s29, 4096
    s_add_u32 s32, s28, s29
    v_add_u32 v15, s32, v13
    s_lshl_b32 s28, s60, 16
    s_lshl_b32 s29, s26, 15
    s_add_u32 s28, s28, s29
    s_lshl_b32 s29, s61, 7
    s_add_u32 s28, s28, s29
    s_lshl_b32 s29, s27, 6
    s_add_u32 s28, s28, s29
    v_and_b32 v7, 31, v1
    v_lshlrev_b32 v7, 10, v7
    v_lshl_add_u32 v7, v12, 4, v7
    v_add_u32 v7, s28, v7
    v_sub_u32 v110, v14, v13
    v_and_b32 v109, 31, v1
    v_mul_u32_u24 v109, 80, v109
    v_lshl_add_u32 v109, v12, 3, v109
    v_add_u32 v109, v109, v110
    v_lshrrev_b32 v111, 2, v1
    v_and_b32 v9, 3, v1
    v_mul_u32_u24 v7, 80, v111
    v_lshl_add_u32 v7, v9, 4, v7
    v_add_u32 v110, v110, v7
    v_lshlrev_b32 v7, 10, v111
    v_lshl_add_u32 v7, v9, 4, v7
    v_add_u32 v7, s28, v7
    v_add_u32 v111, 0x4000, v7
    v_min_u32 v6, 27, v1
    s_lshl_b32 s28, s60, 8
    s_add_u32 s28, s28, 0x1150000
    v_lshl_add_u32 v6, v6, 3, s28
    s_cmp_lt_u32 s2, 32
    s_cbranch_scc1 K3_NOF
    v_mov_b32 v252, s6
    v_mov_b32 v253, s7
    s_waitcnt vmcnt(0)
    s_mov_b64 exec, s[62:63]
    global_store_dwordx2 v250, v[252:253], s[14:15] sc1
    s_mov_b64 exec, -1
K3_NOF:
    s_barrier
    s_barrier
    s_cmp_ge_u32 s2, 32
    s_cbranch_scc1 K3_WK_OK
    s_lshl_b32 s28, s2, 7
    s_add_u32 s28, s28, 0x1105000
    v_mov_b32 v5, s28
    global_load_dwordx2 v[2:3], v5, s[14:15] sc1
    s_waitcnt vmcnt(0)
K3_WK:
    v_lshl_add_u64 v[2:3], v[2:3], 0, s[58:59]
    v_cmp_ne_u32 vcc, 0, v3
    s_cbranch_vccz K3_WK_OK
    s_add_u32 s5, s5, 1
    s_cmp_gt_u32 s5, 0x200000
    s_cbranch_scc1 K3_WK_OK
    s_sleep 3
    global_load_dwordx2 v[2:3], v5, s[14:15] sc1
    s_waitcnt vmcnt(0)
    s_branch K3_WK
K3_WK_OK:
    global_load_dwordx2 v[2:3], v6, s[14:15] sc1
    ds_read_b64_tr_b16 v[112:113], v108 offset:0
    ds_read_b64_tr_b16 v[114:115], v108 offset:1024
    ds_read_b64_tr_b16 v[116:117], v108 offset:2048
    ds_read_b64_tr_b16 v[118:119], v108 offset:3072
    ds_read_b64_tr_b16 v[48:49], v96 offset:32768
    ds_read_b64_tr_b16 v[50:51], v96 offset:34816
    ds_read_b64_tr_b16 v[52:53], v97 offset:32768
    ds_read_b64_tr_b16 v[54:55], v97 offset:34816
    ds_read_b64_tr_b16 v[56:57], v96 offset:33792
    ds_read_b64_tr_b16 v[58:59], v96 offset:35840
    ds_read_b64_tr_b16 v[60:61], v97 offset:33792
    ds_read_b64_tr_b16 v[62:63], v97 offset:35840
    ds_read_b64_tr_b16 v[64:65], v98 offset:16384
    ds_read_b64_tr_b16 v[66:67], v98 offset:18432
    ds_read_b64_tr_b16 v[68:69], v99 offset:16384
    ds_read_b64_tr_b16 v[70:71], v99 offset:18432
    ds_read_b64_tr_b16 v[72:73], v98 offset:17408
    ds_read_b64_tr_b16 v[74:75], v98 offset:19456
    ds_read_b64_tr_b16 v[76:77], v99 offset:17408
    ds_read_b64_tr_b16 v[78:79], v99 offset:19456
    s_waitcnt lgkmcnt(15)
    v_lshlrev_b32 v120, 16, v112
    v_and_b32 v121, s37, v112
    v_lshlrev_b32 v122, 16, v113
    v_and_b32 v123, s37, v113
    v_lshlrev_b32 v124, 16, v114
    v_and_b32 v125, s37, v114
    v_lshlrev_b32 v126, 16, v115
    v_and_b32 v127, s37, v115
    v_lshlrev_b32 v128, 16, v116
    v_and_b32 v129, s37, v116
    v_lshlrev_b32 v130, 16, v117
    v_and_b32 v131, s37, v117
    v_lshlrev_b32 v132, 16, v118
    v_and_b32 v133, s37, v118
    v_lshlrev_b32 v134, 16, v119
    v_and_b32 v135, s37, v119
    s_waitcnt vmcnt(0)
K3_PC:
    v_lshl_add_u64 v[2:3], v[2:3], 0, s[58:59]
    v_cmp_ne_u32 vcc, 0, v3
    s_cbranch_vccz K3_PC_OK
    s_add_u32 s5, s5, 1
    s_cmp_gt_u32 s5, 0x200000
    s_cbranch_scc1 K3_PC_OK
    s_sleep 4
    global_load_dwordx2 v[2:3], v6, s[14:15] sc1
    s_waitcnt vmcnt(0)
    s_branch K3_PC
K3_PC_OK:
    s_mov_b32 s36, 0
    buffer_load_dwordx4 v[136:139], v4, s[40:43], s36 offen offset:0 sc1
    buffer_load_dwordx4 v[140:143], v4, s[40:43], s36 offen offset:512 sc1
    buffer_load_dwordx4 v[144:147], v4, s[40:43], s36 offen offset:2048 sc1
    buffer_load_dwordx4 v[148:151], v4, s[40:43], s36 offen offset:2560 sc1
    s_mov_b32 s36, 4096
    buffer_load_dwordx4 v[152:155], v4, s[40:43], s36 offen offset:0 sc1
    buffer_load_dwordx4 v[156:159], v4, s[40:43], s36 offen offset:512 sc1
    buffer_load_dwordx4 v[160:163], v4, s[40:43], s36 offen offset:2048 sc1
    buffer_load_dwordx4 v[164:167], v4, s[40:43], s36 offen offset:2560 sc1
    s_mov_b32 s36, 8192
    buffer_load_dwordx4 v[168:171], v4, s[40:43], s36 offen offset:0 sc1
    buffer_load_dwordx4 v[172:175], v4, s[40:43], s36 offen offset:512 sc1
    buffer_load_dwordx4 v[176:179], v4, s[40:43], s36 offen offset:2048 sc1
    buffer_load_dwordx4 v[180:183], v4, s[40:43], s36 offen offset:2560 sc1
    s_mov_b32 s36, 12288
    buffer_load_dwordx4 v[184:187], v4, s[40:43], s36 offen offset:0 sc1
    buffer_load_dwordx4 v[188:191], v4, s[40:43], s36 offen offset:512 sc1
    s_waitcnt vmcnt(12)
    s_waitcnt lgkmcnt(8)
    v_mfma_f32_32x32x16_bf16 v[32:47], v[52:55], v[136:139], 0
    buffer_load_dwordx4 v[192:195], v4, s[40:43], s36 offen offset:2048 sc1
    ds_read_b64_tr_b16 v[80:81], v100 offset:0
    ds_read_b64_tr_b16 v[82:83], v100 offset:2048
    v_mfma_f32_32x32x16_bf16 v[16:31], v[48:51], v[136:139], 0
    buffer_load_dwordx4 v[196:199], v4, s[40:43], s36 offen offset:2560 sc1
    ds_read_b64_tr_b16 v[84:85], v101 offset:0
    ds_read_b64_tr_b16 v[86:87], v101 offset:2048
    v_mfma_f32_32x32x16_bf16 v[32:47], v[60:63], v[140:143], v[32:47]
    ds_read_b64_tr_b16 v[88:89], v100 offset:1024
    ds_read_b64_tr_b16 v[90:91], v100 offset:3072
    v_mfma_f32_32x32x16_bf16 v[16:31], v[56:59], v[140:143], v[16:31]
    ds_read_b64_tr_b16 v[92:93], v101 offset:1024
    ds_read_b64_tr_b16 v[94:95], v101 offset:3072
    s_waitcnt vmcnt(12)
    s_waitcnt lgkmcnt(8)
    v_mfma_f32_32x32x16_bf16 v[32:47], v[68:71], v[144:147], v[32:47]
    s_mov_b32 s36, 16384
    buffer_load_dwordx4 v[200:203], v4, s[40:43], s36 offen offset:0 sc1
    ds_read_b64_tr_b16 v[48:49], v96 offset:40960
    ds_read_b64_tr_b16 v[50:51], v96 offset:43008
    v_mfma_f32_32x32x16_bf16 v[16:31], v[64:67], v[144:147], v[16:31]
    buffer_load_dwordx4 v[204:207], v4, s[40:43], s36 offen offset:512 sc1
    ds_read_b64_tr_b16 v[52:53], v97 offset:40960
    ds_read_b64_tr_b16 v[54:55], v97 offset:43008
    v_mfma_f32_32x32x16_bf16 v[32:47], v[76:79], v[148:151], v[32:47]
    ds_read_b64_tr_b16 v[56:57], v96 offset:41984
    ds_read_b64_tr_b16 v[58:59], v96 offset:44032
    v_mfma_f32_32x32x16_bf16 v[16:31], v[72:75], v[148:151], v[16:31]
    ds_read_b64_tr_b16 v[60:61], v97 offset:41984
    ds_read_b64_tr_b16 v[62:63], v97 offset:44032
    s_waitcnt vmcnt(12)
    s_waitcnt lgkmcnt(8)
    v_mfma_f32_32x32x16_bf16 v[32:47], v[84:87], v[152:155], v[32:47]
    buffer_load_dwordx4 v[136:139], v4, s[40:43], s36 offen offset:2048 sc1
    ds_read_b64_tr_b16 v[64:65], v98 offset:24576
    ds_read_b64_tr_b16 v[66:67], v98 offset:26624
    v_mfma_f32_32x32x16_bf16 v[16:31], v[80:83], v[152:155], v[16:31]
    buffer_load_dwordx4 v[140:143], v4, s[40:43], s36 offen offset:2560 sc1
    ds_read_b64_tr_b16 v[68:69], v99 offset:24576
    ds_read_b64_tr_b16 v[70:71], v99 offset:26624
    v_mfma_f32_32x32x16_bf16 v[32:47], v[92:95], v[156:159], v[32:47]
    ds_read_b64_tr_b16 v[72:73], v98 offset:25600
    ds_read_b64_tr_b16 v[74:75], v98 offset:27648
    v_mfma_f32_32x32x16_bf16 v[16:31], v[88:91], v[156:159], v[16:31]
    ds_read_b64_tr_b16 v[76:77], v99 offset:25600
    ds_read_b64_tr_b16 v[78:79], v99 offset:27648
    s_waitcnt vmcnt(12)
    s_waitcnt lgkmcnt(8)
    v_mfma_f32_32x32x16_bf16 v[32:47], v[52:55], v[160:163], v[32:47]
    s_mov_b32 s36, 20480
    buffer_load_dwordx4 v[144:147], v4, s[40:43], s36 offen offset:0 sc1
    ds_read_b64_tr_b16 v[80:81], v100 offset:8192
    ds_read_b64_tr_b16 v[82:83], v100 offset:10240
    v_mfma_f32_32x32x16_bf16 v[16:31], v[48:51], v[160:163], v[16:31]
    buffer_load_dwordx4 v[148:151], v4, s[40:43], s36 offen offset:512 sc1
    ds_read_b64_tr_b16 v[84:85], v101 offset:8192
    ds_read_b64_tr_b16 v[86:87], v101 offset:10240
    v_mfma_f32_32x32x16_bf16 v[32:47], v[60:63], v[164:167], v[32:47]
    ds_read_b64_tr_b16 v[88:89], v100 offset:9216
    ds_read_b64_tr_b16 v[90:91], v100 offset:11264
    v_mfma_f32_32x32x16_bf16 v[16:31], v[56:59], v[164:167], v[16:31]
    ds_read_b64_tr_b16 v[92:93], v101 offset:9216
    ds_read_b64_tr_b16 v[94:95], v101 offset:11264
    s_waitcnt vmcnt(12)
    s_waitcnt lgkmcnt(8)
    v_mfma_f32_32x32x16_bf16 v[32:47], v[68:71], v[168:171], v[32:47]
    buffer_load_dwordx4 v[152:155], v4, s[40:43], s36 offen offset:2048 sc1
    ds_read_b64_tr_b16 v[48:49], v96 offset:0
    ds_read_b64_tr_b16 v[50:51], v96 offset:2048
    v_mfma_f32_32x32x16_bf16 v[16:31], v[64:67], v[168:171], v[16:31]
    buffer_load_dwordx4 v[156:159], v4, s[40:43], s36 offen offset:2560 sc1
    ds_read_b64_tr_b16 v[52:53], v97 offset:0
    ds_read_b64_tr_b16 v[54:55], v97 offset:2048
    v_mfma_f32_32x32x16_bf16 v[32:47], v[76:79], v[172:175], v[32:47]
    ds_read_b64_tr_b16 v[56:57], v96 offset:1024
    ds_read_b64_tr_b16 v[58:59], v96 offset:3072
    v_mfma_f32_32x32x16_bf16 v[16:31], v[72:75], v[172:175], v[16:31]
    ds_read_b64_tr_b16 v[60:61], v97 offset:1024
    ds_read_b64_tr_b16 v[62:63], v97 offset:3072
    s_waitcnt vmcnt(12)
    s_waitcnt lgkmcnt(8)
    s_barrier
    v_mfma_f32_32x32x16_bf16 v[32:47], v[84:87], v[176:179], v[32:47]
    s_mov_b32 s36, 24576
    buffer_load_dwordx4 v[160:163], v4, s[40:43], s36 offen offset:0 sc1
    ds_read_b64_tr_b16 v[64:65], v96 offset:49152
    ds_read_b64_tr_b16 v[66:67], v96 offset:51200
    v_mfma_f32_32x32x16_bf16 v[16:31], v[80:83], v[176:179], v[16:31]
    buffer_load_dwordx4 v[164:167], v4, s[40:43], s36 offen offset:512 sc1
    ds_read_b64_tr_b16 v[68:69], v97 offset:49152
    ds_read_b64_tr_b16 v[70:71], v97 offset:51200
    v_mfma_f32_32x32x16_bf16 v[32:47], v[92:95], v[180:183], v[32:47]
    ds_read_b64_tr_b16 v[72:73], v96 offset:50176
    ds_read_b64_tr_b16 v[74:75], v96 offset:52224
    v_mfma_f32_32x32x16_bf16 v[16:31], v[88:91], v[180:183], v[16:31]
    ds_read_b64_tr_b16 v[76:77], v97 offset:50176
    ds_read_b64_tr_b16 v[78:79], v97 offset:52224
    s_waitcnt vmcnt(12)
    s_waitcnt lgkmcnt(8)
    v_mfma_f32_32x32x16_bf16 v[32:47], v[52:55], v[184:187], v[32:47]
    buffer_load_dwordx4 v[168:171], v4, s[40:43], s36 offen offset:2048 sc1
    ds_read_b64_tr_b16 v[80:81], v98 offset:32768
    ds_read_b64_tr_b16 v[82:83], v98 offset:34816
    v_mfma_f32_32x32x16_bf16 v[16:31], v[48:51], v[184:187], v[16:31]
    buffer_load_dwordx4 v[172:175], v4, s[40:43], s36 offen offset:2560 sc1
    ds_read_b64_tr_b16 v[84:85], v99 offset:32768
    ds_read_b64_tr_b16 v[86:87], v99 offset:34816
    v_mfma_f32_32x32x16_bf16 v[32:47], v[60:63], v[188:191], v[32:47]
    ds_read_b64_tr_b16 v[88:89], v98 offset:33792
    ds_read_b64_tr_b16 v[90:91], v98 offset:35840
    v_mfma_f32_32x32x16_bf16 v[16:31], v[56:59], v[188:191], v[16:31]
    ds_read_b64_tr_b16 v[92:93], v99 offset:33792
    ds_read_b64_tr_b16 v[94:95], v99 offset:35840
    s_waitcnt vmcnt(12)
    s_waitcnt lgkmcnt(8)
    v_mfma_f32_32x32x16_bf16 v[32:47], v[68:71], v[192:195], v[32:47]
    s_mov_b32 s36, 28672
    buffer_load_dwordx4 v[176:179], v4, s[40:43], s36 offen offset:0 sc1
    ds_read_b64_tr_b16 v[48:49], v96 offset:8192
    ds_read_b64_tr_b16 v[50:51], v96 offset:10240
    v_mfma_f32_32x32x16_bf16 v[16:31], v[64:67], v[192:195], v[16:31]
    buffer_load_dwordx4 v[180:183], v4, s[40:43], s36 offen offset:512 sc1
    ds_read_b64_tr_b16 v[52:53], v97 offset:8192
    ds_read_b64_tr_b16 v[54:55], v97 offset:10240
    v_mfma_f32_32x32x16_bf16 v[32:47], v[76:79], v[196:199], v[32:47]
    ds_read_b64_tr_b16 v[56:57], v96 offset:9216
    ds_read_b64_tr_b16 v[58:59], v96 offset:11264
    v_mfma_f32_32x32x16_bf16 v[16:31], v[72:75], v[196:199], v[16:31]
    ds_read_b64_tr_b16 v[60:61], v97 offset:9216
    ds_read_b64_tr_b16 v[62:63], v97 offset:11264
    s_waitcnt vmcnt(12)
    s_waitcnt lgkmcnt(8)
    v_mfma_f32_32x32x16_bf16 v[32:47], v[84:87], v[200:203], v[32:47]
    buffer_load_dwordx4 v[184:187], v4, s[40:43], s36 offen offset:2048 sc1
    ds_read_b64_tr_b16 v[64:65], v96 offset:57344
    ds_read_b64_tr_b16 v[66:67], v96 offset:59392
    v_mfma_f32_32x32x16_bf16 v[16:31], v[80:83], v[200:203], v[16:31]
    buffer_load_dwordx4 v[188:191], v4, s[40:43], s36 offen offset:2560 sc1
    ds_read_b64_tr_b16 v[68:69], v97 offset:57344
    ds_read_b64_tr_b16 v[70:71], v97 offset:59392
    v_mfma_f32_32x32x16_bf16 v[32:47], v[92:95], v[204:207], v[32:47]
    ds_read_b64_tr_b16 v[72:73], v96 offset:58368
    ds_read_b64_tr_b16 v[74:75], v96 offset:60416
    v_mfma_f32_32x32x16_bf16 v[16:31], v[88:91], v[204:207], v[16:31]
    ds_read_b64_tr_b16 v[76:77], v97 offset:58368
    ds_read_b64_tr_b16 v[78:79], v97 offset:60416
    s_waitcnt vmcnt(12)
    s_waitcnt lgkmcnt(8)
    v_mfma_f32_32x32x16_bf16 v[32:47], v[52:55], v[136:139], v[32:47]
    s_mov_b32 s36, 32768
    buffer_load_dwordx4 v[192:195], v4, s[40:43], s36 offen offset:0 sc1
    ds_read_b64_tr_b16 v[80:81], v98 offset:40960
    ds_read_b64_tr_b16 v[82:83], v98 offset:43008
    v_mfma_f32_32x32x16_bf16 v[16:31], v[48:51], v[136:139], v[16:31]
    buffer_load_dwordx4 v[196:199], v4, s[40:43], s36 offen offset:512 sc1
    ds_read_b64_tr_b16 v[84:85], v99 offset:40960
    ds_read_b64_tr_b16 v[86:87], v99 offset:43008
    v_mfma_f32_32x32x16_bf16 v[32:47], v[60:63], v[140:143], v[32:47]
    ds_read_b64_tr_b16 v[88:89], v98 offset:41984
    ds_read_b64_tr_b16 v[90:91], v98 offset:44032
    v_mfma_f32_32x32x16_bf16 v[16:31], v[56:59], v[140:143], v[16:31]
    ds_read_b64_tr_b16 v[92:93], v99 offset:41984
    ds_read_b64_tr_b16 v[94:95], v99 offset:44032
    s_waitcnt vmcnt(12)
    s_waitcnt lgkmcnt(8)
    v_mfma_f32_32x32x16_bf16 v[32:47], v[68:71], v[144:147], v[32:47]
    buffer_load_dwordx4 v[200:203], v4, s[40:43], s36 offen offset:2048 sc1
    ds_read_b64_tr_b16 v[48:49], v96 offset:16384
    ds_read_b64_tr_b16 v[50:51], v96 offset:18432
    v_mfma_f32_32x32x16_bf16 v[16:31], v[64:67], v[144:147], v[16:31]
    buffer_load_dwordx4 v[204:207], v4, s[40:43], s36 offen offset:2560 sc1
    ds_read_b64_tr_b16 v[52:53], v97 offset:16384
    ds_read_b64_tr_b16 v[54:55], v97 offset:18432
    v_mfma_f32_32x32x16_bf16 v[32:47], v[76:79], v[148:151], v[32:47]
    ds_read_b64_tr_b16 v[56:57], v96 offset:17408
    ds_read_b64_tr_b16 v[58:59], v96 offset:19456
    v_mfma_f32_32x32x16_bf16 v[16:31], v[72:75], v[148:151], v[16:31]
    ds_read_b64_tr_b16 v[60:61], v97 offset:17408
    ds_read_b64_tr_b16 v[62:63], v97 offset:19456
    s_waitcnt vmcnt(12)
    s_waitcnt lgkmcnt(8)
    s_barrier
    v_mfma_f32_32x32x16_bf16 v[32:47], v[84:87], v[152:155], v[32:47]
    s_mov_b32 s36, 36864
    buffer_load_dwordx4 v[136:139], v4, s[40:43], s36 offen offset:0 sc1
    ds_read_b64_tr_b16 v[64:65], v98 offset:0
    ds_read_b64_tr_b16 v[66:67], v98 offset:2048
    v_mfma_f32_32x32x16_bf16 v[16:31], v[80:83], v[152:155], v[16:31]
    buffer_load_dwordx4 v[140:143], v4, s[40:43], s36 offen offset:512 sc1
    ds_read_b64_tr_b16 v[68:69], v99 offset:0
    ds_read_b64_tr_b16 v[70:71], v99 offset:2048
    v_mfma_f32_32x32x16_bf16 v[32:47], v[92:95], v[156:159], v[32:47]
    ds_read_b64_tr_b16 v[72:73], v98 offset:1024
    ds_read_b64_tr_b16 v[74:75], v98 offset:3072
    v_mfma_f32_32x32x16_bf16 v[16:31], v[88:91], v[156:159], v[16:31]
    ds_read_b64_tr_b16 v[76:77], v99 offset:1024
    ds_read_b64_tr_b16 v[78:79], v99 offset:3072
    s_waitcnt vmcnt(12)
    s_waitcnt lgkmcnt(8)
    v_mfma_f32_32x32x16_bf16 v[32:47], v[52:55], v[160:163], v[32:47]
    buffer_load_dwordx4 v[144:147], v4, s[40:43], s36 offen offset:2048 sc1
    ds_read_b64_tr_b16 v[80:81], v98 offset:49152
    ds_read_b64_tr_b16 v[82:83], v98 offset:51200
    v_mfma_f32_32x32x16_bf16 v[16:31], v[48:51], v[160:163], v[16:31]
    buffer_load_dwordx4 v[148:151], v4, s[40:43], s36 offen offset:2560 sc1
    ds_read_b64_tr_b16 v[84:85], v99 offset:49152
    ds_read_b64_tr_b16 v[86:87], v99 offset:51200
    v_mfma_f32_32x32x16_bf16 v[32:47], v[60:63], v[164:167], v[32:47]
    ds_read_b64_tr_b16 v[88:89], v98 offset:50176
    ds_read_b64_tr_b16 v[90:91], v98 offset:52224
    v_mfma_f32_32x32x16_bf16 v[16:31], v[56:59], v[164:167], v[16:31]
    ds_read_b64_tr_b16 v[92:93], v99 offset:50176
    ds_read_b64_tr_b16 v[94:95], v99 offset:52224
    s_waitcnt vmcnt(12)
    s_waitcnt lgkmcnt(8)
    v_mfma_f32_32x32x16_bf16 v[32:47], v[68:71], v[168:171], v[32:47]
    s_mov_b32 s36, 40960
    buffer_load_dwordx4 v[152:155], v4, s[40:43], s36 offen offset:0 sc1
    ds_read_b64_tr_b16 v[48:49], v96 offset:24576
    ds_read_b64_tr_b16 v[50:51], v96 offset:26624
    v_mfma_f32_32x32x16_bf16 v[16:31], v[64:67], v[168:171], v[16:31]
    buffer_load_dwordx4 v[156:159], v4, s[40:43], s36 offen offset:512 sc1
    ds_read_b64_tr_b16 v[52:53], v97 offset:24576
    ds_read_b64_tr_b16 v[54:55], v97 offset:26624
    v_mfma_f32_32x32x16_bf16 v[32:47], v[76:79], v[172:175], v[32:47]
    ds_read_b64_tr_b16 v[56:57], v96 offset:25600
    ds_read_b64_tr_b16 v[58:59], v96 offset:27648
    v_mfma_f32_32x32x16_bf16 v[16:31], v[72:75], v[172:175], v[16:31]
    ds_read_b64_tr_b16 v[60:61], v97 offset:25600
    ds_read_b64_tr_b16 v[62:63], v97 offset:27648
    s_waitcnt vmcnt(12)
    s_waitcnt lgkmcnt(8)
    v_mfma_f32_32x32x16_bf16 v[32:47], v[84:87], v[176:179], v[32:47]
    buffer_load_dwordx4 v[160:163], v4, s[40:43], s36 offen offset:2048 sc1
    ds_read_b64_tr_b16 v[64:65], v98 offset:8192
    ds_read_b64_tr_b16 v[66:67], v98 offset:10240
    v_mfma_f32_32x32x16_bf16 v[16:31], v[80:83], v[176:179], v[16:31]
    buffer_load_dwordx4 v[164:167], v4, s[40:43], s36 offen offset:2560 sc1
    ds_read_b64_tr_b16 v[68:69], v99 offset:8192
    ds_read_b64_tr_b16 v[70:71], v99 offset:10240
    v_mfma_f32_32x32x16_bf16 v[32:47], v[92:95], v[180:183], v[32:47]
    ds_read_b64_tr_b16 v[72:73], v98 offset:9216
    ds_read_b64_tr_b16 v[74:75], v98 offset:11264
    v_mfma_f32_32x32x16_bf16 v[16:31], v[88:91], v[180:183], v[16:31]
    ds_read_b64_tr_b16 v[76:77], v99 offset:9216
    ds_read_b64_tr_b16 v[78:79], v99 offset:11264
    s_waitcnt vmcnt(12)
    s_waitcnt lgkmcnt(8)
    v_mfma_f32_32x32x16_bf16 v[32:47], v[52:55], v[184:187], v[32:47]
    s_mov_b32 s36, 45056
    buffer_load_dwordx4 v[168:171], v4, s[40:43], s36 offen offset:0 sc1
    ds_read_b64_tr_b16 v[80:81], v98 offset:57344
    ds_read_b64_tr_b16 v[82:83], v98 offset:59392
    v_mfma_f32_32x32x16_bf16 v[16:31], v[48:51], v[184:187], v[16:31]
    buffer_load_dwordx4 v[172:175], v4, s[40:43], s36 offen offset:512 sc1
    ds_read_b64_tr_b16 v[84:85], v99 offset:57344
    ds_read_b64_tr_b16 v[86:87], v99 offset:59392
    v_mfma_f32_32x32x16_bf16 v[32:47], v[60:63], v[188:191], v[32:47]
    ds_read_b64_tr_b16 v[88:89], v98 offset:58368
    ds_read_b64_tr_b16 v[90:91], v98 offset:60416
    v_mfma_f32_32x32x16_bf16 v[16:31], v[56:59], v[188:191], v[16:31]
    ds_read_b64_tr_b16 v[92:93], v99 offset:58368
    ds_read_b64_tr_b16 v[94:95], v99 offset:60416
    s_waitcnt vmcnt(12)
    s_waitcnt lgkmcnt(8)
    s_barrier
    v_mfma_f32_32x32x16_bf16 v[32:47], v[68:71], v[192:195], v[32:47]
    buffer_load_dwordx4 v[176:179], v4, s[40:43], s36 offen offset:2048 sc1
    ds_read_b64_tr_b16 v[48:49], v96 offset:32768
    ds_read_b64_tr_b16 v[50:51], v96 offset:34816
    v_mfma_f32_32x32x16_bf16 v[16:31], v[64:67], v[192:195], v[16:31]
    buffer_load_dwordx4 v[180:183], v4, s[40:43], s36 offen offset:2560 sc1
    ds_read_b64_tr_b16 v[52:53], v97 offset:32768
    ds_read_b64_tr_b16 v[54:55], v97 offset:34816
    v_mfma_f32_32x32x16_bf16 v[32:47], v[76:79], v[196:199], v[32:47]
    ds_read_b64_tr_b16 v[56:57], v96 offset:33792
    ds_read_b64_tr_b16 v[58:59], v96 offset:35840
    v_mfma_f32_32x32x16_bf16 v[16:31], v[72:75], v[196:199], v[16:31]
    ds_read_b64_tr_b16 v[60:61], v97 offset:33792
    ds_read_b64_tr_b16 v[62:63], v97 offset:35840
    s_waitcnt vmcnt(12)
    s_waitcnt lgkmcnt(8)
    v_mfma_f32_32x32x16_bf16 v[32:47], v[84:87], v[200:203], v[32:47]
    s_mov_b32 s36, 49152
    buffer_load_dwordx4 v[184:187], v4, s[40:43], s36 offen offset:0 sc1
    ds_read_b64_tr_b16 v[64:65], v98 offset:16384
    ds_read_b64_tr_b16 v[66:67], v98 offset:18432
    v_mfma_f32_32x32x16_bf16 v[16:31], v[80:83], v[200:203], v[16:31]
    buffer_load_dwordx4 v[188:191], v4, s[40:43], s36 offen offset:512 sc1
    ds_read_b64_tr_b16 v[68:69], v99 offset:16384
    ds_read_b64_tr_b16 v[70:71], v99 offset:18432
    v_mfma_f32_32x32x16_bf16 v[32:47], v[92:95], v[204:207], v[32:47]
    ds_read_b64_tr_b16 v[72:73], v98 offset:17408
    ds_read_b64_tr_b16 v[74:75], v98 offset:19456
    v_mfma_f32_32x32x16_bf16 v[16:31], v[88:91], v[204:207], v[16:31]
    ds_read_b64_tr_b16 v[76:77], v99 offset:17408
    ds_read_b64_tr_b16 v[78:79], v99 offset:19456
    s_waitcnt vmcnt(12)
    s_waitcnt lgkmcnt(8)
    v_mfma_f32_32x32x16_bf16 v[32:47], v[52:55], v[136:139], v[32:47]
    buffer_load_dwordx4 v[192:195], v4, s[40:43], s36 offen offset:2048 sc1
    ds_read_b64_tr_b16 v[80:81], v100 offset:0
    ds_read_b64_tr_b16 v[82:83], v100 offset:2048
    v_mfma_f32_32x32x16_bf16 v[16:31], v[48:51], v[136:139], v[16:31]
    buffer_load_dwordx4 v[196:199], v4, s[40:43], s36 offen offset:2560 sc1
    ds_read_b64_tr_b16 v[84:85], v101 offset:0
    ds_read_b64_tr_b16 v[86:87], v101 offset:2048
    v_mfma_f32_32x32x16_bf16 v[32:47], v[60:63], v[140:143], v[32:47]
    ds_read_b64_tr_b16 v[88:89], v100 offset:1024
    ds_read_b64_tr_b16 v[90:91], v100 offset:3072
    v_mfma_f32_32x32x16_bf16 v[16:31], v[56:59], v[140:143], v[16:31]
    ds_read_b64_tr_b16 v[92:93], v101 offset:1024
    ds_read_b64_tr_b16 v[94:95], v101 offset:3072
    s_waitcnt vmcnt(12)
    s_waitcnt lgkmcnt(8)
    v_mfma_f32_32x32x16_bf16 v[32:47], v[68:71], v[144:147], v[32:47]
    s_mov_b32 s36, 53248
    buffer_load_dwordx4 v[200:203], v4, s[40:43], s36 offen offset:0 sc1
    ds_read_b64_tr_b16 v[48:49], v96 offset:40960
    ds_read_b64_tr_b16 v[50:51], v96 offset:43008
    v_mfma_f32_32x32x16_bf16 v[16:31], v[64:67], v[144:147], v[16:31]
    buffer_load_dwordx4 v[204:207], v4, s[40:43], s36 offen offset:512 sc1
    ds_read_b64_tr_b16 v[52:53], v97 offset:40960
    ds_read_b64_tr_b16 v[54:55], v97 offset:43008
    v_mfma_f32_32x32x16_bf16 v[32:47], v[76:79], v[148:151], v[32:47]
    ds_read_b64_tr_b16 v[56:57], v96 offset:41984
    ds_read_b64_tr_b16 v[58:59], v96 offset:44032
    v_mfma_f32_32x32x16_bf16 v[16:31], v[72:75], v[148:151], v[16:31]
    ds_read_b64_tr_b16 v[60:61], v97 offset:41984
    ds_read_b64_tr_b16 v[62:63], v97 offset:44032
    s_waitcnt vmcnt(12)
    s_waitcnt lgkmcnt(8)
    v_mfma_f32_32x32x16_bf16 v[32:47], v[84:87], v[152:155], v[32:47]
    buffer_load_dwordx4 v[136:139], v4, s[40:43], s36 offen offset:2048 sc1
    ds_read_b64_tr_b16 v[64:65], v98 offset:24576
    ds_read_b64_tr_b16 v[66:67], v98 offset:26624
    v_mfma_f32_32x32x16_bf16 v[16:31], v[80:83], v[152:155], v[16:31]
    buffer_load_dwordx4 v[140:143], v4, s[40:43], s36 offen offset:2560 sc1
    ds_read_b64_tr_b16 v[68:69], v99 offset:24576
    ds_read_b64_tr_b16 v[70:71], v99 offset:26624
    v_mfma_f32_32x32x16_bf16 v[32:47], v[92:95], v[156:159], v[32:47]
    ds_read_b64_tr_b16 v[72:73], v98 offset:25600
    ds_read_b64_tr_b16 v[74:75], v98 offset:27648
    v_mfma_f32_32x32x16_bf16 v[16:31], v[88:91], v[156:159], v[16:31]
    ds_read_b64_tr_b16 v[76:77], v99 offset:25600
    ds_read_b64_tr_b16 v[78:79], v99 offset:27648
    s_waitcnt vmcnt(12)
    s_waitcnt lgkmcnt(8)
    v_mfma_f32_32x32x16_bf16 v[32:47], v[52:55], v[160:163], v[32:47]
    ds_read_b64_tr_b16 v[80:81], v100 offset:8192
    ds_read_b64_tr_b16 v[82:83], v100 offset:10240
    v_mfma_f32_32x32x16_bf16 v[16:31], v[48:51], v[160:163], v[16:31]
    ds_read_b64_tr_b16 v[84:85], v101 offset:8192
    ds_read_b64_tr_b16 v[86:87], v101 offset:10240
    v_mfma_f32_32x32x16_bf16 v[32:47], v[60:63], v[164:167], v[32:47]
    ds_read_b64_tr_b16 v[88:89], v100 offset:9216
    ds_read_b64_tr_b16 v[90:91], v100 offset:11264
    v_mfma_f32_32x32x16_bf16 v[16:31], v[56:59], v[164:167], v[16:31]
    ds_read_b64_tr_b16 v[92:93], v101 offset:9216
    ds_read_b64_tr_b16 v[94:95], v101 offset:11264
    s_waitcnt vmcnt(10)
    s_waitcnt lgkmcnt(8)
    v_mfma_f32_32x32x16_bf16 v[32:47], v[68:71], v[168:171], v[32:47]
    ds_read_b64_tr_b16 v[48:49], v96 offset:0
    ds_read_b64_tr_b16 v[50:51], v96 offset:2048
    v_mfma_f32_32x32x16_bf16 v[16:31], v[64:67], v[168:171], v[16:31]
    ds_read_b64_tr_b16 v[52:53], v97 offset:0
    ds_read_b64_tr_b16 v[54:55], v97 offset:2048
    v_mfma_f32_32x32x16_bf16 v[32:47], v[76:79], v[172:175], v[32:47]
    ds_read_b64_tr_b16 v[56:57], v96 offset:1024
    ds_read_b64_tr_b16 v[58:59], v96 offset:3072
    v_mfma_f32_32x32x16_bf16 v[16:31], v[72:75], v[172:175], v[16:31]
    ds_read_b64_tr_b16 v[60:61], v97 offset:1024
    ds_read_b64_tr_b16 v[62:63], v97 offset:3072
    s_waitcnt vmcnt(8)
    s_waitcnt lgkmcnt(8)
    v_mfma_f32_32x32x16_bf16 v[32:47], v[84:87], v[176:179], v[32:47]
    ds_read_b64_tr_b16 v[64:65], v96 offset:49152
    ds_read_b64_tr_b16 v[66:67], v96 offset:51200
    v_mfma_f32_32x32x16_bf16 v[16:31], v[80:83], v[176:179], v[16:31]
    ds_read_b64_tr_b16 v[68:69], v97 offset:49152
    ds_read_b64_tr_b16 v[70:71], v97 offset:51200
    v_mfma_f32_32x32x16_bf16 v[32:47], v[92:95], v[180:183], v[32:47]
    ds_read_b64_tr_b16 v[72:73], v96 offset:50176
    ds_read_b64_tr_b16 v[74:75], v96 offset:52224
    v_mfma_f32_32x32x16_bf16 v[16:31], v[88:91], v[180:183], v[16:31]
    ds_read_b64_tr_b16 v[76:77], v97 offset:50176
    ds_read_b64_tr_b16 v[78:79], v97 offset:52224
    s_waitcnt vmcnt(6)
    s_waitcnt lgkmcnt(8)
    v_mfma_f32_32x32x16_bf16 v[32:47], v[52:55], v[184:187], v[32:47]
    ds_read_b64_tr_b16 v[80:81], v98 offset:32768
    ds_read_b64_tr_b16 v[82:83], v98 offset:34816
    v_mfma_f32_32x32x16_bf16 v[16:31], v[48:51], v[184:187], v[16:31]
    ds_read_b64_tr_b16 v[84:85], v99 offset:32768
    ds_read_b64_tr_b16 v[86:87], v99 offset:34816
    v_mfma_f32_32x32x16_bf16 v[32:47], v[60:63], v[188:191], v[32:47]
    ds_read_b64_tr_b16 v[88:89], v98 offset:33792
    ds_read_b64_tr_b16 v[90:91], v98 offset:35840
    v_mfma_f32_32x32x16_bf16 v[16:31], v[56:59], v[188:191], v[16:31]
    ds_read_b64_tr_b16 v[92:93], v99 offset:33792
    ds_read_b64_tr_b16 v[94:95], v99 offset:35840
    s_waitcnt vmcnt(4)
    s_waitcnt lgkmcnt(8)
    v_mfma_f32_32x32x16_bf16 v[32:47], v[68:71], v[192:195], v[32:47]
    ds_read_b64_tr_b16 v[48:49], v96 offset:8192
    ds_read_b64_tr_b16 v[50:51], v96 offset:10240
    v_mfma_f32_32x32x16_bf16 v[16:31], v[64:67], v[192:195], v[16:31]
    ds_read_b64_tr_b16 v[52:53], v97 offset:8192
    ds_read_b64_tr_b16 v[54:55], v97 offset:10240
    v_mfma_f32_32x32x16_bf16 v[32:47], v[76:79], v[196:199], v[32:47]
    ds_read_b64_tr_b16 v[56:57], v96 offset:9216
    ds_read_b64_tr_b16 v[58:59], v96 offset:11264
    v_mfma_f32_32x32x16_bf16 v[16:31], v[72:75], v[196:199], v[16:31]
    ds_read_b64_tr_b16 v[60:61], v97 offset:9216
    ds_read_b64_tr_b16 v[62:63], v97 offset:11264
    s_waitcnt vmcnt(2)
    s_waitcnt lgkmcnt(8)
    v_mfma_f32_32x32x16_bf16 v[32:47], v[84:87], v[200:203], v[32:47]
    v_mfma_f32_32x32x16_bf16 v[16:31], v[80:83], v[200:203], v[16:31]
    v_mfma_f32_32x32x16_bf16 v[32:47], v[92:95], v[204:207], v[32:47]
    v_mfma_f32_32x32x16_bf16 v[16:31], v[88:91], v[204:207], v[16:31]
    s_waitcnt vmcnt(0)
    s_waitcnt lgkmcnt(0)
    v_mfma_f32_32x32x16_bf16 v[32:47], v[52:55], v[136:139], v[32:47]
    v_mfma_f32_32x32x16_bf16 v[16:31], v[48:51], v[136:139], v[16:31]
    v_mfma_f32_32x32x16_bf16 v[32:47], v[60:63], v[140:143], v[32:47]
    v_mfma_f32_32x32x16_bf16 v[16:31], v[56:59], v[140:143], v[16:31]
    s_nop 10
    ds_write_b128 v15, v[32:35] offset:0
    ds_write_b128 v15, v[36:39] offset:1024
    ds_write_b128 v15, v[40:43] offset:2048
    ds_write_b128 v15, v[44:47] offset:3072
    s_waitcnt lgkmcnt(0)
    s_barrier
    ds_read_b128 v[64:67], v14 offset:0
    ds_read_b128 v[68:71], v14 offset:1024
    ds_read_b128 v[72:75], v14 offset:2048
    ds_read_b128 v[76:79], v14 offset:3072
    s_waitcnt lgkmcnt(3)
    v_pk_add_f32 v[16:17], v[16:17], v[64:65]
    v_pk_add_f32 v[18:19], v[18:19], v[66:67]
    s_waitcnt lgkmcnt(2)
    v_pk_add_f32 v[20:21], v[20:21], v[68:69]
    v_pk_add_f32 v[22:23], v[22:23], v[70:71]
    s_waitcnt lgkmcnt(1)
    v_pk_add_f32 v[24:25], v[24:25], v[72:73]
    v_pk_add_f32 v[26:27], v[26:27], v[74:75]
    s_waitcnt lgkmcnt(0)
    v_pk_add_f32 v[28:29], v[28:29], v[76:77]
    v_pk_add_f32 v[30:31], v[30:31], v[78:79]
    v_cvt_pk_bf16_f32 v48, v16, v17
    v_cvt_pk_bf16_f32 v49, v18, v19
    v_cvt_pk_bf16_f32 v50, v20, v21
    v_cvt_pk_bf16_f32 v51, v22, v23
    v_cvt_pk_bf16_f32 v52, v24, v25
    v_cvt_pk_bf16_f32 v53, v26, v27
    v_cvt_pk_bf16_f32 v54, v28, v29
    v_cvt_pk_bf16_f32 v55, v30, v31
    v_lshlrev_b32 v16, 16, v48
    v_and_b32 v17, s37, v48
    v_lshlrev_b32 v18, 16, v49
    v_and_b32 v19, s37, v49
    v_lshlrev_b32 v20, 16, v50
    v_and_b32 v21, s37, v50
    v_lshlrev_b32 v22, 16, v51
    v_and_b32 v23, s37, v51
    v_lshlrev_b32 v24, 16, v52
    v_and_b32 v25, s37, v52
    v_lshlrev_b32 v26, 16, v53
    v_and_b32 v27, s37, v53
    v_lshlrev_b32 v28, 16, v54
    v_and_b32 v29, s37, v54
    v_lshlrev_b32 v30, 16, v55
    v_and_b32 v31, s37, v55
    v_pk_add_f32 v[16:17], v[16:17], v[120:121]
    v_pk_add_f32 v[18:19], v[18:19], v[122:123]
    v_pk_add_f32 v[20:21], v[20:21], v[124:125]
    v_pk_add_f32 v[22:23], v[22:23], v[126:127]
    v_pk_add_f32 v[24:25], v[24:25], v[128:129]
    v_pk_add_f32 v[26:27], v[26:27], v[130:131]
    v_pk_add_f32 v[28:29], v[28:29], v[132:133]
    v_pk_add_f32 v[30:31], v[30:31], v[134:135]
    v_cvt_pk_bf16_f32 v48, v16, v17
    v_cvt_pk_bf16_f32 v49, v18, v19
    v_cvt_pk_bf16_f32 v50, v20, v21
    v_cvt_pk_bf16_f32 v51, v22, v23
    v_cvt_pk_bf16_f32 v52, v24, v25
    v_cvt_pk_bf16_f32 v53, v26, v27
    v_cvt_pk_bf16_f32 v54, v28, v29
    v_cvt_pk_bf16_f32 v55, v30, v31
    ds_write_b64 v109, v[48:49] offset:0
    ds_write_b64 v109, v[50:51] offset:16
    ds_write_b64 v109, v[52:53] offset:32
    ds_write_b64 v109, v[54:55] offset:48
    ds_read_b128 v[64:67], v110 offset:0
    ds_read_b128 v[68:71], v110 offset:1280
    s_waitcnt lgkmcnt(1)
    global_store_dwordx4 v7, v[64:67], s[18:19]
    s_waitcnt lgkmcnt(0)
    global_store_dwordx4 v111, v[68:71], s[18:19]
K3_END:
    s_endpgm
K3_HR0_0:
    s_add_u32 s5, s5, 1
    s_cmp_gt_u32 s5, 0x200000
    s_cbranch_scc1 K3_HO0_0
    s_sleep 2
    s_mov_b32 m0, 0
    s_add_u32 s33, s63, 0
    s_and_b32 s33, s33, 15
    s_lshl_b32 s33, s33, 17
    buffer_load_dwordx4 v16, s[40:43], s33 offen offset:0 sc1 lds
    buffer_load_dwordx4 v17, s[40:43], s33 offen offset:1024 sc1 lds
    buffer_load_dwordx4 v18, s[40:43], s33 offen offset:2048 sc1 lds
    buffer_load_dwordx4 v19, s[40:43], s33 offen offset:3072 sc1 lds
    s_waitcnt vmcnt(0)
    ds_read_b128 v[128:131], v20 offset:0
    ds_read_b128 v[132:135], v20 offset:1024
    ds_read_b128 v[136:139], v20 offset:2048
    ds_read_b128 v[140:143], v20 offset:3072
    s_waitcnt lgkmcnt(2)
    v_max3_u32 v21, v128, v130, v132
    s_waitcnt lgkmcnt(0)
    v_max3_u32 v22, v136, v138, v140
    v_max3_u32 v21, v21, v134, v142
    v_max_u32 v21, v21, v22
    v_cmp_eq_u32 vcc, -1, v21
    s_cbranch_vccnz K3_HR0_0
    s_branch K3_HO0_0
K3_HR0_1:
    s_add_u32 s5, s5, 1
    s_cmp_gt_u32 s5, 0x200000
    s_cbranch_scc1 K3_HO0_1
    s_sleep 2
    s_mov_b32 m0, 8192
    s_add_u32 s33, s63, 1
    s_and_b32 s33, s33, 15
    s_lshl_b32 s33, s33, 17
    buffer_load_dwordx4 v16, s[40:43], s33 offen offset:0 sc1 lds
    buffer_load_dwordx4 v17, s[40:43], s33 offen offset:1024 sc1 lds
    buffer_load_dwordx4 v18, s[40:43], s33 offen offset:2048 sc1 lds
    buffer_load_dwordx4 v19, s[40:43], s33 offen offset:3072 sc1 lds
    s_waitcnt vmcnt(0)
    ds_read_b128 v[128:131], v20 offset:8192
    ds_read_b128 v[132:135], v20 offset:9216
    ds_read_b128 v[136:139], v20 offset:10240
    ds_read_b128 v[140:143], v20 offset:11264
    s_waitcnt lgkmcnt(2)
    v_max3_u32 v21, v128, v130, v132
    s_waitcnt lgkmcnt(0)
    v_max3_u32 v22, v136, v138, v140
    v_max3_u32 v21, v21, v134, v142
    v_max_u32 v21, v21, v22
    v_cmp_eq_u32 vcc, -1, v21
    s_cbranch_vccnz K3_HR0_1
    s_branch K3_HO0_1
K3_HR0_2:
    s_add_u32 s5, s5, 1
    s_cmp_gt_u32 s5, 0x200000
    s_cbranch_scc1 K3_HO0_2
    s_sleep 2
    s_mov_b32 m0, 16384
    s_add_u32 s33, s63, 2
    s_and_b32 s33, s33, 15
    s_lshl_b32 s33, s33, 17
    buffer_load_dwordx4 v16, s[40:43], s33 offen offset:0 sc1 lds
    buffer_load_dwordx4 v17, s[40:43], s33 offen offset:1024 sc1 lds
    buffer_load_dwordx4 v18, s[40:43], s33 offen offset:2048 sc1 lds
    buffer_load_dwordx4 v19, s[40:43], s33 offen offset:3072 sc1 lds
    s_waitcnt vmcnt(0)
    ds_read_b128 v[128:131], v20 offset:16384
    ds_read_b128 v[132:135], v20 offset:17408
    ds_read_b128 v[136:139], v20 offset:18432
    ds_read_b128 v[140:143], v20 offset:19456
    s_waitcnt lgkmcnt(2)
    v_max3_u32 v21, v128, v130, v132
    s_waitcnt lgkmcnt(0)
    v_max3_u32 v22, v136, v138, v140
    v_max3_u32 v21, v21, v134, v142
    v_max_u32 v21, v21, v22
    v_cmp_eq_u32 vcc, -1, v21
    s_cbranch_vccnz K3_HR0_2
    s_branch K3_HO0_2
K3_HR0_3:
    s_add_u32 s5, s5, 1
    s_cmp_gt_u32 s5, 0x200000
    s_cbranch_scc1 K3_HO0_3
    s_sleep 2
    s_mov_b32 m0, 24576
    s_add_u32 s33, s63, 3
    s_and_b32 s33, s33, 15
    s_lshl_b32 s33, s33, 17
    buffer_load_dwordx4 v16, s[40:43], s33 offen offset:0 sc1 lds
    buffer_load_dwordx4 v17, s[40:43], s33 offen offset:1024 sc1 lds
    buffer_load_dwordx4 v18, s[40:43], s33 offen offset:2048 sc1 lds
    buffer_load_dwordx4 v19, s[40:43], s33 offen offset:3072 sc1 lds
    s_waitcnt vmcnt(0)
    ds_read_b128 v[128:131], v20 offset:24576
    ds_read_b128 v[132:135], v20 offset:25600
    ds_read_b128 v[136:139], v20 offset:26624
    ds_read_b128 v[140:143], v20 offset:27648
    s_waitcnt lgkmcnt(2)
    v_max3_u32 v21, v128, v130, v132
    s_waitcnt lgkmcnt(0)
    v_max3_u32 v22, v136, v138, v140
    v_max3_u32 v21, v21, v134, v142
    v_max_u32 v21, v21, v22
    v_cmp_eq_u32 vcc, -1, v21
    s_cbranch_vccnz K3_HR0_3
    s_branch K3_HO0_3
K3_HR0_4:
    s_add_u32 s5, s5, 1
    s_cmp_gt_u32 s5, 0x200000
    s_cbranch_scc1 K3_HO0_4
    s_sleep 2
    s_mov_b32 m0, 32768
    s_add_u32 s33, s63, 4
    s_and_b32 s33, s33, 15
    s_lshl_b32 s33, s33, 17
    buffer_load_dwordx4 v16, s[40:43], s33 offen offset:0 sc1 lds
    buffer_load_dwordx4 v17, s[40:43], s33 offen offset:1024 sc1 lds
    buffer_load_dwordx4 v18, s[40:43], s33 offen offset:2048 sc1 lds
    buffer_load_dwordx4 v19, s[40:43], s33 offen offset:3072 sc1 lds
    s_waitcnt vmcnt(0)
    ds_read_b128 v[128:131], v20 offset:32768
    ds_read_b128 v[132:135], v20 offset:33792
    ds_read_b128 v[136:139], v20 offset:34816
    ds_read_b128 v[140:143], v20 offset:35840
    s_waitcnt lgkmcnt(2)
    v_max3_u32 v21, v128, v130, v132
    s_waitcnt lgkmcnt(0)
    v_max3_u32 v22, v136, v138, v140
    v_max3_u32 v21, v21, v134, v142
    v_max_u32 v21, v21, v22
    v_cmp_eq_u32 vcc, -1, v21
    s_cbranch_vccnz K3_HR0_4
    s_branch K3_HO0_4
K3_HR0_5:
    s_add_u32 s5, s5, 1
    s_cmp_gt_u32 s5, 0x200000
    s_cbranch_scc1 K3_HO0_5
    s_sleep 2
    s_mov_b32 m0, 40960
    s_add_u32 s33, s63, 5
    s_and_b32 s33, s33, 15
    s_lshl_b32 s33, s33, 17
    buffer_load_dwordx4 v16, s[40:43], s33 offen offset:0 sc1 lds
    buffer_load_dwordx4 v17, s[40:43], s33 offen offset:1024 sc1 lds
    buffer_load_dwordx4 v18, s[40:43], s33 offen offset:2048 sc1 lds
    buffer_load_dwordx4 v19, s[40:43], s33 offen offset:3072 sc1 lds
    s_waitcnt vmcnt(0)
    ds_read_b128 v[128:131], v20 offset:40960
    ds_read_b128 v[132:135], v20 offset:41984
    ds_read_b128 v[136:139], v20 offset:43008
    ds_read_b128 v[140:143], v20 offset:44032
    s_waitcnt lgkmcnt(2)
    v_max3_u32 v21, v128, v130, v132
    s_waitcnt lgkmcnt(0)
    v_max3_u32 v22, v136, v138, v140
    v_max3_u32 v21, v21, v134, v142
    v_max_u32 v21, v21, v22
    v_cmp_eq_u32 vcc, -1, v21
    s_cbranch_vccnz K3_HR0_5
    s_branch K3_HO0_5
K3_HR0_6:
    s_add_u32 s5, s5, 1
    s_cmp_gt_u32 s5, 0x200000
    s_cbranch_scc1 K3_HO0_6
    s_sleep 2
    s_mov_b32 m0, 0
    s_add_u32 s33, s63, 6
    s_and_b32 s33, s33, 15
    s_lshl_b32 s33, s33, 17
    buffer_load_dwordx4 v16, s[40:43], s33 offen offset:0 sc1 lds
    buffer_load_dwordx4 v17, s[40:43], s33 offen offset:1024 sc1 lds
    buffer_load_dwordx4 v18, s[40:43], s33 offen offset:2048 sc1 lds
    buffer_load_dwordx4 v19, s[40:43], s33 offen offset:3072 sc1 lds
    s_waitcnt vmcnt(0)
    ds_read_b128 v[128:131], v20 offset:0
    ds_read_b128 v[132:135], v20 offset:1024
    ds_read_b128 v[136:139], v20 offset:2048
    ds_read_b128 v[140:143], v20 offset:3072
    s_waitcnt lgkmcnt(2)
    v_max3_u32 v21, v128, v130, v132
    s_waitcnt lgkmcnt(0)
    v_max3_u32 v22, v136, v138, v140
    v_max3_u32 v21, v21, v134, v142
    v_max_u32 v21, v21, v22
    v_cmp_eq_u32 vcc, -1, v21
    s_cbranch_vccnz K3_HR0_6
    s_branch K3_HO0_6
K3_HR0_7:
    s_add_u32 s5, s5, 1
    s_cmp_gt_u32 s5, 0x200000
    s_cbranch_scc1 K3_HO0_7
    s_sleep 2
    s_mov_b32 m0, 8192
    s_add_u32 s33, s63, 7
    s_and_b32 s33, s33, 15
    s_lshl_b32 s33, s33, 17
    buffer_load_dwordx4 v16, s[40:43], s33 offen offset:0 sc1 lds
    buffer_load_dwordx4 v17, s[40:43], s33 offen offset:1024 sc1 lds
    buffer_load_dwordx4 v18, s[40:43], s33 offen offset:2048 sc1 lds
    buffer_load_dwordx4 v19, s[40:43], s33 offen offset:3072 sc1 lds
    s_waitcnt vmcnt(0)
    ds_read_b128 v[128:131], v20 offset:8192
    ds_read_b128 v[132:135], v20 offset:9216
    ds_read_b128 v[136:139], v20 offset:10240
    ds_read_b128 v[140:143], v20 offset:11264
    s_waitcnt lgkmcnt(2)
    v_max3_u32 v21, v128, v130, v132
    s_waitcnt lgkmcnt(0)
    v_max3_u32 v22, v136, v138, v140
    v_max3_u32 v21, v21, v134, v142
    v_max_u32 v21, v21, v22
    v_cmp_eq_u32 vcc, -1, v21
    s_cbranch_vccnz K3_HR0_7
    s_branch K3_HO0_7
K3_HR0_8:
    s_add_u32 s5, s5, 1
    s_cmp_gt_u32 s5, 0x200000
    s_cbranch_scc1 K3_HO0_8
    s_sleep 2
    s_mov_b32 m0, 16384
    s_add_u32 s33, s63, 8
    s_and_b32 s33, s33, 15
    s_lshl_b32 s33, s33, 17
    buffer_load_dwordx4 v16, s[40:43], s33 offen offset:0 sc1 lds
    buffer_load_dwordx4 v17, s[40:43], s33 offen offset:1024 sc1 lds
    buffer_load_dwordx4 v18, s[40:43], s33 offen offset:2048 sc1 lds
    buffer_load_dwordx4 v19, s[40:43], s33 offen offset:3072 sc1 lds
    s_waitcnt vmcnt(0)
    ds_read_b128 v[128:131], v20 offset:16384
    ds_read_b128 v[132:135], v20 offset:17408
    ds_read_b128 v[136:139], v20 offset:18432
    ds_read_b128 v[140:143], v20 offset:19456
    s_waitcnt lgkmcnt(2)
    v_max3_u32 v21, v128, v130, v132
    s_waitcnt lgkmcnt(0)
    v_max3_u32 v22, v136, v138, v140
    v_max3_u32 v21, v21, v134, v142
    v_max_u32 v21, v21, v22
    v_cmp_eq_u32 vcc, -1, v21
    s_cbranch_vccnz K3_HR0_8
    s_branch K3_HO0_8
K3_HR0_9:
    s_add_u32 s5, s5, 1
    s_cmp_gt_u32 s5, 0x200000
    s_cbranch_scc1 K3_HO0_9
    s_sleep 2
    s_mov_b32 m0, 24576
    s_add_u32 s33, s63, 9
    s_and_b32 s33, s33, 15
    s_lshl_b32 s33, s33, 17
    buffer_load_dwordx4 v16, s[40:43], s33 offen offset:0 sc1 lds
    buffer_load_dwordx4 v17, s[40:43], s33 offen offset:1024 sc1 lds
    buffer_load_dwordx4 v18, s[40:43], s33 offen offset:2048 sc1 lds
    buffer_load_dwordx4 v19, s[40:43], s33 offen offset:3072 sc1 lds
    s_waitcnt vmcnt(0)
    ds_read_b128 v[128:131], v20 offset:24576
    ds_read_b128 v[132:135], v20 offset:25600
    ds_read_b128 v[136:139], v20 offset:26624
    ds_read_b128 v[140:143], v20 offset:27648
    s_waitcnt lgkmcnt(2)
    v_max3_u32 v21, v128, v130, v132
    s_waitcnt lgkmcnt(0)
    v_max3_u32 v22, v136, v138, v140
    v_max3_u32 v21, v21, v134, v142
    v_max_u32 v21, v21, v22
    v_cmp_eq_u32 vcc, -1, v21
    s_cbranch_vccnz K3_HR0_9
    s_branch K3_HO0_9
K3_HR0_10:
    s_add_u32 s5, s5, 1
    s_cmp_gt_u32 s5, 0x200000
    s_cbranch_scc1 K3_HO0_10
    s_sleep 2
    s_mov_b32 m0, 32768
    s_add_u32 s33, s63, 10
    s_and_b32 s33, s33, 15
    s_lshl_b32 s33, s33, 17
    buffer_load_dwordx4 v16, s[40:43], s33 offen offset:0 sc1 lds
    buffer_load_dwordx4 v17, s[40:43], s33 offen offset:1024 sc1 lds
    buffer_load_dwordx4 v18, s[40:43], s33 offen offset:2048 sc1 lds
    buffer_load_dwordx4 v19, s[40:43], s33 offen offset:3072 sc1 lds
    s_waitcnt vmcnt(0)
    ds_read_b128 v[128:131], v20 offset:32768
    ds_read_b128 v[132:135], v20 offset:33792
    ds_read_b128 v[136:139], v20 offset:34816
    ds_read_b128 v[140:143], v20 offset:35840
    s_waitcnt lgkmcnt(2)
    v_max3_u32 v21, v128, v130, v132
    s_waitcnt lgkmcnt(0)
    v_max3_u32 v22, v136, v138, v140
    v_max3_u32 v21, v21, v134, v142
    v_max_u32 v21, v21, v22
    v_cmp_eq_u32 vcc, -1, v21
    s_cbranch_vccnz K3_HR0_10
    s_branch K3_HO0_10
K3_HR0_11:
    s_add_u32 s5, s5, 1
    s_cmp_gt_u32 s5, 0x200000
    s_cbranch_scc1 K3_HO0_11
    s_sleep 2
    s_mov_b32 m0, 40960
    s_add_u32 s33, s63, 11
    s_and_b32 s33, s33, 15
    s_lshl_b32 s33, s33, 17
    buffer_load_dwordx4 v16, s[40:43], s33 offen offset:0 sc1 lds
    buffer_load_dwordx4 v17, s[40:43], s33 offen offset:1024 sc1 lds
    buffer_load_dwordx4 v18, s[40:43], s33 offen offset:2048 sc1 lds
    buffer_load_dwordx4 v19, s[40:43], s33 offen offset:3072 sc1 lds
    s_waitcnt vmcnt(0)
    ds_read_b128 v[128:131], v20 offset:40960
    ds_read_b128 v[132:135], v20 offset:41984
    ds_read_b128 v[136:139], v20 offset:43008
    ds_read_b128 v[140:143], v20 offset:44032
    s_waitcnt lgkmcnt(2)
    v_max3_u32 v21, v128, v130, v132
    s_waitcnt lgkmcnt(0)
    v_max3_u32 v22, v136, v138, v140
    v_max3_u32 v21, v21, v134, v142
    v_max_u32 v21, v21, v22
    v_cmp_eq_u32 vcc, -1, v21
    s_cbranch_vccnz K3_HR0_11
    s_branch K3_HO0_11
K3_HR0_12:
    s_add_u32 s5, s5, 1
    s_cmp_gt_u32 s5, 0x200000
    s_cbranch_scc1 K3_HO0_12
    s_sleep 2
    s_mov_b32 m0, 0
    s_add_u32 s33, s63, 12
    s_and_b32 s33, s33, 15
    s_lshl_b32 s33, s33, 17
    buffer_load_dwordx4 v16, s[40:43], s33 offen offset:0 sc1 lds
    buffer_load_dwordx4 v17, s[40:43], s33 offen offset:1024 sc1 lds
    buffer_load_dwordx4 v18, s[40:43], s33 offen offset:2048 sc1 lds
    buffer_load_dwordx4 v19, s[40:43], s33 offen offset:3072 sc1 lds
    s_waitcnt vmcnt(0)
    ds_read_b128 v[128:131], v20 offset:0
    ds_read_b128 v[132:135], v20 offset:1024
    ds_read_b128 v[136:139], v20 offset:2048
    ds_read_b128 v[140:143], v20 offset:3072
    s_waitcnt lgkmcnt(2)
    v_max3_u32 v21, v128, v130, v132
    s_waitcnt lgkmcnt(0)
    v_max3_u32 v22, v136, v138, v140
    v_max3_u32 v21, v21, v134, v142
    v_max_u32 v21, v21, v22
    v_cmp_eq_u32 vcc, -1, v21
    s_cbranch_vccnz K3_HR0_12
    s_branch K3_HO0_12
K3_HR0_13:
    s_add_u32 s5, s5, 1
    s_cmp_gt_u32 s5, 0x200000
    s_cbranch_scc1 K3_HO0_13
    s_sleep 2
    s_mov_b32 m0, 8192
    s_add_u32 s33, s63, 13
    s_and_b32 s33, s33, 15
    s_lshl_b32 s33, s33, 17
    buffer_load_dwordx4 v16, s[40:43], s33 offen offset:0 sc1 lds
    buffer_load_dwordx4 v17, s[40:43], s33 offen offset:1024 sc1 lds
    buffer_load_dwordx4 v18, s[40:43], s33 offen offset:2048 sc1 lds
    buffer_load_dwordx4 v19, s[40:43], s33 offen offset:3072 sc1 lds
    s_waitcnt vmcnt(0)
    ds_read_b128 v[128:131], v20 offset:8192
    ds_read_b128 v[132:135], v20 offset:9216
    ds_read_b128 v[136:139], v20 offset:10240
    ds_read_b128 v[140:143], v20 offset:11264
    s_waitcnt lgkmcnt(2)
    v_max3_u32 v21, v128, v130, v132
    s_waitcnt lgkmcnt(0)
    v_max3_u32 v22, v136, v138, v140
    v_max3_u32 v21, v21, v134, v142
    v_max_u32 v21, v21, v22
    v_cmp_eq_u32 vcc, -1, v21
    s_cbranch_vccnz K3_HR0_13
    s_branch K3_HO0_13
K3_HR0_14:
    s_add_u32 s5, s5, 1
    s_cmp_gt_u32 s5, 0x200000
    s_cbranch_scc1 K3_HO0_14
    s_sleep 2
    s_mov_b32 m0, 16384
    s_add_u32 s33, s63, 14
    s_and_b32 s33, s33, 15
    s_lshl_b32 s33, s33, 17
    buffer_load_dwordx4 v16, s[40:43], s33 offen offset:0 sc1 lds
    buffer_load_dwordx4 v17, s[40:43], s33 offen offset:1024 sc1 lds
    buffer_load_dwordx4 v18, s[40:43], s33 offen offset:2048 sc1 lds
    buffer_load_dwordx4 v19, s[40:43], s33 offen offset:3072 sc1 lds
    s_waitcnt vmcnt(0)
    ds_read_b128 v[128:131], v20 offset:16384
    ds_read_b128 v[132:135], v20 offset:17408
    ds_read_b128 v[136:139], v20 offset:18432
    ds_read_b128 v[140:143], v20 offset:19456
    s_waitcnt lgkmcnt(2)
    v_max3_u32 v21, v128, v130, v132
    s_waitcnt lgkmcnt(0)
    v_max3_u32 v22, v136, v138, v140
    v_max3_u32 v21, v21, v134, v142
    v_max_u32 v21, v21, v22
    v_cmp_eq_u32 vcc, -1, v21
    s_cbranch_vccnz K3_HR0_14
    s_branch K3_HO0_14
K3_HR0_15:
    s_add_u32 s5, s5, 1
    s_cmp_gt_u32 s5, 0x200000
    s_cbranch_scc1 K3_HO0_15
    s_sleep 2
    s_mov_b32 m0, 24576
    s_add_u32 s33, s63, 15
    s_and_b32 s33, s33, 15
    s_lshl_b32 s33, s33, 17
    buffer_load_dwordx4 v16, s[40:43], s33 offen offset:0 sc1 lds
    buffer_load_dwordx4 v17, s[40:43], s33 offen offset:1024 sc1 lds
    buffer_load_dwordx4 v18, s[40:43], s33 offen offset:2048 sc1 lds
    buffer_load_dwordx4 v19, s[40:43], s33 offen offset:3072 sc1 lds
    s_waitcnt vmcnt(0)
    ds_read_b128 v[128:131], v20 offset:24576
    ds_read_b128 v[132:135], v20 offset:25600
    ds_read_b128 v[136:139], v20 offset:26624
    ds_read_b128 v[140:143], v20 offset:27648
    s_waitcnt lgkmcnt(2)
    v_max3_u32 v21, v128, v130, v132
    s_waitcnt lgkmcnt(0)
    v_max3_u32 v22, v136, v138, v140
    v_max3_u32 v21, v21, v134, v142
    v_max_u32 v21, v21, v22
    v_cmp_eq_u32 vcc, -1, v21
    s_cbranch_vccnz K3_HR0_15
    s_branch K3_HO0_15
K3_HR1_0:
    s_add_u32 s5, s5, 1
    s_cmp_gt_u32 s5, 0x200000
    s_cbranch_scc1 K3_HO1_0
    s_sleep 2
    s_mov_b32 m0, 4096
    s_add_u32 s33, s63, 0
    s_and_b32 s33, s33, 15
    s_lshl_b32 s33, s33, 17
    buffer_load_dwordx4 v16, s[40:43], s33 offen offset:0 sc1 lds
    buffer_load_dwordx4 v17, s[40:43], s33 offen offset:1024 sc1 lds
    buffer_load_dwordx4 v18, s[40:43], s33 offen offset:2048 sc1 lds
    buffer_load_dwordx4 v19, s[40:43], s33 offen offset:3072 sc1 lds
    s_waitcnt vmcnt(0)
    ds_read_b128 v[128:131], v20 offset:0
    ds_read_b128 v[132:135], v20 offset:1024
    ds_read_b128 v[136:139], v20 offset:2048
    ds_read_b128 v[140:143], v20 offset:3072
    s_waitcnt lgkmcnt(2)
    v_max3_u32 v21, v128, v130, v132
    s_waitcnt lgkmcnt(0)
    v_max3_u32 v22, v136, v138, v140
    v_max3_u32 v21, v21, v134, v142
    v_max_u32 v21, v21, v22
    v_cmp_eq_u32 vcc, -1, v21
    s_cbranch_vccnz K3_HR1_0
    s_branch K3_HO1_0
K3_HR1_1:
    s_add_u32 s5, s5, 1
    s_cmp_gt_u32 s5, 0x200000
    s_cbranch_scc1 K3_HO1_1
    s_sleep 2
    s_mov_b32 m0, 12288
    s_add_u32 s33, s63, 1
    s_and_b32 s33, s33, 15
    s_lshl_b32 s33, s33, 17
    buffer_load_dwordx4 v16, s[40:43], s33 offen offset:0 sc1 lds
    buffer_load_dwordx4 v17, s[40:43], s33 offen offset:1024 sc1 lds
    buffer_load_dwordx4 v18, s[40:43], s33 offen offset:2048 sc1 lds
    buffer_load_dwordx4 v19, s[40:43], s33 offen offset:3072 sc1 lds
    s_waitcnt vmcnt(0)
    ds_read_b128 v[128:131], v20 offset:8192
    ds_read_b128 v[132:135], v20 offset:9216
    ds_read_b128 v[136:139], v20 offset:10240
    ds_read_b128 v[140:143], v20 offset:11264
    s_waitcnt lgkmcnt(2)
    v_max3_u32 v21, v128, v130, v132
    s_waitcnt lgkmcnt(0)
    v_max3_u32 v22, v136, v138, v140
    v_max3_u32 v21, v21, v134, v142
    v_max_u32 v21, v21, v22
    v_cmp_eq_u32 vcc, -1, v21
    s_cbranch_vccnz K3_HR1_1
    s_branch K3_HO1_1
K3_HR1_2:
    s_add_u32 s5, s5, 1
    s_cmp_gt_u32 s5, 0x200000
    s_cbranch_scc1 K3_HO1_2
    s_sleep 2
    s_mov_b32 m0, 20480
    s_add_u32 s33, s63, 2
    s_and_b32 s33, s33, 15
    s_lshl_b32 s33, s33, 17
    buffer_load_dwordx4 v16, s[40:43], s33 offen offset:0 sc1 lds
    buffer_load_dwordx4 v17, s[40:43], s33 offen offset:1024 sc1 lds
    buffer_load_dwordx4 v18, s[40:43], s33 offen offset:2048 sc1 lds
    buffer_load_dwordx4 v19, s[40:43], s33 offen offset:3072 sc1 lds
    s_waitcnt vmcnt(0)
    ds_read_b128 v[128:131], v20 offset:16384
    ds_read_b128 v[132:135], v20 offset:17408
    ds_read_b128 v[136:139], v20 offset:18432
    ds_read_b128 v[140:143], v20 offset:19456
    s_waitcnt lgkmcnt(2)
    v_max3_u32 v21, v128, v130, v132
    s_waitcnt lgkmcnt(0)
    v_max3_u32 v22, v136, v138, v140
    v_max3_u32 v21, v21, v134, v142
    v_max_u32 v21, v21, v22
    v_cmp_eq_u32 vcc, -1, v21
    s_cbranch_vccnz K3_HR1_2
    s_branch K3_HO1_2
K3_HR1_3:
    s_add_u32 s5, s5, 1
    s_cmp_gt_u32 s5, 0x200000
    s_cbranch_scc1 K3_HO1_3
    s_sleep 2
    s_mov_b32 m0, 28672
    s_add_u32 s33, s63, 3
    s_and_b32 s33, s33, 15
    s_lshl_b32 s33, s33, 17
    buffer_load_dwordx4 v16, s[40:43], s33 offen offset:0 sc1 lds
    buffer_load_dwordx4 v17, s[40:43], s33 offen offset:1024 sc1 lds
    buffer_load_dwordx4 v18, s[40:43], s33 offen offset:2048 sc1 lds
    buffer_load_dwordx4 v19, s[40:43], s33 offen offset:3072 sc1 lds
    s_waitcnt vmcnt(0)
    ds_read_b128 v[128:131], v20 offset:24576
    ds_read_b128 v[132:135], v20 offset:25600
    ds_read_b128 v[136:139], v20 offset:26624
    ds_read_b128 v[140:143], v20 offset:27648
    s_waitcnt lgkmcnt(2)
    v_max3_u32 v21, v128, v130, v132
    s_waitcnt lgkmcnt(0)
    v_max3_u32 v22, v136, v138, v140
    v_max3_u32 v21, v21, v134, v142
    v_max_u32 v21, v21, v22
    v_cmp_eq_u32 vcc, -1, v21
    s_cbranch_vccnz K3_HR1_3
    s_branch K3_HO1_3
K3_HR1_4:
    s_add_u32 s5, s5, 1
    s_cmp_gt_u32 s5, 0x200000
    s_cbranch_scc1 K3_HO1_4
    s_sleep 2
    s_mov_b32 m0, 36864
    s_add_u32 s33, s63, 4
    s_and_b32 s33, s33, 15
    s_lshl_b32 s33, s33, 17
    buffer_load_dwordx4 v16, s[40:43], s33 offen offset:0 sc1 lds
    buffer_load_dwordx4 v17, s[40:43], s33 offen offset:1024 sc1 lds
    buffer_load_dwordx4 v18, s[40:43], s33 offen offset:2048 sc1 lds
    buffer_load_dwordx4 v19, s[40:43], s33 offen offset:3072 sc1 lds
    s_waitcnt vmcnt(0)
    ds_read_b128 v[128:131], v20 offset:32768
    ds_read_b128 v[132:135], v20 offset:33792
    ds_read_b128 v[136:139], v20 offset:34816
    ds_read_b128 v[140:143], v20 offset:35840
    s_waitcnt lgkmcnt(2)
    v_max3_u32 v21, v128, v130, v132
    s_waitcnt lgkmcnt(0)
    v_max3_u32 v22, v136, v138, v140
    v_max3_u32 v21, v21, v134, v142
    v_max_u32 v21, v21, v22
    v_cmp_eq_u32 vcc, -1, v21
    s_cbranch_vccnz K3_HR1_4
    s_branch K3_HO1_4
K3_HR1_5:
    s_add_u32 s5, s5, 1
    s_cmp_gt_u32 s5, 0x200000
    s_cbranch_scc1 K3_HO1_5
    s_sleep 2
    s_mov_b32 m0, 45056
    s_add_u32 s33, s63, 5
    s_and_b32 s33, s33, 15
    s_lshl_b32 s33, s33, 17
    buffer_load_dwordx4 v16, s[40:43], s33 offen offset:0 sc1 lds
    buffer_load_dwordx4 v17, s[40:43], s33 offen offset:1024 sc1 lds
    buffer_load_dwordx4 v18, s[40:43], s33 offen offset:2048 sc1 lds
    buffer_load_dwordx4 v19, s[40:43], s33 offen offset:3072 sc1 lds
    s_waitcnt vmcnt(0)
    ds_read_b128 v[128:131], v20 offset:40960
    ds_read_b128 v[132:135], v20 offset:41984
    ds_read_b128 v[136:139], v20 offset:43008
    ds_read_b128 v[140:143], v20 offset:44032
    s_waitcnt lgkmcnt(2)
    v_max3_u32 v21, v128, v130, v132
    s_waitcnt lgkmcnt(0)
    v_max3_u32 v22, v136, v138, v140
    v_max3_u32 v21, v21, v134, v142
    v_max_u32 v21, v21, v22
    v_cmp_eq_u32 vcc, -1, v21
    s_cbranch_vccnz K3_HR1_5
    s_branch K3_HO1_5
K3_HR1_6:
    s_add_u32 s5, s5, 1
    s_cmp_gt_u32 s5, 0x200000
    s_cbranch_scc1 K3_HO1_6
    s_sleep 2
    s_mov_b32 m0, 4096
    s_add_u32 s33, s63, 6
    s_and_b32 s33, s33, 15
    s_lshl_b32 s33, s33, 17
    buffer_load_dwordx4 v16, s[40:43], s33 offen offset:0 sc1 lds
    buffer_load_dwordx4 v17, s[40:43], s33 offen offset:1024 sc1 lds
    buffer_load_dwordx4 v18, s[40:43], s33 offen offset:2048 sc1 lds
    buffer_load_dwordx4 v19, s[40:43], s33 offen offset:3072 sc1 lds
    s_waitcnt vmcnt(0)
    ds_read_b128 v[128:131], v20 offset:0
    ds_read_b128 v[132:135], v20 offset:1024
    ds_read_b128 v[136:139], v20 offset:2048
    ds_read_b128 v[140:143], v20 offset:3072
    s_waitcnt lgkmcnt(2)
    v_max3_u32 v21, v128, v130, v132
    s_waitcnt lgkmcnt(0)
    v_max3_u32 v22, v136, v138, v140
    v_max3_u32 v21, v21, v134, v142
    v_max_u32 v21, v21, v22
    v_cmp_eq_u32 vcc, -1, v21
    s_cbranch_vccnz K3_HR1_6
    s_branch K3_HO1_6
K3_HR1_7:
    s_add_u32 s5, s5, 1
    s_cmp_gt_u32 s5, 0x200000
    s_cbranch_scc1 K3_HO1_7
    s_sleep 2
    s_mov_b32 m0, 12288
    s_add_u32 s33, s63, 7
    s_and_b32 s33, s33, 15
    s_lshl_b32 s33, s33, 17
    buffer_load_dwordx4 v16, s[40:43], s33 offen offset:0 sc1 lds
    buffer_load_dwordx4 v17, s[40:43], s33 offen offset:1024 sc1 lds
    buffer_load_dwordx4 v18, s[40:43], s33 offen offset:2048 sc1 lds
    buffer_load_dwordx4 v19, s[40:43], s33 offen offset:3072 sc1 lds
    s_waitcnt vmcnt(0)
    ds_read_b128 v[128:131], v20 offset:8192
    ds_read_b128 v[132:135], v20 offset:9216
    ds_read_b128 v[136:139], v20 offset:10240
    ds_read_b128 v[140:143], v20 offset:11264
    s_waitcnt lgkmcnt(2)
    v_max3_u32 v21, v128, v130, v132
    s_waitcnt lgkmcnt(0)
    v_max3_u32 v22, v136, v138, v140
    v_max3_u32 v21, v21, v134, v142
    v_max_u32 v21, v21, v22
    v_cmp_eq_u32 vcc, -1, v21
    s_cbranch_vccnz K3_HR1_7
    s_branch K3_HO1_7
K3_HR1_8:
    s_add_u32 s5, s5, 1
    s_cmp_gt_u32 s5, 0x200000
    s_cbranch_scc1 K3_HO1_8
    s_sleep 2
    s_mov_b32 m0, 20480
    s_add_u32 s33, s63, 8
    s_and_b32 s33, s33, 15
    s_lshl_b32 s33, s33, 17
    buffer_load_dwordx4 v16, s[40:43], s33 offen offset:0 sc1 lds
    buffer_load_dwordx4 v17, s[40:43], s33 offen offset:1024 sc1 lds
    buffer_load_dwordx4 v18, s[40:43], s33 offen offset:2048 sc1 lds
    buffer_load_dwordx4 v19, s[40:43], s33 offen offset:3072 sc1 lds
    s_waitcnt vmcnt(0)
    ds_read_b128 v[128:131], v20 offset:16384
    ds_read_b128 v[132:135], v20 offset:17408
    ds_read_b128 v[136:139], v20 offset:18432
    ds_read_b128 v[140:143], v20 offset:19456
    s_waitcnt lgkmcnt(2)
    v_max3_u32 v21, v128, v130, v132
    s_waitcnt lgkmcnt(0)
    v_max3_u32 v22, v136, v138, v140
    v_max3_u32 v21, v21, v134, v142
    v_max_u32 v21, v21, v22
    v_cmp_eq_u32 vcc, -1, v21
    s_cbranch_vccnz K3_HR1_8
    s_branch K3_HO1_8
K3_HR1_9:
    s_add_u32 s5, s5, 1
    s_cmp_gt_u32 s5, 0x200000
    s_cbranch_scc1 K3_HO1_9
    s_sleep 2
    s_mov_b32 m0, 28672
    s_add_u32 s33, s63, 9
    s_and_b32 s33, s33, 15
    s_lshl_b32 s33, s33, 17
    buffer_load_dwordx4 v16, s[40:43], s33 offen offset:0 sc1 lds
    buffer_load_dwordx4 v17, s[40:43], s33 offen offset:1024 sc1 lds
    buffer_load_dwordx4 v18, s[40:43], s33 offen offset:2048 sc1 lds
    buffer_load_dwordx4 v19, s[40:43], s33 offen offset:3072 sc1 lds
    s_waitcnt vmcnt(0)
    ds_read_b128 v[128:131], v20 offset:24576
    ds_read_b128 v[132:135], v20 offset:25600
    ds_read_b128 v[136:139], v20 offset:26624
    ds_read_b128 v[140:143], v20 offset:27648
    s_waitcnt lgkmcnt(2)
    v_max3_u32 v21, v128, v130, v132
    s_waitcnt lgkmcnt(0)
    v_max3_u32 v22, v136, v138, v140
    v_max3_u32 v21, v21, v134, v142
    v_max_u32 v21, v21, v22
    v_cmp_eq_u32 vcc, -1, v21
    s_cbranch_vccnz K3_HR1_9
    s_branch K3_HO1_9
K3_HR1_10:
    s_add_u32 s5, s5, 1
    s_cmp_gt_u32 s5, 0x200000
    s_cbranch_scc1 K3_HO1_10
    s_sleep 2
    s_mov_b32 m0, 36864
    s_add_u32 s33, s63, 10
    s_and_b32 s33, s33, 15
    s_lshl_b32 s33, s33, 17
    buffer_load_dwordx4 v16, s[40:43], s33 offen offset:0 sc1 lds
    buffer_load_dwordx4 v17, s[40:43], s33 offen offset:1024 sc1 lds
    buffer_load_dwordx4 v18, s[40:43], s33 offen offset:2048 sc1 lds
    buffer_load_dwordx4 v19, s[40:43], s33 offen offset:3072 sc1 lds
    s_waitcnt vmcnt(0)
    ds_read_b128 v[128:131], v20 offset:32768
    ds_read_b128 v[132:135], v20 offset:33792
    ds_read_b128 v[136:139], v20 offset:34816
    ds_read_b128 v[140:143], v20 offset:35840
    s_waitcnt lgkmcnt(2)
    v_max3_u32 v21, v128, v130, v132
    s_waitcnt lgkmcnt(0)
    v_max3_u32 v22, v136, v138, v140
    v_max3_u32 v21, v21, v134, v142
    v_max_u32 v21, v21, v22
    v_cmp_eq_u32 vcc, -1, v21
    s_cbranch_vccnz K3_HR1_10
    s_branch K3_HO1_10
K3_HR1_11:
    s_add_u32 s5, s5, 1
    s_cmp_gt_u32 s5, 0x200000
    s_cbranch_scc1 K3_HO1_11
    s_sleep 2
    s_mov_b32 m0, 45056
    s_add_u32 s33, s63, 11
    s_and_b32 s33, s33, 15
    s_lshl_b32 s33, s33, 17
    buffer_load_dwordx4 v16, s[40:43], s33 offen offset:0 sc1 lds
    buffer_load_dwordx4 v17, s[40:43], s33 offen offset:1024 sc1 lds
    buffer_load_dwordx4 v18, s[40:43], s33 offen offset:2048 sc1 lds
    buffer_load_dwordx4 v19, s[40:43], s33 offen offset:3072 sc1 lds
    s_waitcnt vmcnt(0)
    ds_read_b128 v[128:131], v20 offset:40960
    ds_read_b128 v[132:135], v20 offset:41984
    ds_read_b128 v[136:139], v20 offset:43008
    ds_read_b128 v[140:143], v20 offset:44032
    s_waitcnt lgkmcnt(2)
    v_max3_u32 v21, v128, v130, v132
    s_waitcnt lgkmcnt(0)
    v_max3_u32 v22, v136, v138, v140
    v_max3_u32 v21, v21, v134, v142
    v_max_u32 v21, v21, v22
    v_cmp_eq_u32 vcc, -1, v21
    s_cbranch_vccnz K3_HR1_11
    s_branch K3_HO1_11
K3_HR1_12:
    s_add_u32 s5, s5, 1
    s_cmp_gt_u32 s5, 0x200000
    s_cbranch_scc1 K3_HO1_12
    s_sleep 2
    s_mov_b32 m0, 4096
    s_add_u32 s33, s63, 12
    s_and_b32 s33, s33, 15
    s_lshl_b32 s33, s33, 17
    buffer_load_dwordx4 v16, s[40:43], s33 offen offset:0 sc1 lds
    buffer_load_dwordx4 v17, s[40:43], s33 offen offset:1024 sc1 lds
    buffer_load_dwordx4 v18, s[40:43], s33 offen offset:2048 sc1 lds
    buffer_load_dwordx4 v19, s[40:43], s33 offen offset:3072 sc1 lds
    s_waitcnt vmcnt(0)
    ds_read_b128 v[128:131], v20 offset:0
    ds_read_b128 v[132:135], v20 offset:1024
    ds_read_b128 v[136:139], v20 offset:2048
    ds_read_b128 v[140:143], v20 offset:3072
    s_waitcnt lgkmcnt(2)
    v_max3_u32 v21, v128, v130, v132
    s_waitcnt lgkmcnt(0)
    v_max3_u32 v22, v136, v138, v140
    v_max3_u32 v21, v21, v134, v142
    v_max_u32 v21, v21, v22
    v_cmp_eq_u32 vcc, -1, v21
    s_cbranch_vccnz K3_HR1_12
    s_branch K3_HO1_12
K3_HR1_13:
    s_add_u32 s5, s5, 1
    s_cmp_gt_u32 s5, 0x200000
    s_cbranch_scc1 K3_HO1_13
    s_sleep 2
    s_mov_b32 m0, 12288
    s_add_u32 s33, s63, 13
    s_and_b32 s33, s33, 15
    s_lshl_b32 s33, s33, 17
    buffer_load_dwordx4 v16, s[40:43], s33 offen offset:0 sc1 lds
    buffer_load_dwordx4 v17, s[40:43], s33 offen offset:1024 sc1 lds
    buffer_load_dwordx4 v18, s[40:43], s33 offen offset:2048 sc1 lds
    buffer_load_dwordx4 v19, s[40:43], s33 offen offset:3072 sc1 lds
    s_waitcnt vmcnt(0)
    ds_read_b128 v[128:131], v20 offset:8192
    ds_read_b128 v[132:135], v20 offset:9216
    ds_read_b128 v[136:139], v20 offset:10240
    ds_read_b128 v[140:143], v20 offset:11264
    s_waitcnt lgkmcnt(2)
    v_max3_u32 v21, v128, v130, v132
    s_waitcnt lgkmcnt(0)
    v_max3_u32 v22, v136, v138, v140
    v_max3_u32 v21, v21, v134, v142
    v_max_u32 v21, v21, v22
    v_cmp_eq_u32 vcc, -1, v21
    s_cbranch_vccnz K3_HR1_13
    s_branch K3_HO1_13
K3_HR1_14:
    s_add_u32 s5, s5, 1
    s_cmp_gt_u32 s5, 0x200000
    s_cbranch_scc1 K3_HO1_14
    s_sleep 2
    s_mov_b32 m0, 20480
    s_add_u32 s33, s63, 14
    s_and_b32 s33, s33, 15
    s_lshl_b32 s33, s33, 17
    buffer_load_dwordx4 v16, s[40:43], s33 offen offset:0 sc1 lds
    buffer_load_dwordx4 v17, s[40:43], s33 offen offset:1024 sc1 lds
    buffer_load_dwordx4 v18, s[40:43], s33 offen offset:2048 sc1 lds
    buffer_load_dwordx4 v19, s[40:43], s33 offen offset:3072 sc1 lds
    s_waitcnt vmcnt(0)
    ds_read_b128 v[128:131], v20 offset:16384
    ds_read_b128 v[132:135], v20 offset:17408
    ds_read_b128 v[136:139], v20 offset:18432
    ds_read_b128 v[140:143], v20 offset:19456
    s_waitcnt lgkmcnt(2)
    v_max3_u32 v21, v128, v130, v132
    s_waitcnt lgkmcnt(0)
    v_max3_u32 v22, v136, v138, v140
    v_max3_u32 v21, v21, v134, v142
    v_max_u32 v21, v21, v22
    v_cmp_eq_u32 vcc, -1, v21
    s_cbranch_vccnz K3_HR1_14
    s_branch K3_HO1_14
K3_HR1_15:
    s_add_u32 s5, s5, 1
    s_cmp_gt_u32 s5, 0x200000
    s_cbranch_scc1 K3_HO1_15
    s_sleep 2
    s_mov_b32 m0, 28672
    s_add_u32 s33, s63, 15
    s_and_b32 s33, s33, 15
    s_lshl_b32 s33, s33, 17
    buffer_load_dwordx4 v16, s[40:43], s33 offen offset:0 sc1 lds
    buffer_load_dwordx4 v17, s[40:43], s33 offen offset:1024 sc1 lds
    buffer_load_dwordx4 v18, s[40:43], s33 offen offset:2048 sc1 lds
    buffer_load_dwordx4 v19, s[40:43], s33 offen offset:3072 sc1 lds
    s_waitcnt vmcnt(0)
    ds_read_b128 v[128:131], v20 offset:24576
    ds_read_b128 v[132:135], v20 offset:25600
    ds_read_b128 v[136:139], v20 offset:26624
    ds_read_b128 v[140:143], v20 offset:27648
    s_waitcnt lgkmcnt(2)
    v_max3_u32 v21, v128, v130, v132
    s_waitcnt lgkmcnt(0)
    v_max3_u32 v22, v136, v138, v140
    v_max3_u32 v21, v21, v134, v142
    v_max_u32 v21, v21, v22
    v_cmp_eq_u32 vcc, -1, v21
    s_cbranch_vccnz K3_HR1_15
    s_branch K3_HO1_15
.section .rodata,"a"
.p2align 6
.amdhsa_kernel sequential_preLN__ssm_conv_s4d__swiglu_ffn__prompt_kernel
  .amdhsa_next_free_vgpr 256
  .amdhsa_next_free_sgpr 100
  .amdhsa_accum_offset 256
  .amdhsa_group_segment_fixed_size 0
  .amdhsa_kernarg_size 112
  .amdhsa_user_sgpr_count 2
  .amdhsa_user_sgpr_kernarg_segment_ptr 1
  .amdhsa_system_sgpr_workgroup_id_x 1
.end_amdhsa_kernel
```
